```python
import torch

def _softmax(x, axis=-1):
    return torch.softmax(x, dim=axis)
def _gelu(x):
    return torch.nn.functional.gelu(x, approximate="tanh")
def _silu(x):
    return torch.nn.functional.silu(x)
def _sigmoid(x):
    return torch.sigmoid(x)
def _layernorm(x, axis=-1, eps=1e-5):
    m = x.mean(dim=axis, keepdim=True)
    v = x.var(dim=axis, keepdim=True, unbiased=False)
    return (x - m) / torch.sqrt(v + eps)
def _scatter_add(tgt, idx, src, axis=0):
    return tgt.clone().index_add_(axis, idx, src)
def _segment_sum(src, seg, n):
    out = torch.zeros((n,) + src.shape[1:], dtype=src.dtype)
    return out.index_add_(0, seg, src)
def _pad(x, pw):
    flat = tuple(v for pair in reversed(pw) for v in pair)
    return torch.nn.functional.pad(x, flat)

kernel_name = 'parallel_sum__grouped_kv_mqa__glu_gated_geglu__prompt'

def setup_inputs():

    _w = (lambda a: (lambda t: t.to(torch.bfloat16) if t.is_floating_point() else t)(torch.as_tensor(a)))
    def _A_setup():
        B, S, D, H = 1, 2048, 512, 32
        Dh = D // H
        return {
            "x": _w((lambda *s: torch.randn(*s, dtype=torch.bfloat16) * 0.05)(B, S, D)),
            "wq": _w((lambda *s: torch.randn(*s, dtype=torch.bfloat16) * 0.05)(D, H * Dh)),
            "wk": _w((lambda *s: torch.randn(*s, dtype=torch.bfloat16) * 0.05)(D, Dh)),
            "wv": _w((lambda *s: torch.randn(*s, dtype=torch.bfloat16) * 0.05)(D, Dh)),
            "wo": _w((lambda *s: torch.randn(*s, dtype=torch.bfloat16) * 0.05)(H * Dh, D)),
        }
    _A_in = _A_setup()

    def _B_setup():
        B, S, Dm, Df = 1, 2048, 512, 1792
        return {
            "x": _w((lambda *s: torch.randn(*s, dtype=torch.bfloat16) * 0.05)(B, S, Dm)),
            "w_gate": _w((lambda *s: torch.randn(*s, dtype=torch.bfloat16) * 0.4)(Dm, Df) * (Dm ** -0.5)),
            "w_up": _w((lambda *s: torch.randn(*s, dtype=torch.bfloat16) * 0.4)(Dm, Df) * (Dm ** -0.5)),
            "w_down": _w((lambda *s: torch.randn(*s, dtype=torch.bfloat16) * 0.4)(Df, Dm) * (Df ** -0.5)),
        }
    _B_in = _B_setup()

    return {
        "A_x": _A_in["x"],
        "A_wq": _A_in["wq"],
        "A_wk": _A_in["wk"],
        "A_wv": _A_in["wv"],
        "A_wo": _A_in["wo"],
        "B_x": _B_in["x"],
        "B_w_gate": _B_in["w_gate"],
        "B_w_up": _B_in["w_up"],
        "B_w_down": _B_in["w_down"],
    }

def reference(A_x, A_wq, A_wk, A_wv, A_wo, B_x, B_w_gate, B_w_up, B_w_down):
    def _A_ref(x, wq, wk, wv, wo):
        B, S, D = x.shape
        H = 32
        Dh = D // H
        q = (lambda x, *d: x.permute(*d))((x @ wq).reshape(B, S, H, Dh), 0, 2, 1, 3)
        k = x @ wk
        v = x @ wv
        scores = torch.einsum("bhqd,bkd->bhqk", q, k) * (Dh ** -0.5)
        p = _softmax(scores, axis=-1)
        o = torch.einsum("bhqk,bkd->bhqd", p, v)
        return (lambda x, *d: x.permute(*d))(o, 0, 2, 1, 3).reshape(B, S, H * Dh) @ wo

    def _B_ref(x, w_gate, w_up, w_down):
        g = torch.einsum("bsd,df->bsf", x, w_gate)
        u = torch.einsum("bsd,df->bsf", x, w_up)
        h = _gelu(g) * u
        return torch.einsum("bsf,fd->bsd", h, w_down)

    x = A_x
    xn = _layernorm(x, axis=-1)
    return x + _A_ref(xn, A_wq, A_wk, A_wv, A_wo) + _B_ref(xn, B_w_gate, B_w_up, B_w_down)
```

```asm
; @launch grid=(768,1,1) block=(256,1,1) lds=81920
.amdgcn_target "amdgcn-amd-amdhsa--gfx950"
.text
.globl parallel_sum__grouped_kv_mqa__glu_gated_geglu__prompt_kernel
.p2align 8
.type parallel_sum__grouped_kv_mqa__glu_gated_geglu__prompt_kernel,@function
parallel_sum__grouped_kv_mqa__glu_gated_geglu__prompt_kernel:
    s_cmp_ge_u32 s2, 768
    s_cbranch_scc1 K_end
    s_load_dwordx16 s[16:31], s[0:1], 0
    s_load_dwordx8 s[32:39], s[0:1], 64
    v_and_b32 v1, 63, v0
    v_lshrrev_b32 v2, 6, v0
    s_nop 0
    v_readfirstlane_b32 s3, v2
    s_waitcnt lgkmcnt(0)
    s_cmp_ge_u32 s2, 32
    s_cbranch_scc1 K_notkv
    s_setprio 3
    s_and_b32 s4, s2, 7
    s_lshl_b32 s4, s4, 2
    s_lshr_b32 s5, s2, 3
    s_add_u32 s4, s4, s5
    s_mov_b32 s40, s16
    s_and_b32 s41, s17, 0xffff
    s_mov_b32 s42, 2097152
    s_mov_b32 s43, 0x00020000
    s_mul_i32 s6, s3, 20480
    v_lshrrev_b32 v3, 3, v1
    v_lshlrev_b32 v3, 10, v3
    v_and_b32 v4, 7, v1
    v_lshrrev_b32 v5, 4, v1
    v_xor_b32 v6, v4, v5
    v_lshl_add_u32 v8, v6, 4, v3
    v_xor_b32 v9, 64, v8
    s_lshl_b32 s8, s4, 16
    s_lshl_b32 s9, s3, 8
    s_add_u32 s8, s8, s9
    s_add_u32 m0, s6, 8192
    s_add_u32 s10, s8, 0
    buffer_load_dwordx4 v8, s[40:43], s10 offen lds
    s_add_u32 m0, s6, 9216
    s_add_u32 s10, s8, 8192
    buffer_load_dwordx4 v9, s[40:43], s10 offen lds
    s_add_u32 m0, s6, 10240
    s_add_u32 s10, s8, 16384
    buffer_load_dwordx4 v8, s[40:43], s10 offen lds
    s_add_u32 m0, s6, 11264
    s_add_u32 s10, s8, 24576
    buffer_load_dwordx4 v9, s[40:43], s10 offen lds
    s_mov_b32 s44, s20
    s_and_b32 s45, s21, 0xffff
    s_mov_b32 s46, 16384
    s_mov_b32 s47, 0x00020000
    s_mov_b32 s48, s22
    s_and_b32 s49, s23, 0xffff
    s_mov_b32 s50, 16384
    s_mov_b32 s51, 0x00020000
    v_lshlrev_b32 v3, 4, v1
    v_xor_b32 v5, 128, v3
    s_lshl_b32 s9, s3, 12
    s_add_u32 m0, s6, 0
    s_add_u32 s10, s9, 0
    buffer_load_dwordx4 v3, s[44:47], s10 offen lds
    s_add_u32 m0, s6, 4096
    s_nop 0
    buffer_load_dwordx4 v5, s[48:51], s10 offen lds
    s_add_u32 m0, s6, 1024
    s_add_u32 s10, s9, 1024
    buffer_load_dwordx4 v3, s[44:47], s10 offen lds
    s_add_u32 m0, s6, 5120
    s_nop 0
    buffer_load_dwordx4 v5, s[48:51], s10 offen lds
    s_add_u32 m0, s6, 2048
    s_add_u32 s10, s9, 2048
    buffer_load_dwordx4 v3, s[44:47], s10 offen lds
    s_add_u32 m0, s6, 6144
    s_nop 0
    buffer_load_dwordx4 v5, s[48:51], s10 offen lds
    s_add_u32 m0, s6, 3072
    s_add_u32 s10, s9, 3072
    buffer_load_dwordx4 v3, s[44:47], s10 offen lds
    s_add_u32 m0, s6, 7168
    s_nop 0
    buffer_load_dwordx4 v5, s[48:51], s10 offen lds
    s_add_u32 m0, s6, 12288
    s_add_u32 s10, s8, 128
    buffer_load_dwordx4 v8, s[40:43], s10 offen lds
    s_add_u32 m0, s6, 13312
    s_add_u32 s10, s8, 8320
    buffer_load_dwordx4 v9, s[40:43], s10 offen lds
    s_add_u32 m0, s6, 14336
    s_add_u32 s10, s8, 16512
    buffer_load_dwordx4 v8, s[40:43], s10 offen lds
    s_add_u32 m0, s6, 15360
    s_add_u32 s10, s8, 24704
    buffer_load_dwordx4 v9, s[40:43], s10 offen lds
    s_add_u32 m0, s6, 16384
    s_add_u32 s10, s8, 32768
    buffer_load_dwordx4 v8, s[40:43], s10 offen lds
    s_add_u32 m0, s6, 17408
    s_add_u32 s10, s8, 40960
    buffer_load_dwordx4 v9, s[40:43], s10 offen lds
    s_add_u32 m0, s6, 18432
    s_add_u32 s10, s8, 49152
    buffer_load_dwordx4 v8, s[40:43], s10 offen lds
    s_add_u32 m0, s6, 19456
    s_add_u32 s10, s8, 57344
    buffer_load_dwordx4 v9, s[40:43], s10 offen lds
    v_lshlrev_b32 v6, 10, v1
    s_add_u32 s10, s8, 32896
    s_mov_b32 exec_lo, 0xffffffff
    s_mov_b32 exec_hi, 0x0
    buffer_load_dword v200, v6, s[40:43], s10 offen
    s_mov_b64 exec, -1
    s_mov_b32 s52, s38
    s_and_b32 s53, s39, 0xffff
    s_mov_b32 s54, 524288
    s_mov_b32 s55, 0x00020000
    s_mov_b32 s60, s38
    s_and_b32 s61, s39, 0xffff
    s_mov_b32 s62, 65536
    s_mov_b32 s63, 0x00020000
    s_add_u32 s64, s38, 65536
    s_addc_u32 s65, s39, 0
    s_and_b32 s65, s65, 0xffff
    s_mov_b32 s66, 65536
    s_mov_b32 s67, 0x00020000
    s_or_b32 s76, s2, s3
    s_cmp_lg_u32 s76, 0
    s_cbranch_scc1 TAGW_1
    s_memrealtime s[76:77]
    s_waitcnt lgkmcnt(0)
    s_or_b32 s76, s76, 1
    v_mov_b32 v2, 0
    v_mov_b32 v3, s76
    s_mov_b32 exec_lo, 0x1
    s_mov_b32 exec_hi, 0x0
    global_store_dword v2, v3, s[36:37] sc0 sc1
    s_mov_b64 exec, -1
TAGW_1:
    v_and_b32 v6, 31, v1
    v_lshrrev_b32 v7, 5, v1
    v_bfe_u32 v11, v1, 1, 3
    v_xor_b32 v11, v11, v7
    v_lshlrev_b32 v11, 4, v11
    v_lshl_add_u32 v11, v6, 7, v11
    v_add_u32 v12, s6, v11
    v_xor_b32 v13, 32, v12
    v_xor_b32 v14, 64, v12
    v_xor_b32 v15, 96, v12
    v_bfe_u32 v3, v1, 4, 1
    v_lshlrev_b32 v10, 12, v3
    v_bfe_u32 v11, v1, 2, 2
    v_lshl_add_u32 v11, v7, 3, v11
    v_lshl_add_u32 v10, v11, 5, v10
    v_and_b32 v11, 3, v1
    v_lshl_add_u32 v10, v11, 3, v10
    v_add_u32 v10, s6, v10
    v_lshlrev_b32 v3, 7, v3
    v_xor_b32 v11, 128, v3
    v_add_u32 v11, v10, v11
    v_add_u32 v10, v10, v3
    v_mov_b32 v16, 0
    v_mov_b32 v17, 0
    v_mov_b32 v18, 0
    v_mov_b32 v19, 0
    v_mov_b32 v20, 0
    v_mov_b32 v21, 0
    v_mov_b32 v22, 0
    v_mov_b32 v23, 0
    v_mov_b32 v24, 0
    v_mov_b32 v25, 0
    v_mov_b32 v26, 0
    v_mov_b32 v27, 0
    v_mov_b32 v28, 0
    v_mov_b32 v29, 0
    v_mov_b32 v30, 0
    v_mov_b32 v31, 0
    v_mov_b32 v32, 0
    v_mov_b32 v33, 0
    v_mov_b32 v34, 0
    v_mov_b32 v35, 0
    v_mov_b32 v36, 0
    v_mov_b32 v37, 0
    v_mov_b32 v38, 0
    v_mov_b32 v39, 0
    v_mov_b32 v40, 0
    v_mov_b32 v41, 0
    v_mov_b32 v42, 0
    v_mov_b32 v43, 0
    v_mov_b32 v44, 0
    v_mov_b32 v45, 0
    v_mov_b32 v46, 0
    v_mov_b32 v47, 0
    v_mov_b32 v48, 0
    v_mov_b32 v49, 0
    v_mov_b32 v50, 0
    v_mov_b32 v51, 0
    v_mov_b32 v52, 0
    v_mov_b32 v53, 0
    v_mov_b32 v54, 0
    v_mov_b32 v55, 0
    v_mov_b32 v56, 0
    v_mov_b32 v57, 0
    v_mov_b32 v58, 0
    v_mov_b32 v59, 0
    v_mov_b32 v60, 0
    v_mov_b32 v61, 0
    v_mov_b32 v62, 0
    v_mov_b32 v63, 0
    v_mov_b32 v64, 0
    v_mov_b32 v65, 0
    v_mov_b32 v66, 0
    v_mov_b32 v67, 0
    v_mov_b32 v68, 0
    v_mov_b32 v69, 0
    v_mov_b32 v70, 0
    v_mov_b32 v71, 0
    v_mov_b32 v72, 0
    v_mov_b32 v73, 0
    v_mov_b32 v74, 0
    v_mov_b32 v75, 0
    v_mov_b32 v76, 0
    v_mov_b32 v77, 0
    v_mov_b32 v78, 0
    v_mov_b32 v79, 0
    v_mov_b32 v80, 0
    v_mov_b32 v81, 0
    v_mov_b32 v82, 0
    v_mov_b32 v83, 0
    v_mov_b32 v84, 0
    v_mov_b32 v85, 0
    v_mov_b32 v86, 0
    v_mov_b32 v87, 0
    v_mov_b32 v88, 0
    v_mov_b32 v89, 0
    v_mov_b32 v90, 0
    v_mov_b32 v91, 0
    v_mov_b32 v92, 0
    v_mov_b32 v93, 0
    v_mov_b32 v94, 0
    v_mov_b32 v95, 0
    v_mov_b32 v128, 0x3f803f80
    v_mov_b32 v129, 0x3f803f80
    v_mov_b32 v130, 0x3f803f80
    v_mov_b32 v131, 0x3f803f80
    v_mov_b32 v132, 0
    v_mov_b32 v133, 0
    v_mov_b32 v134, 0
    v_mov_b32 v135, 0
    s_waitcnt vmcnt(1)
    v_mov_b32 v205, 0
    global_load_dword v204, v205, s[36:37]
    ds_read_b64_tr_b16 v[96:97], v10 offset:0
    ds_read_b64_tr_b16 v[98:99], v11 offset:0
    ds_read_b64_tr_b16 v[100:101], v10 offset:512
    ds_read_b64_tr_b16 v[102:103], v11 offset:512
    ds_read_b64_tr_b16 v[104:105], v10 offset:1024
    ds_read_b64_tr_b16 v[106:107], v11 offset:1024
    ds_read_b64_tr_b16 v[108:109], v10 offset:1536
    ds_read_b64_tr_b16 v[110:111], v11 offset:1536
    ds_read_b64_tr_b16 v[112:113], v10 offset:2048
    ds_read_b64_tr_b16 v[114:115], v11 offset:2048
    ds_read_b64_tr_b16 v[116:117], v10 offset:2560
    ds_read_b64_tr_b16 v[118:119], v11 offset:2560
    ds_read_b64_tr_b16 v[120:121], v10 offset:3072
    ds_read_b64_tr_b16 v[122:123], v11 offset:3072
    ds_read_b64_tr_b16 v[124:125], v10 offset:3584
    ds_read_b64_tr_b16 v[126:127], v11 offset:3584
    ds_read_b128 v[144:147], v12 offset:8192
    ds_read_b128 v[148:151], v13 offset:8192
    ds_read_b128 v[152:155], v14 offset:8192
    ds_read_b128 v[156:159], v15 offset:8192
    s_waitcnt lgkmcnt(3)
    v_mfma_f32_32x32x16_bf16 v[16:31], v[96:99], v[144:147], v[16:31]
    v_lshlrev_b32 v136, 16, v144
    v_and_b32 v137, 0xffff0000, v144
    v_fma_f32 v132, v136, v136, v132
    v_fma_f32 v133, v137, v137, v133
    v_lshlrev_b32 v138, 16, v145
    v_and_b32 v139, 0xffff0000, v145
    v_mfma_f32_32x32x16_bf16 v[64:79], v[128:131], v[144:147], v[64:79]
    v_fma_f32 v132, v138, v138, v132
    v_fma_f32 v133, v139, v139, v133
    v_lshlrev_b32 v136, 16, v146
    v_and_b32 v137, 0xffff0000, v146
    v_fma_f32 v132, v136, v136, v132
    v_fma_f32 v133, v137, v137, v133
    v_mfma_f32_32x32x16_bf16 v[48:63], v[96:99], v[128:131], v[48:63]
    v_lshlrev_b32 v138, 16, v147
    v_and_b32 v139, 0xffff0000, v147
    v_fma_f32 v132, v138, v138, v132
    v_fma_f32 v133, v139, v139, v133
    ds_read_b128 v[144:147], v12 offset:12288
    s_waitcnt lgkmcnt(3)
    v_mfma_f32_32x32x16_bf16 v[16:31], v[100:103], v[148:151], v[16:31]
    v_lshlrev_b32 v136, 16, v148
    v_and_b32 v137, 0xffff0000, v148
    v_fma_f32 v132, v136, v136, v132
    v_fma_f32 v133, v137, v137, v133
    v_lshlrev_b32 v138, 16, v149
    v_and_b32 v139, 0xffff0000, v149
    v_mfma_f32_32x32x16_bf16 v[64:79], v[128:131], v[148:151], v[64:79]
    v_fma_f32 v132, v138, v138, v132
    v_fma_f32 v133, v139, v139, v133
    v_lshlrev_b32 v136, 16, v150
    v_and_b32 v137, 0xffff0000, v150
    v_fma_f32 v132, v136, v136, v132
    v_fma_f32 v133, v137, v137, v133
    v_mfma_f32_32x32x16_bf16 v[48:63], v[100:103], v[128:131], v[48:63]
    v_lshlrev_b32 v138, 16, v151
    v_and_b32 v139, 0xffff0000, v151
    v_fma_f32 v132, v138, v138, v132
    v_fma_f32 v133, v139, v139, v133
    ds_read_b128 v[148:151], v13 offset:12288
    s_waitcnt lgkmcnt(3)
    v_mfma_f32_32x32x16_bf16 v[16:31], v[104:107], v[152:155], v[16:31]
    v_lshlrev_b32 v136, 16, v152
    v_and_b32 v137, 0xffff0000, v152
    v_fma_f32 v132, v136, v136, v132
    v_fma_f32 v133, v137, v137, v133
    v_lshlrev_b32 v138, 16, v153
    v_and_b32 v139, 0xffff0000, v153
    v_mfma_f32_32x32x16_bf16 v[64:79], v[128:131], v[152:155], v[64:79]
    v_fma_f32 v132, v138, v138, v132
    v_fma_f32 v133, v139, v139, v133
    v_lshlrev_b32 v136, 16, v154
    v_and_b32 v137, 0xffff0000, v154
    v_fma_f32 v132, v136, v136, v132
    v_fma_f32 v133, v137, v137, v133
    v_mfma_f32_32x32x16_bf16 v[48:63], v[104:107], v[128:131], v[48:63]
    v_lshlrev_b32 v138, 16, v155
    v_and_b32 v139, 0xffff0000, v155
    v_fma_f32 v132, v138, v138, v132
    v_fma_f32 v133, v139, v139, v133
    ds_read_b128 v[152:155], v14 offset:12288
    s_waitcnt lgkmcnt(3)
    v_mfma_f32_32x32x16_bf16 v[16:31], v[108:111], v[156:159], v[16:31]
    v_lshlrev_b32 v136, 16, v156
    v_and_b32 v137, 0xffff0000, v156
    v_fma_f32 v132, v136, v136, v132
    v_fma_f32 v133, v137, v137, v133
    v_lshlrev_b32 v138, 16, v157
    v_and_b32 v139, 0xffff0000, v157
    v_mfma_f32_32x32x16_bf16 v[64:79], v[128:131], v[156:159], v[64:79]
    v_fma_f32 v132, v138, v138, v132
    v_fma_f32 v133, v139, v139, v133
    v_lshlrev_b32 v136, 16, v158
    v_and_b32 v137, 0xffff0000, v158
    v_fma_f32 v132, v136, v136, v132
    v_fma_f32 v133, v137, v137, v133
    v_mfma_f32_32x32x16_bf16 v[48:63], v[108:111], v[128:131], v[48:63]
    v_lshlrev_b32 v138, 16, v159
    v_and_b32 v139, 0xffff0000, v159
    v_fma_f32 v132, v138, v138, v132
    v_fma_f32 v133, v139, v139, v133
    ds_read_b128 v[156:159], v15 offset:12288
    s_waitcnt lgkmcnt(3)
    v_mfma_f32_32x32x16_bf16 v[16:31], v[112:115], v[144:147], v[16:31]
    v_lshlrev_b32 v136, 16, v144
    v_and_b32 v137, 0xffff0000, v144
    v_fma_f32 v132, v136, v136, v132
    v_fma_f32 v133, v137, v137, v133
    v_lshlrev_b32 v138, 16, v145
    v_and_b32 v139, 0xffff0000, v145
    v_mfma_f32_32x32x16_bf16 v[64:79], v[128:131], v[144:147], v[64:79]
    v_fma_f32 v132, v138, v138, v132
    v_fma_f32 v133, v139, v139, v133
    v_lshlrev_b32 v136, 16, v146
    v_and_b32 v137, 0xffff0000, v146
    v_fma_f32 v132, v136, v136, v132
    v_fma_f32 v133, v137, v137, v133
    v_mfma_f32_32x32x16_bf16 v[48:63], v[112:115], v[128:131], v[48:63]
    v_lshlrev_b32 v138, 16, v147
    v_and_b32 v139, 0xffff0000, v147
    v_fma_f32 v132, v138, v138, v132
    v_fma_f32 v133, v139, v139, v133
    s_add_u32 m0, s6, 8192
    s_add_u32 s10, s8, 32896
    buffer_load_dwordx4 v8, s[40:43], s10 offen lds
    s_add_u32 m0, s6, 9216
    s_add_u32 s10, s8, 41088
    buffer_load_dwordx4 v9, s[40:43], s10 offen lds
    s_add_u32 m0, s6, 10240
    s_add_u32 s10, s8, 49280
    buffer_load_dwordx4 v8, s[40:43], s10 offen lds
    s_add_u32 m0, s6, 11264
    s_add_u32 s10, s8, 57472
    buffer_load_dwordx4 v9, s[40:43], s10 offen lds
    ds_read_b128 v[144:147], v12 offset:16384
    s_waitcnt lgkmcnt(3)
    v_mfma_f32_32x32x16_bf16 v[16:31], v[116:119], v[148:151], v[16:31]
    v_lshlrev_b32 v136, 16, v148
    v_and_b32 v137, 0xffff0000, v148
    v_fma_f32 v132, v136, v136, v132
    v_fma_f32 v133, v137, v137, v133
    v_lshlrev_b32 v138, 16, v149
    v_and_b32 v139, 0xffff0000, v149
    v_mfma_f32_32x32x16_bf16 v[64:79], v[128:131], v[148:151], v[64:79]
    v_fma_f32 v132, v138, v138, v132
    v_fma_f32 v133, v139, v139, v133
    v_lshlrev_b32 v136, 16, v150
    v_and_b32 v137, 0xffff0000, v150
    v_fma_f32 v132, v136, v136, v132
    v_fma_f32 v133, v137, v137, v133
    v_mfma_f32_32x32x16_bf16 v[48:63], v[116:119], v[128:131], v[48:63]
    v_lshlrev_b32 v138, 16, v151
    v_and_b32 v139, 0xffff0000, v151
    v_fma_f32 v132, v138, v138, v132
    v_fma_f32 v133, v139, v139, v133
    ds_read_b128 v[148:151], v13 offset:16384
    s_waitcnt lgkmcnt(3)
    v_mfma_f32_32x32x16_bf16 v[16:31], v[120:123], v[152:155], v[16:31]
    v_lshlrev_b32 v136, 16, v152
    v_and_b32 v137, 0xffff0000, v152
    v_fma_f32 v132, v136, v136, v132
    v_fma_f32 v133, v137, v137, v133
    v_lshlrev_b32 v138, 16, v153
    v_and_b32 v139, 0xffff0000, v153
    v_mfma_f32_32x32x16_bf16 v[64:79], v[128:131], v[152:155], v[64:79]
    v_fma_f32 v132, v138, v138, v132
    v_fma_f32 v133, v139, v139, v133
    v_lshlrev_b32 v136, 16, v154
    v_and_b32 v137, 0xffff0000, v154
    v_fma_f32 v132, v136, v136, v132
    v_fma_f32 v133, v137, v137, v133
    v_mfma_f32_32x32x16_bf16 v[48:63], v[120:123], v[128:131], v[48:63]
    v_lshlrev_b32 v138, 16, v155
    v_and_b32 v139, 0xffff0000, v155
    v_fma_f32 v132, v138, v138, v132
    v_fma_f32 v133, v139, v139, v133
    ds_read_b128 v[152:155], v14 offset:16384
    s_waitcnt lgkmcnt(3)
    v_mfma_f32_32x32x16_bf16 v[16:31], v[124:127], v[156:159], v[16:31]
    v_lshlrev_b32 v136, 16, v156
    v_and_b32 v137, 0xffff0000, v156
    v_fma_f32 v132, v136, v136, v132
    v_fma_f32 v133, v137, v137, v133
    v_lshlrev_b32 v138, 16, v157
    v_and_b32 v139, 0xffff0000, v157
    v_mfma_f32_32x32x16_bf16 v[64:79], v[128:131], v[156:159], v[64:79]
    v_fma_f32 v132, v138, v138, v132
    v_fma_f32 v133, v139, v139, v133
    v_lshlrev_b32 v136, 16, v158
    v_and_b32 v137, 0xffff0000, v158
    v_fma_f32 v132, v136, v136, v132
    v_fma_f32 v133, v137, v137, v133
    v_mfma_f32_32x32x16_bf16 v[48:63], v[124:127], v[128:131], v[48:63]
    v_lshlrev_b32 v138, 16, v159
    v_and_b32 v139, 0xffff0000, v159
    v_fma_f32 v132, v138, v138, v132
    v_fma_f32 v133, v139, v139, v133
    ds_read_b128 v[156:159], v15 offset:16384
    s_waitcnt lgkmcnt(3)
    v_mfma_f32_32x32x16_bf16 v[32:47], v[96:99], v[144:147], v[32:47]
    v_lshlrev_b32 v136, 16, v144
    v_and_b32 v137, 0xffff0000, v144
    v_fma_f32 v134, v136, v136, v134
    v_fma_f32 v135, v137, v137, v135
    v_lshlrev_b32 v138, 16, v145
    v_and_b32 v139, 0xffff0000, v145
    v_mfma_f32_32x32x16_bf16 v[80:95], v[128:131], v[144:147], v[80:95]
    v_fma_f32 v134, v138, v138, v134
    v_fma_f32 v135, v139, v139, v135
    v_lshlrev_b32 v136, 16, v146
    v_and_b32 v137, 0xffff0000, v146
    v_fma_f32 v134, v136, v136, v134
    v_fma_f32 v135, v137, v137, v135
    v_lshlrev_b32 v138, 16, v147
    v_and_b32 v139, 0xffff0000, v147
    v_fma_f32 v134, v138, v138, v134
    v_fma_f32 v135, v139, v139, v135
    s_waitcnt vmcnt(0)
    ds_read_b128 v[144:147], v12 offset:8192
    s_waitcnt lgkmcnt(3)
    v_mfma_f32_32x32x16_bf16 v[32:47], v[100:103], v[148:151], v[32:47]
    v_lshlrev_b32 v136, 16, v148
    v_and_b32 v137, 0xffff0000, v148
    v_fma_f32 v134, v136, v136, v134
    v_fma_f32 v135, v137, v137, v135
    v_lshlrev_b32 v138, 16, v149
    v_and_b32 v139, 0xffff0000, v149
    v_mfma_f32_32x32x16_bf16 v[80:95], v[128:131], v[148:151], v[80:95]
    v_fma_f32 v134, v138, v138, v134
    v_fma_f32 v135, v139, v139, v135
    v_lshlrev_b32 v136, 16, v150
    v_and_b32 v137, 0xffff0000, v150
    v_fma_f32 v134, v136, v136, v134
    v_fma_f32 v135, v137, v137, v135
    v_lshlrev_b32 v138, 16, v151
    v_and_b32 v139, 0xffff0000, v151
    v_fma_f32 v134, v138, v138, v134
    v_fma_f32 v135, v139, v139, v135
    ds_read_b128 v[148:151], v13 offset:8192
    s_waitcnt lgkmcnt(3)
    v_mfma_f32_32x32x16_bf16 v[32:47], v[104:107], v[152:155], v[32:47]
    v_lshlrev_b32 v136, 16, v152
    v_and_b32 v137, 0xffff0000, v152
    v_fma_f32 v134, v136, v136, v134
    v_fma_f32 v135, v137, v137, v135
    v_lshlrev_b32 v138, 16, v153
    v_and_b32 v139, 0xffff0000, v153
    v_mfma_f32_32x32x16_bf16 v[80:95], v[128:131], v[152:155], v[80:95]
    v_fma_f32 v134, v138, v138, v134
    v_fma_f32 v135, v139, v139, v135
    v_lshlrev_b32 v136, 16, v154
    v_and_b32 v137, 0xffff0000, v154
    v_fma_f32 v134, v136, v136, v134
    v_fma_f32 v135, v137, v137, v135
    v_lshlrev_b32 v138, 16, v155
    v_and_b32 v139, 0xffff0000, v155
    v_fma_f32 v134, v138, v138, v134
    v_fma_f32 v135, v139, v139, v135
    ds_read_b128 v[152:155], v14 offset:8192
    s_waitcnt lgkmcnt(3)
    v_mfma_f32_32x32x16_bf16 v[32:47], v[108:111], v[156:159], v[32:47]
    v_lshlrev_b32 v136, 16, v156
    v_and_b32 v137, 0xffff0000, v156
    v_fma_f32 v134, v136, v136, v134
    v_fma_f32 v135, v137, v137, v135
    v_lshlrev_b32 v138, 16, v157
    v_and_b32 v139, 0xffff0000, v157
    v_mfma_f32_32x32x16_bf16 v[80:95], v[128:131], v[156:159], v[80:95]
    v_fma_f32 v134, v138, v138, v134
    v_fma_f32 v135, v139, v139, v135
    v_lshlrev_b32 v136, 16, v158
    v_and_b32 v137, 0xffff0000, v158
    v_fma_f32 v134, v136, v136, v134
    v_fma_f32 v135, v137, v137, v135
    v_lshlrev_b32 v138, 16, v159
    v_and_b32 v139, 0xffff0000, v159
    v_fma_f32 v134, v138, v138, v134
    v_fma_f32 v135, v139, v139, v135
    s_waitcnt vmcnt(0)
    ds_read_b128 v[156:159], v15 offset:8192
    s_waitcnt lgkmcnt(3)
    v_mfma_f32_32x32x16_bf16 v[32:47], v[112:115], v[144:147], v[32:47]
    v_lshlrev_b32 v136, 16, v144
    v_and_b32 v137, 0xffff0000, v144
    v_fma_f32 v134, v136, v136, v134
    v_fma_f32 v135, v137, v137, v135
    v_lshlrev_b32 v138, 16, v145
    v_and_b32 v139, 0xffff0000, v145
    v_mfma_f32_32x32x16_bf16 v[80:95], v[128:131], v[144:147], v[80:95]
    v_fma_f32 v134, v138, v138, v134
    v_fma_f32 v135, v139, v139, v135
    v_lshlrev_b32 v136, 16, v146
    v_and_b32 v137, 0xffff0000, v146
    v_fma_f32 v134, v136, v136, v134
    v_fma_f32 v135, v137, v137, v135
    v_lshlrev_b32 v138, 16, v147
    v_and_b32 v139, 0xffff0000, v147
    v_fma_f32 v134, v138, v138, v134
    v_fma_f32 v135, v139, v139, v135
    s_waitcnt lgkmcnt(2)
    v_mfma_f32_32x32x16_bf16 v[32:47], v[116:119], v[148:151], v[32:47]
    v_lshlrev_b32 v136, 16, v148
    v_and_b32 v137, 0xffff0000, v148
    v_fma_f32 v134, v136, v136, v134
    v_fma_f32 v135, v137, v137, v135
    v_lshlrev_b32 v138, 16, v149
    v_and_b32 v139, 0xffff0000, v149
    v_mfma_f32_32x32x16_bf16 v[80:95], v[128:131], v[148:151], v[80:95]
    v_fma_f32 v134, v138, v138, v134
    v_fma_f32 v135, v139, v139, v135
    v_lshlrev_b32 v136, 16, v150
    v_and_b32 v137, 0xffff0000, v150
    v_fma_f32 v134, v136, v136, v134
    v_fma_f32 v135, v137, v137, v135
    v_lshlrev_b32 v138, 16, v151
    v_and_b32 v139, 0xffff0000, v151
    v_fma_f32 v134, v138, v138, v134
    v_fma_f32 v135, v139, v139, v135
    s_waitcnt lgkmcnt(1)
    v_mfma_f32_32x32x16_bf16 v[32:47], v[120:123], v[152:155], v[32:47]
    v_lshlrev_b32 v136, 16, v152
    v_and_b32 v137, 0xffff0000, v152
    v_fma_f32 v134, v136, v136, v134
    v_fma_f32 v135, v137, v137, v135
    v_lshlrev_b32 v138, 16, v153
    v_and_b32 v139, 0xffff0000, v153
    v_mfma_f32_32x32x16_bf16 v[80:95], v[128:131], v[152:155], v[80:95]
    v_fma_f32 v134, v138, v138, v134
    v_fma_f32 v135, v139, v139, v135
    v_lshlrev_b32 v136, 16, v154
    v_and_b32 v137, 0xffff0000, v154
    v_fma_f32 v134, v136, v136, v134
    v_fma_f32 v135, v137, v137, v135
    v_lshlrev_b32 v138, 16, v155
    v_and_b32 v139, 0xffff0000, v155
    v_fma_f32 v134, v138, v138, v134
    v_fma_f32 v135, v139, v139, v135
    s_waitcnt lgkmcnt(0)
    v_mfma_f32_32x32x16_bf16 v[32:47], v[124:127], v[156:159], v[32:47]
    v_lshlrev_b32 v136, 16, v156
    v_and_b32 v137, 0xffff0000, v156
    v_fma_f32 v134, v136, v136, v134
    v_fma_f32 v135, v137, v137, v135
    v_lshlrev_b32 v138, 16, v157
    v_and_b32 v139, 0xffff0000, v157
    v_mfma_f32_32x32x16_bf16 v[80:95], v[128:131], v[156:159], v[80:95]
    v_fma_f32 v134, v138, v138, v134
    v_fma_f32 v135, v139, v139, v135
    v_lshlrev_b32 v136, 16, v158
    v_and_b32 v137, 0xffff0000, v158
    v_fma_f32 v134, v136, v136, v134
    v_fma_f32 v135, v137, v137, v135
    v_lshlrev_b32 v138, 16, v159
    v_and_b32 v139, 0xffff0000, v159
    v_fma_f32 v134, v138, v138, v134
    v_fma_f32 v135, v139, v139, v135
    s_barrier
    v_add_f32 v132, v132, v133
    v_add_f32 v134, v134, v135
    v_lshlrev_b32 v3, 4, v1
    s_mul_i32 s9, s3, 12288
    v_add_u32 v2, s9, v3
    ds_write_b128 v2, v[16:19] offset:0
    ds_write_b128 v2, v[20:23] offset:1024
    ds_write_b128 v2, v[24:27] offset:2048
    ds_write_b128 v2, v[28:31] offset:3072
    ds_write_b128 v2, v[32:35] offset:4096
    ds_write_b128 v2, v[36:39] offset:5120
    ds_write_b128 v2, v[40:43] offset:6144
    ds_write_b128 v2, v[44:47] offset:7168
    ds_write_b128 v2, v[48:51] offset:8192
    ds_write_b128 v2, v[52:55] offset:9216
    ds_write_b128 v2, v[56:59] offset:10240
    ds_write_b128 v2, v[60:63] offset:11264
    v_lshlrev_b32 v4, 2, v1
    s_lshl_b32 s9, s3, 10
    s_add_u32 s9, s9, 49152
    v_add_u32 v4, s9, v4
    ds_write_b32 v4, v64
    ds_write_b32 v4, v80 offset:256
    ds_write_b32 v4, v132 offset:512
    ds_write_b32 v4, v134 offset:768
    v_readfirstlane_b32 s74, v204
    s_cmp_lg_u32 s74, 0
    s_cbranch_scc1 TAGF_3
    s_mov_b32 s75, 0
TAGR_2:
    s_sleep 4
    global_load_dword v204, v205, s[36:37] sc0 sc1
    s_waitcnt vmcnt(0)
    v_readfirstlane_b32 s74, v204
    s_cmp_lg_u32 s74, 0
    s_cbranch_scc1 TAGF_3
    s_add_u32 s75, s75, 1
    s_cmp_lt_u32 s75, 200000
    s_cbranch_scc1 TAGR_2
TAGF_3:
    s_waitcnt lgkmcnt(0)
    s_barrier
    v_lshlrev_b32 v3, 4, v1
    s_and_b32 s10, s3, 1
    s_lshr_b32 s11, s3, 1
    s_lshl_b32 s9, s10, 12
    s_lshl_b32 s12, s11, 11
    s_add_u32 s9, s9, s12
    v_add_u32 v2, s9, v3
    v_add_u32 v4, s12, v3
    ds_read_b128 v[16:19], v2 offset:0
    ds_read_b128 v[48:51], v4 offset:8192
    ds_read_b128 v[20:23], v2 offset:1024
    ds_read_b128 v[52:55], v4 offset:9216
    ds_read_b128 v[24:27], v2 offset:12288
    ds_read_b128 v[56:59], v4 offset:20480
    ds_read_b128 v[28:31], v2 offset:13312
    ds_read_b128 v[60:63], v4 offset:21504
    ds_read_b128 v[32:35], v2 offset:24576
    ds_read_b128 v[64:67], v4 offset:32768
    ds_read_b128 v[36:39], v2 offset:25600
    ds_read_b128 v[68:71], v4 offset:33792
    ds_read_b128 v[40:43], v2 offset:36864
    ds_read_b128 v[72:75], v4 offset:45056
    ds_read_b128 v[44:47], v2 offset:37888
    ds_read_b128 v[76:79], v4 offset:46080
    v_lshlrev_b32 v5, 2, v6
    s_lshl_b32 s9, s10, 8
    s_add_u32 s9, s9, 49152
    v_add_u32 v5, s9, v5
    ds_read_b32 v80, v5 offset:0
    ds_read_b32 v84, v5 offset:512
    ds_read_b32 v85, v5 offset:640
    ds_read_b32 v81, v5 offset:1024
    ds_read_b32 v86, v5 offset:1536
    ds_read_b32 v87, v5 offset:1664
    ds_read_b32 v82, v5 offset:2048
    ds_read_b32 v88, v5 offset:2560
    ds_read_b32 v89, v5 offset:2688
    ds_read_b32 v83, v5 offset:3072
    ds_read_b32 v90, v5 offset:3584
    ds_read_b32 v91, v5 offset:3712
    s_lshl_b32 s13, s4, 1
    s_add_u32 s13, s13, s10
    s_waitcnt lgkmcnt(0)
    v_add_f32 v16, v16, v24
    v_add_f32 v32, v32, v40
    v_add_f32 v48, v48, v56
    v_add_f32 v64, v64, v72
    v_add_f32 v17, v17, v25
    v_add_f32 v33, v33, v41
    v_add_f32 v49, v49, v57
    v_add_f32 v65, v65, v73
    v_add_f32 v18, v18, v26
    v_add_f32 v34, v34, v42
    v_add_f32 v50, v50, v58
    v_add_f32 v66, v66, v74
    v_add_f32 v19, v19, v27
    v_add_f32 v35, v35, v43
    v_add_f32 v51, v51, v59
    v_add_f32 v67, v67, v75
    v_add_f32 v20, v20, v28
    v_add_f32 v36, v36, v44
    v_add_f32 v52, v52, v60
    v_add_f32 v68, v68, v76
    v_add_f32 v21, v21, v29
    v_add_f32 v37, v37, v45
    v_add_f32 v53, v53, v61
    v_add_f32 v69, v69, v77
    v_add_f32 v22, v22, v30
    v_add_f32 v38, v38, v46
    v_add_f32 v54, v54, v62
    v_add_f32 v70, v70, v78
    v_add_f32 v23, v23, v31
    v_add_f32 v39, v39, v47
    v_add_f32 v55, v55, v63
    v_add_f32 v71, v71, v79
    v_add_f32 v80, v80, v81
    v_add_f32 v82, v82, v83
    v_add_f32 v84, v84, v85
    v_add_f32 v86, v86, v87
    v_add_f32 v88, v88, v89
    v_add_f32 v90, v90, v91
    v_add_f32 v80, v80, v82
    v_add_f32 v84, v84, v86
    v_add_f32 v88, v88, v90
    v_add_f32 v84, v84, v88
    v_mul_f32 v80, 0.001953125, v80
    v_mul_f32 v84, 0.001953125, v84
    v_fma_f32 v84, -v80, v80, v84
    v_max_f32 v84, 0, v84
    v_add_f32 v84, 0x3727c5ac, v84
    v_rsq_f32 v86, v84
    v_add_f32 v16, v16, v32
    v_add_f32 v48, v48, v64
    v_add_f32 v17, v17, v33
    v_add_f32 v49, v49, v65
    v_add_f32 v18, v18, v34
    v_add_f32 v50, v50, v66
    v_add_f32 v19, v19, v35
    v_add_f32 v51, v51, v67
    v_add_f32 v20, v20, v36
    v_add_f32 v52, v52, v68
    v_add_f32 v21, v21, v37
    v_add_f32 v53, v53, v69
    v_add_f32 v22, v22, v38
    v_add_f32 v54, v54, v70
    v_add_f32 v23, v23, v39
    v_add_f32 v55, v55, v71
    v_mul_f32 v87, v80, v86
    v_sub_f32 v87, 0, v87
    v_mul_f32 v48, v87, v48
    v_mul_f32 v49, v87, v49
    v_mul_f32 v50, v87, v50
    v_mul_f32 v51, v87, v51
    v_mul_f32 v52, v87, v52
    v_mul_f32 v53, v87, v53
    v_mul_f32 v54, v87, v54
    v_mul_f32 v55, v87, v55
    v_fma_f32 v16, v16, v86, v48
    v_fma_f32 v17, v17, v86, v49
    v_fma_f32 v18, v18, v86, v50
    v_fma_f32 v19, v19, v86, v51
    v_fma_f32 v20, v20, v86, v52
    v_fma_f32 v21, v21, v86, v53
    v_fma_f32 v22, v22, v86, v54
    v_fma_f32 v23, v23, v86, v55
    v_cvt_pk_bf16_f32 v64, v16, v17
    v_cvt_pk_bf16_f32 v65, v18, v19
    v_cvt_pk_bf16_f32 v66, v20, v21
    v_cvt_pk_bf16_f32 v67, v22, v23
    s_cmp_eq_u32 s11, 1
    s_cbranch_scc1 KV_V_4
    v_and_b32 v2, 0x33, v1
    v_bfe_u32 v4, v1, 2, 1
    v_lshl_or_b32 v2, v4, 3, v2
    v_bfe_u32 v4, v1, 3, 1
    v_lshl_or_b32 v2, v4, 2, v2
    v_lshlrev_b32 v2, 4, v2
    s_lshl_b32 s12, s13, 10
    buffer_store_dwordx4 v[64:67], v2, s[60:63], s12 offen sc1
    s_lshl_b32 s12, s13, 7
    v_lshl_add_u32 v4, v6, 2, s12
    s_mov_b32 exec_lo, 0xffffffff
    s_mov_b32 exec_hi, 0x0
    s_mov_b32 s14, 131072
    buffer_store_dword v86, v4, s[52:55], s14 offen sc1
    s_mov_b32 s14, 139264
    buffer_store_dword v87, v4, s[52:55], s14 offen sc1
    s_mov_b64 exec, -1
    v_mul_f32 v84, v16, v16
    v_mul_f32 v85, v17, v17
    v_fmac_f32 v84, v18, v18
    v_fmac_f32 v85, v19, v19
    v_fmac_f32 v84, v20, v20
    v_fmac_f32 v85, v21, v21
    v_fmac_f32 v84, v22, v22
    v_fmac_f32 v85, v23, v23
    v_add_f32 v84, v84, v85
    v_mov_b32 v85, v84
    s_nop 1
    v_permlane32_swap_b32 v84, v85
    s_nop 1
    v_add_f32 v84, v84, v85
    s_nop 1
    v_max_f32_dpp v84, v84, v84 quad_perm:[1,0,3,2] row_mask:0xf bank_mask:0xf
    s_nop 1
    v_max_f32_dpp v84, v84, v84 quad_perm:[2,3,0,1] row_mask:0xf bank_mask:0xf
    s_nop 1
    v_max_f32_dpp v84, v84, v84 row_half_mirror row_mask:0xf bank_mask:0xf
    s_nop 1
    v_max_f32_dpp v84, v84, v84 row_mirror row_mask:0xf bank_mask:0xf
    s_nop 1
    v_max_f32_dpp v84, v84, v84 row_bcast:15 row_mask:0xa bank_mask:0xf
    s_nop 1
    v_max_f32_dpp v84, v84, v84 row_bcast:31 row_mask:0xc bank_mask:0xf
    s_lshl_b32 s12, s13, 2
    s_add_u32 s14, s12, 147456
    v_mov_b32 v2, 0
    s_mov_b32 exec_lo, 0x0
    s_mov_b32 exec_hi, 0x80000000
    buffer_store_dword v84, v2, s[52:55], s14 offen sc1
    s_mov_b64 exec, -1
    s_branch KV_e_5
KV_V_4:
    s_lshl_b32 s9, s10, 10
    s_add_u32 s9, s9, 57344
    v_lshlrev_b32 v2, 1, v6
    v_lshl_add_u32 v2, v7, 8, v2
    v_add_u32 v2, s9, v2
    ds_write_b16 v2, v64 offset:0
    ds_write_b16_d16_hi v2, v64 offset:64
    ds_write_b16 v2, v65 offset:128
    ds_write_b16_d16_hi v2, v65 offset:192
    ds_write_b16 v2, v66 offset:512
    ds_write_b16_d16_hi v2, v66 offset:576
    ds_write_b16 v2, v67 offset:640
    ds_write_b16_d16_hi v2, v67 offset:704
    v_and_b32 v2, 15, v1
    v_lshlrev_b32 v4, 6, v2
    v_lshl_add_u32 v4, v7, 3, v4
    v_add_u32 v4, s9, v4
    v_lshl_add_u32 v2, v7, 4, v2
    v_lshlrev_b32 v2, 4, v2
    s_lshl_b32 s12, s13, 10
    s_waitcnt lgkmcnt(0)
    ds_read_b64 v[72:73], v4 offset:0
    ds_read_b64 v[74:75], v4 offset:16
    ds_read_b64 v[76:77], v4 offset:32
    ds_read_b64 v[78:79], v4 offset:48
    s_waitcnt lgkmcnt(0)
    s_mov_b32 exec_lo, 0xffff
    s_mov_b32 exec_hi, 0xffff
    buffer_store_dwordx4 v[72:75], v2, s[64:67], s12 offen sc1
    buffer_store_dwordx4 v[76:79], v2, s[64:67], s12 offen offset:512 sc1
    s_mov_b64 exec, -1
KV_e_5:
    s_lshl_b32 s12, s4, 2
    s_add_u32 s12, s12, 196608
    s_waitcnt vmcnt(0)
    s_barrier
    s_cmp_lg_u32 s3, 0
    s_cbranch_scc1 SIG_6
    v_mul_u32_u24 v2, 256, v1
    v_mov_b32 v3, s74
    s_mov_b32 exec_lo, 0xffff
    s_mov_b32 exec_hi, 0x0
    buffer_store_dword v3, v2, s[52:55], s12 offen sc0 sc1
    s_mov_b64 exec, -1
SIG_6:
    s_branch K_flush
K_notkv:
    s_cmp_ge_u32 s2, 512
    s_cbranch_scc1 K_fin
    s_cmp_ge_u32 s2, 288
    s_cbranch_scc1 K_gu
    s_setprio 3
    s_sub_u32 s100, s2, 32
    s_and_b32 s4, s100, 7
    s_lshl_b32 s4, s4, 2
    s_lshr_b32 s5, s100, 3
    s_and_b32 s6, s5, 3
    s_add_u32 s4, s4, s6
    s_lshr_b32 s5, s5, 2
    s_mov_b32 s40, s16
    s_and_b32 s41, s17, 0xffff
    s_mov_b32 s42, 2097152
    s_mov_b32 s43, 0x00020000
    s_mov_b32 s44, s18
    s_and_b32 s45, s19, 0xffff
    s_mov_b32 s46, 524288
    s_mov_b32 s47, 0x00020000
    s_and_b32 s6, s3, 1
    s_lshr_b32 s7, s3, 1
    v_lshrrev_b32 v3, 3, v1
    v_lshlrev_b32 v3, 10, v3
    v_and_b32 v4, 7, v1
    v_lshrrev_b32 v5, 4, v1
    v_xor_b32 v6, v4, v5
    v_lshl_add_u32 v8, v6, 4, v3
    v_xor_b32 v9, 64, v8
    v_bfe_u32 v6, v1, 2, 1
    v_and_b32 v7, 1, v5
    v_xor_b32 v6, v6, v7
    v_lshl_add_u32 v10, v6, 6, v3
    v_and_b32 v6, 3, v1
    v_lshl_add_u32 v10, v6, 4, v10
    s_lshl_b32 s8, s4, 6
    s_lshl_b32 s9, s3, 4
    s_add_u32 s8, s8, s9
    s_lshl_b32 s8, s8, 10
    s_lshl_b32 s9, s9, 10
    s_lshl_b32 s10, s5, 7
    s_add_u32 s9, s9, s10
    s_lshl_b32 s10, s3, 11
    s_and_b32 s69, s4, 3
    s_lshl_b32 s69, s69, 1
    s_mov_b32 s68, s69
    s_lshl_b32 s12, s69, 7
    s_add_u32 s12, s12, s8
    s_lshl_b32 s13, s69, 16
    s_add_u32 s13, s13, s9
    s_add_u32 s69, s69, 1
    s_and_b32 s69, s69, 7
    s_add_u32 m0, s10, 0
    s_add_u32 s11, s12, 0
    buffer_load_dwordx4 v8, s[40:43], s11 offen lds
    s_add_u32 m0, s10, 1024
    s_add_u32 s11, s12, 8192
    buffer_load_dwordx4 v9, s[40:43], s11 offen lds
    s_add_u32 m0, s10, 8192
    s_add_u32 s11, s13, 0
    buffer_load_dwordx4 v10, s[44:47], s11 offen lds
    s_add_u32 m0, s10, 9216
    s_add_u32 s11, s13, 8192
    buffer_load_dwordx4 v10, s[44:47], s11 offen lds
    s_branch A_nt_7
    s_mov_b32 s48, s20
    s_and_b32 s49, s21, 0xffff
    s_mov_b32 s50, 16384
    s_mov_b32 s51, 0x00020000
    s_mov_b32 s52, s22
    s_and_b32 s53, s23, 0xffff
    s_mov_b32 s54, 16384
    s_mov_b32 s55, 0x00020000
    v_lshlrev_b32 v3, 4, v1
    v_xor_b32 v5, 128, v3
    s_lshl_b32 s11, s3, 12
    s_add_u32 m0, s11, 49152
    s_add_u32 s12, s11, 0
    buffer_load_dwordx4 v3, s[48:51], s12 offen lds
    s_add_u32 m0, s11, 65536
    buffer_load_dwordx4 v5, s[52:55], s12 offen lds
    s_add_u32 m0, s11, 50176
    s_add_u32 s12, s11, 1024
    buffer_load_dwordx4 v3, s[48:51], s12 offen lds
    s_add_u32 m0, s11, 66560
    buffer_load_dwordx4 v5, s[52:55], s12 offen lds
    s_add_u32 m0, s11, 51200
    s_add_u32 s12, s11, 2048
    buffer_load_dwordx4 v3, s[48:51], s12 offen lds
    s_add_u32 m0, s11, 67584
    buffer_load_dwordx4 v5, s[52:55], s12 offen lds
    s_add_u32 m0, s11, 52224
    s_add_u32 s12, s11, 3072
    buffer_load_dwordx4 v3, s[48:51], s12 offen lds
    s_add_u32 m0, s11, 68608
    buffer_load_dwordx4 v5, s[52:55], s12 offen lds
A_nt_7:
    s_lshl_b32 s12, s69, 7
    s_add_u32 s12, s12, s8
    s_lshl_b32 s13, s69, 16
    s_add_u32 s13, s13, s9
    s_add_u32 s69, s69, 1
    s_and_b32 s69, s69, 7
    s_add_u32 m0, s10, 16384
    s_add_u32 s11, s12, 0
    buffer_load_dwordx4 v8, s[40:43], s11 offen lds
    s_add_u32 m0, s10, 17408
    s_add_u32 s11, s12, 8192
    buffer_load_dwordx4 v9, s[40:43], s11 offen lds
    s_add_u32 m0, s10, 24576
    s_add_u32 s11, s13, 0
    buffer_load_dwordx4 v10, s[44:47], s11 offen lds
    s_add_u32 m0, s10, 25600
    s_add_u32 s11, s13, 8192
    buffer_load_dwordx4 v10, s[44:47], s11 offen lds
    s_lshl_b32 s12, s69, 7
    s_add_u32 s12, s12, s8
    s_lshl_b32 s13, s69, 16
    s_add_u32 s13, s13, s9
    s_add_u32 s69, s69, 1
    s_and_b32 s69, s69, 7
    s_add_u32 m0, s10, 32768
    s_add_u32 s11, s12, 0
    buffer_load_dwordx4 v8, s[40:43], s11 offen lds
    s_add_u32 m0, s10, 33792
    s_add_u32 s11, s12, 8192
    buffer_load_dwordx4 v9, s[40:43], s11 offen lds
    s_add_u32 m0, s10, 40960
    s_add_u32 s11, s13, 0
    buffer_load_dwordx4 v10, s[44:47], s11 offen lds
    s_add_u32 m0, s10, 41984
    s_add_u32 s11, s13, 8192
    buffer_load_dwordx4 v10, s[44:47], s11 offen lds
    s_lshl_b32 s12, s69, 7
    s_add_u32 s12, s12, s8
    s_lshl_b32 s13, s69, 16
    s_add_u32 s13, s13, s9
    s_add_u32 s69, s69, 1
    s_and_b32 s69, s69, 7
    s_add_u32 m0, s10, 49152
    s_add_u32 s11, s12, 0
    buffer_load_dwordx4 v8, s[40:43], s11 offen lds
    s_add_u32 m0, s10, 50176
    s_add_u32 s11, s12, 8192
    buffer_load_dwordx4 v9, s[40:43], s11 offen lds
    s_add_u32 m0, s10, 57344
    s_add_u32 s11, s13, 0
    buffer_load_dwordx4 v10, s[44:47], s11 offen lds
    s_add_u32 m0, s10, 58368
    s_add_u32 s11, s13, 8192
    buffer_load_dwordx4 v10, s[44:47], s11 offen lds
    v_lshrrev_b32 v2, 3, v1
    v_lshlrev_b32 v2, 10, v2
    v_and_b32 v3, 7, v1
    v_lshl_add_u32 v2, v3, 7, v2
    s_lshl_b32 s11, s4, 6
    s_lshl_b32 s12, s5, 3
    s_add_u32 s11, s11, s12
    s_lshl_b32 s11, s11, 10
    v_lshlrev_b32 v3, 10, v1
    s_and_b32 s12, s4, 3
    s_lshl_b32 s12, s12, 7
    s_and_b32 s13, s3, 1
    s_lshl_b32 s13, s13, 6
    s_add_u32 s12, s12, s13
    s_lshl_b32 s12, s12, 10
    s_lshl_b32 s13, s5, 7
    s_add_u32 s12, s12, s13
    s_cmp_ge_u32 s3, 2
    s_cbranch_scc1 A_t1_8
    buffer_load_dword v190, v3, s[44:47], s12 offen
    s_branch A_t2_9
A_t1_8:
    buffer_load_dword v190, v2, s[40:43], s11 offen
A_t2_9:
    s_mov_b32 s52, s38
    s_and_b32 s53, s39, 0xffff
    s_mov_b32 s54, 524288
    s_mov_b32 s55, 0x00020000
    s_add_u32 s56, s38, 8388608
    s_addc_u32 s57, s39, 0
    s_and_b32 s57, s57, 0xffff
    s_mov_b32 s58, 2097152
    s_mov_b32 s59, 0x00020000
    s_mov_b32 s60, s38
    s_and_b32 s61, s39, 0xffff
    s_mov_b32 s62, 65536
    s_mov_b32 s63, 0x00020000
    s_add_u32 s64, s38, 65536
    s_addc_u32 s65, s39, 0
    s_and_b32 s65, s65, 0xffff
    s_mov_b32 s66, 65536
    s_mov_b32 s67, 0x00020000
    v_and_b32 v6, 31, v1
    v_lshrrev_b32 v7, 5, v1
    v_bfe_u32 v11, v1, 1, 3
    v_xor_b32 v11, v11, v7
    v_lshlrev_b32 v11, 4, v11
    v_lshl_add_u32 v11, v6, 7, v11
    s_lshl_b32 s11, s7, 12
    v_add_u32 v12, s11, v11
    s_lshl_b32 s11, s6, 5
    v_xor_b32 v12, s11, v12
    v_xor_b32 v13, 32, v12
    v_xor_b32 v14, 64, v12
    v_xor_b32 v15, 96, v12
    v_bfe_u32 v11, v1, 2, 2
    v_lshl_add_u32 v2, v7, 3, v11
    v_lshlrev_b32 v2, 7, v2
    v_lshrrev_b32 v11, 1, v11
    v_xor_b32 v11, s6, v11
    v_lshl_add_u32 v2, v11, 6, v2
    v_bfe_u32 v11, v1, 4, 1
    v_lshl_add_u32 v2, v11, 5, v2
    v_and_b32 v11, 3, v1
    v_lshl_add_u32 v2, v11, 3, v2
    s_lshl_b32 s11, s6, 11
    v_add_u32 v4, s11, v2
    v_subrev_u32 v5, s11, v2
    v_bfe_u32 v3, v1, 4, 1
    v_lshlrev_b32 v140, 14, v3
    v_bfe_u32 v11, v1, 2, 2
    v_lshl_add_u32 v11, v7, 3, v11
    v_lshl_add_u32 v140, v11, 5, v140
    v_and_b32 v11, 3, v1
    v_lshl_add_u32 v140, v11, 3, v140
    s_lshl_b32 s11, s6, 9
    s_add_u32 s11, s11, 49152
    v_add_u32 v140, s11, v140
    v_lshlrev_b32 v3, 7, v3
    v_xor_b32 v11, 128, v3
    v_add_u32 v141, v140, v11
    v_add_u32 v140, v140, v3
    v_xor_b32 v160, 4096, v14
    v_mov_b32 v16, 0
    v_mov_b32 v17, 0
    v_mov_b32 v18, 0
    v_mov_b32 v19, 0
    v_mov_b32 v20, 0
    v_mov_b32 v21, 0
    v_mov_b32 v22, 0
    v_mov_b32 v23, 0
    v_mov_b32 v24, 0
    v_mov_b32 v25, 0
    v_mov_b32 v26, 0
    v_mov_b32 v27, 0
    v_mov_b32 v28, 0
    v_mov_b32 v29, 0
    v_mov_b32 v30, 0
    v_mov_b32 v31, 0
    v_mov_b32 v32, 0
    v_mov_b32 v33, 0
    v_mov_b32 v34, 0
    v_mov_b32 v35, 0
    v_mov_b32 v36, 0
    v_mov_b32 v37, 0
    v_mov_b32 v38, 0
    v_mov_b32 v39, 0
    v_mov_b32 v40, 0
    v_mov_b32 v41, 0
    v_mov_b32 v42, 0
    v_mov_b32 v43, 0
    v_mov_b32 v44, 0
    v_mov_b32 v45, 0
    v_mov_b32 v46, 0
    v_mov_b32 v47, 0
    v_mov_b32 v48, 0
    v_mov_b32 v49, 0
    v_mov_b32 v50, 0
    v_mov_b32 v51, 0
    v_mov_b32 v52, 0
    v_mov_b32 v53, 0
    v_mov_b32 v54, 0
    v_mov_b32 v55, 0
    v_mov_b32 v56, 0
    v_mov_b32 v57, 0
    v_mov_b32 v58, 0
    v_mov_b32 v59, 0
    v_mov_b32 v60, 0
    v_mov_b32 v61, 0
    v_mov_b32 v62, 0
    v_mov_b32 v63, 0
    v_mov_b32 v128, 0x3f803f80
    v_mov_b32 v129, 0x3f803f80
    v_mov_b32 v130, 0x3f803f80
    v_mov_b32 v131, 0x3f803f80
    v_mov_b32 v132, 0
    v_mov_b32 v133, 0
    v_mov_b32 v134, 0
    v_mov_b32 v135, 0
Q_none_11:
    s_waitcnt vmcnt(13)
    s_barrier
    ds_read_b128 v[64:67], v12 offset:0
    ds_read_b64_tr_b16 v[68:69], v4 offset:8192
    ds_read_b64_tr_b16 v[70:71], v4 offset:8704
    ds_read_b128 v[72:75], v13 offset:0
    ds_read_b64_tr_b16 v[76:77], v5 offset:10240
    ds_read_b64_tr_b16 v[78:79], v5 offset:10752
    ds_read_b128 v[80:83], v14 offset:0
    ds_read_b64_tr_b16 v[84:85], v4 offset:12288
    ds_read_b64_tr_b16 v[86:87], v4 offset:12800
    ds_read_b128 v[88:91], v15 offset:0
    ds_read_b64_tr_b16 v[92:93], v5 offset:14336
    ds_read_b64_tr_b16 v[94:95], v5 offset:14848
    s_waitcnt vmcnt(9) lgkmcnt(0)
    s_barrier
    v_mfma_f32_32x32x16_bf16 v[16:31], v[68:71], v[64:67], v[16:31]
    ds_read_b128 v[96:99], v12 offset:16384
    ds_read_b64_tr_b16 v[100:101], v4 offset:24576
    ds_read_b64_tr_b16 v[102:103], v4 offset:25088
    s_lshl_b32 s12, s69, 7
    s_add_u32 s12, s12, s8
    s_lshl_b32 s13, s69, 16
    v_mfma_f32_32x32x16_bf16 v[48:63], v[68:71], v[128:131], v[48:63]
    s_add_u32 s13, s13, s9
    s_add_u32 s69, s69, 1
    s_and_b32 s69, s69, 7
    s_add_u32 m0, s10, 0
    s_add_u32 s11, s12, 0
    buffer_load_dwordx4 v8, s[40:43], s11 offen lds
    v_mfma_f32_32x32x16_bf16 v[16:31], v[76:79], v[72:75], v[16:31]
    ds_read_b128 v[104:107], v13 offset:16384
    ds_read_b64_tr_b16 v[108:109], v5 offset:26624
    ds_read_b64_tr_b16 v[110:111], v5 offset:27136
    v_mfma_f32_32x32x16_bf16 v[48:63], v[76:79], v[128:131], v[48:63]
    s_add_u32 m0, s10, 1024
    s_add_u32 s11, s12, 8192
    buffer_load_dwordx4 v9, s[40:43], s11 offen lds
    v_mfma_f32_32x32x16_bf16 v[16:31], v[84:87], v[80:83], v[16:31]
    ds_read_b128 v[112:115], v14 offset:16384
    ds_read_b64_tr_b16 v[116:117], v4 offset:28672
    ds_read_b64_tr_b16 v[118:119], v4 offset:29184
    v_mfma_f32_32x32x16_bf16 v[48:63], v[84:87], v[128:131], v[48:63]
    s_add_u32 m0, s10, 8192
    s_add_u32 s11, s13, 0
    buffer_load_dwordx4 v10, s[44:47], s11 offen lds
    v_mfma_f32_32x32x16_bf16 v[16:31], v[92:95], v[88:91], v[16:31]
    ds_read_b128 v[120:123], v15 offset:16384
    ds_read_b64_tr_b16 v[124:125], v5 offset:30720
    ds_read_b64_tr_b16 v[126:127], v5 offset:31232
    v_mfma_f32_32x32x16_bf16 v[48:63], v[92:95], v[128:131], v[48:63]
    s_add_u32 m0, s10, 9216
    s_add_u32 s11, s13, 8192
    buffer_load_dwordx4 v10, s[44:47], s11 offen lds
    s_waitcnt vmcnt(9) lgkmcnt(0)
    s_barrier
    v_mfma_f32_32x32x16_bf16 v[16:31], v[100:103], v[96:99], v[16:31]
    ds_read_b128 v[64:67], v12 offset:32768
    ds_read_b64_tr_b16 v[68:69], v4 offset:40960
    ds_read_b64_tr_b16 v[70:71], v4 offset:41472
    s_lshl_b32 s12, s69, 7
    s_add_u32 s12, s12, s8
    s_lshl_b32 s13, s69, 16
    v_mfma_f32_32x32x16_bf16 v[48:63], v[100:103], v[128:131], v[48:63]
    s_add_u32 s13, s13, s9
    s_add_u32 s69, s69, 1
    s_and_b32 s69, s69, 7
    s_add_u32 m0, s10, 16384
    s_add_u32 s11, s12, 0
    buffer_load_dwordx4 v8, s[40:43], s11 offen lds
    v_mfma_f32_32x32x16_bf16 v[16:31], v[108:111], v[104:107], v[16:31]
    ds_read_b128 v[72:75], v13 offset:32768
    ds_read_b64_tr_b16 v[76:77], v5 offset:43008
    ds_read_b64_tr_b16 v[78:79], v5 offset:43520
    v_mfma_f32_32x32x16_bf16 v[48:63], v[108:111], v[128:131], v[48:63]
    s_add_u32 m0, s10, 17408
    s_add_u32 s11, s12, 8192
    buffer_load_dwordx4 v9, s[40:43], s11 offen lds
    v_mfma_f32_32x32x16_bf16 v[16:31], v[116:119], v[112:115], v[16:31]
    ds_read_b128 v[80:83], v14 offset:32768
    ds_read_b64_tr_b16 v[84:85], v4 offset:45056
    ds_read_b64_tr_b16 v[86:87], v4 offset:45568
    v_mfma_f32_32x32x16_bf16 v[48:63], v[116:119], v[128:131], v[48:63]
    s_add_u32 m0, s10, 24576
    s_add_u32 s11, s13, 0
    buffer_load_dwordx4 v10, s[44:47], s11 offen lds
    v_mfma_f32_32x32x16_bf16 v[16:31], v[124:127], v[120:123], v[16:31]
    ds_read_b128 v[88:91], v15 offset:32768
    ds_read_b64_tr_b16 v[92:93], v5 offset:47104
    ds_read_b64_tr_b16 v[94:95], v5 offset:47616
    v_mfma_f32_32x32x16_bf16 v[48:63], v[124:127], v[128:131], v[48:63]
    s_add_u32 m0, s10, 25600
    s_add_u32 s11, s13, 8192
    buffer_load_dwordx4 v10, s[44:47], s11 offen lds
    s_waitcnt vmcnt(9) lgkmcnt(0)
    s_barrier
    v_mfma_f32_32x32x16_bf16 v[16:31], v[68:71], v[64:67], v[16:31]
    ds_read_b128 v[96:99], v12 offset:49152
    ds_read_b64_tr_b16 v[100:101], v4 offset:57344
    ds_read_b64_tr_b16 v[102:103], v4 offset:57856
    s_lshl_b32 s12, s69, 7
    s_add_u32 s12, s12, s8
    s_lshl_b32 s13, s69, 16
    v_mfma_f32_32x32x16_bf16 v[48:63], v[68:71], v[128:131], v[48:63]
    s_add_u32 s13, s13, s9
    s_add_u32 s69, s69, 1
    s_and_b32 s69, s69, 7
    s_add_u32 m0, s10, 32768
    s_add_u32 s11, s12, 0
    buffer_load_dwordx4 v8, s[40:43], s11 offen lds
    v_mfma_f32_32x32x16_bf16 v[16:31], v[76:79], v[72:75], v[16:31]
    ds_read_b128 v[104:107], v13 offset:49152
    ds_read_b64_tr_b16 v[108:109], v5 offset:59392
    ds_read_b64_tr_b16 v[110:111], v5 offset:59904
    v_mfma_f32_32x32x16_bf16 v[48:63], v[76:79], v[128:131], v[48:63]
    s_add_u32 m0, s10, 33792
    s_add_u32 s11, s12, 8192
    buffer_load_dwordx4 v9, s[40:43], s11 offen lds
    v_mfma_f32_32x32x16_bf16 v[16:31], v[84:87], v[80:83], v[16:31]
    ds_read_b128 v[112:115], v14 offset:49152
    ds_read_b64_tr_b16 v[116:117], v4 offset:61440
    ds_read_b64_tr_b16 v[118:119], v4 offset:61952
    v_mfma_f32_32x32x16_bf16 v[48:63], v[84:87], v[128:131], v[48:63]
    s_add_u32 m0, s10, 40960
    s_add_u32 s11, s13, 0
    buffer_load_dwordx4 v10, s[44:47], s11 offen lds
    v_mfma_f32_32x32x16_bf16 v[16:31], v[92:95], v[88:91], v[16:31]
    ds_read_b128 v[120:123], v15 offset:49152
    ds_read_b64_tr_b16 v[124:125], v5 offset:63488
    ds_read_b64_tr_b16 v[126:127], v5 offset:64000
    v_mfma_f32_32x32x16_bf16 v[48:63], v[92:95], v[128:131], v[48:63]
    s_add_u32 m0, s10, 41984
    s_add_u32 s11, s13, 8192
    buffer_load_dwordx4 v10, s[44:47], s11 offen lds
    s_waitcnt vmcnt(8) lgkmcnt(0)
    s_barrier
    v_mfma_f32_32x32x16_bf16 v[16:31], v[100:103], v[96:99], v[16:31]
    ds_read_b128 v[64:67], v12 offset:0
    ds_read_b64_tr_b16 v[68:69], v4 offset:8192
    ds_read_b64_tr_b16 v[70:71], v4 offset:8704
    s_lshl_b32 s12, s69, 7
    s_add_u32 s12, s12, s8
    s_lshl_b32 s13, s69, 16
    v_mfma_f32_32x32x16_bf16 v[48:63], v[100:103], v[128:131], v[48:63]
    s_add_u32 s13, s13, s9
    s_add_u32 s69, s69, 1
    s_and_b32 s69, s69, 7
    s_add_u32 m0, s10, 49152
    s_add_u32 s11, s12, 0
    buffer_load_dwordx4 v8, s[40:43], s11 offen lds
    v_mfma_f32_32x32x16_bf16 v[16:31], v[108:111], v[104:107], v[16:31]
    ds_read_b128 v[72:75], v13 offset:0
    ds_read_b64_tr_b16 v[76:77], v5 offset:10240
    ds_read_b64_tr_b16 v[78:79], v5 offset:10752
    v_mfma_f32_32x32x16_bf16 v[48:63], v[108:111], v[128:131], v[48:63]
    s_add_u32 m0, s10, 50176
    s_add_u32 s11, s12, 8192
    buffer_load_dwordx4 v9, s[40:43], s11 offen lds
    v_mfma_f32_32x32x16_bf16 v[16:31], v[116:119], v[112:115], v[16:31]
    ds_read_b128 v[80:83], v14 offset:0
    ds_read_b64_tr_b16 v[84:85], v4 offset:12288
    ds_read_b64_tr_b16 v[86:87], v4 offset:12800
    v_mfma_f32_32x32x16_bf16 v[48:63], v[116:119], v[128:131], v[48:63]
    s_add_u32 m0, s10, 57344
    s_add_u32 s11, s13, 0
    buffer_load_dwordx4 v10, s[44:47], s11 offen lds
    v_mfma_f32_32x32x16_bf16 v[16:31], v[124:127], v[120:123], v[16:31]
    ds_read_b128 v[88:91], v15 offset:0
    ds_read_b64_tr_b16 v[92:93], v5 offset:14336
    ds_read_b64_tr_b16 v[94:95], v5 offset:14848
    v_mfma_f32_32x32x16_bf16 v[48:63], v[124:127], v[128:131], v[48:63]
    s_add_u32 m0, s10, 58368
    s_add_u32 s11, s13, 8192
    buffer_load_dwordx4 v10, s[44:47], s11 offen lds
    s_waitcnt vmcnt(8) lgkmcnt(0)
    s_barrier
    v_mfma_f32_32x32x16_bf16 v[16:31], v[68:71], v[64:67], v[16:31]
    ds_read_b128 v[96:99], v12 offset:16384
    v_mfma_f32_32x32x16_bf16 v[48:63], v[68:71], v[128:131], v[48:63]
    ds_read_b64_tr_b16 v[100:101], v4 offset:24576
    ds_read_b64_tr_b16 v[102:103], v4 offset:25088
    v_mfma_f32_32x32x16_bf16 v[16:31], v[76:79], v[72:75], v[16:31]
    ds_read_b128 v[104:107], v13 offset:16384
    v_mfma_f32_32x32x16_bf16 v[48:63], v[76:79], v[128:131], v[48:63]
    ds_read_b64_tr_b16 v[108:109], v5 offset:26624
    ds_read_b64_tr_b16 v[110:111], v5 offset:27136
    v_mfma_f32_32x32x16_bf16 v[16:31], v[84:87], v[80:83], v[16:31]
    ds_read_b128 v[112:115], v14 offset:16384
    v_mfma_f32_32x32x16_bf16 v[48:63], v[84:87], v[128:131], v[48:63]
    ds_read_b64_tr_b16 v[116:117], v4 offset:28672
    ds_read_b64_tr_b16 v[118:119], v4 offset:29184
    v_mfma_f32_32x32x16_bf16 v[16:31], v[92:95], v[88:91], v[16:31]
    ds_read_b128 v[120:123], v15 offset:16384
    v_mfma_f32_32x32x16_bf16 v[48:63], v[92:95], v[128:131], v[48:63]
    ds_read_b64_tr_b16 v[124:125], v5 offset:30720
    ds_read_b64_tr_b16 v[126:127], v5 offset:31232
    s_waitcnt vmcnt(4) lgkmcnt(0)
    s_barrier
    v_mfma_f32_32x32x16_bf16 v[16:31], v[100:103], v[96:99], v[16:31]
    ds_read_b128 v[64:67], v12 offset:32768
    v_mfma_f32_32x32x16_bf16 v[48:63], v[100:103], v[128:131], v[48:63]
    ds_read_b64_tr_b16 v[68:69], v4 offset:40960
    ds_read_b64_tr_b16 v[70:71], v4 offset:41472
    v_mfma_f32_32x32x16_bf16 v[16:31], v[108:111], v[104:107], v[16:31]
    ds_read_b128 v[72:75], v13 offset:32768
    v_mfma_f32_32x32x16_bf16 v[48:63], v[108:111], v[128:131], v[48:63]
    ds_read_b64_tr_b16 v[76:77], v5 offset:43008
    ds_read_b64_tr_b16 v[78:79], v5 offset:43520
    v_mfma_f32_32x32x16_bf16 v[16:31], v[116:119], v[112:115], v[16:31]
    ds_read_b128 v[80:83], v14 offset:32768
    v_mfma_f32_32x32x16_bf16 v[48:63], v[116:119], v[128:131], v[48:63]
    ds_read_b64_tr_b16 v[84:85], v4 offset:45056
    ds_read_b64_tr_b16 v[86:87], v4 offset:45568
    v_mfma_f32_32x32x16_bf16 v[16:31], v[124:127], v[120:123], v[16:31]
    ds_read_b128 v[88:91], v15 offset:32768
    v_mfma_f32_32x32x16_bf16 v[48:63], v[124:127], v[128:131], v[48:63]
    ds_read_b64_tr_b16 v[92:93], v5 offset:47104
    ds_read_b64_tr_b16 v[94:95], v5 offset:47616
    s_waitcnt vmcnt(0) lgkmcnt(0)
    s_barrier
    v_mfma_f32_32x32x16_bf16 v[16:31], v[68:71], v[64:67], v[16:31]
    ds_read_b128 v[96:99], v12 offset:49152
    v_mfma_f32_32x32x16_bf16 v[48:63], v[68:71], v[128:131], v[48:63]
    ds_read_b64_tr_b16 v[100:101], v4 offset:57344
    ds_read_b64_tr_b16 v[102:103], v4 offset:57856
    v_mfma_f32_32x32x16_bf16 v[16:31], v[76:79], v[72:75], v[16:31]
    ds_read_b128 v[104:107], v13 offset:49152
    v_mfma_f32_32x32x16_bf16 v[48:63], v[76:79], v[128:131], v[48:63]
    ds_read_b64_tr_b16 v[108:109], v5 offset:59392
    ds_read_b64_tr_b16 v[110:111], v5 offset:59904
    v_mfma_f32_32x32x16_bf16 v[16:31], v[84:87], v[80:83], v[16:31]
    ds_read_b128 v[112:115], v14 offset:49152
    v_mfma_f32_32x32x16_bf16 v[48:63], v[84:87], v[128:131], v[48:63]
    ds_read_b64_tr_b16 v[116:117], v4 offset:61440
    ds_read_b64_tr_b16 v[118:119], v4 offset:61952
    v_mfma_f32_32x32x16_bf16 v[16:31], v[92:95], v[88:91], v[16:31]
    ds_read_b128 v[120:123], v15 offset:49152
    v_mfma_f32_32x32x16_bf16 v[48:63], v[92:95], v[128:131], v[48:63]
    ds_read_b64_tr_b16 v[124:125], v5 offset:63488
    ds_read_b64_tr_b16 v[126:127], v5 offset:64000
    s_waitcnt lgkmcnt(0)
    v_mfma_f32_32x32x16_bf16 v[16:31], v[100:103], v[96:99], v[16:31]
    v_mfma_f32_32x32x16_bf16 v[48:63], v[100:103], v[128:131], v[48:63]
    v_mfma_f32_32x32x16_bf16 v[16:31], v[108:111], v[104:107], v[16:31]
    v_mfma_f32_32x32x16_bf16 v[48:63], v[108:111], v[128:131], v[48:63]
    v_mfma_f32_32x32x16_bf16 v[16:31], v[116:119], v[112:115], v[16:31]
    v_mfma_f32_32x32x16_bf16 v[48:63], v[116:119], v[128:131], v[48:63]
    v_mfma_f32_32x32x16_bf16 v[16:31], v[124:127], v[120:123], v[16:31]
    v_mfma_f32_32x32x16_bf16 v[48:63], v[124:127], v[128:131], v[48:63]
Q_join_10:
    s_setprio 0
    v_add_f32 v132, v132, v133
    v_add_f32 v134, v134, v135
    v_lshlrev_b32 v2, 2, v1
    s_lshl_b32 s11, s3, 9
    s_add_u32 s11, s11, 73728
    v_add_u32 v2, s11, v2
    ds_write_b32 v2, v132
    ds_write_b32 v2, v134 offset:256
    s_cmp_lg_u32 s3, 3
    s_cbranch_scc1 A_c_14
    v_lshrrev_b32 v5, 3, v1
    v_lshlrev_b32 v5, 9, v5
    v_and_b32 v8, 7, v1
    v_lshl_add_u32 v5, v8, 2, v5
    v_add_u32 v5, 65536, v5
    v_cmp_gt_u32 vcc, 4, v8
    v_mov_b32 v9, 0x3f803f80
    s_nop 0
    v_cndmask_b32 v9, 0, v9, vcc
    ds_write_b32 v5, v9
A_c_14:
    v_mov_b32 v184, 0xdddddddd
    v_mov_b32 v112, 0
    v_mov_b32 v128, 0
    v_mov_b32 v96, 0
    v_mov_b32 v113, 0
    v_mov_b32 v129, 0
    v_mov_b32 v97, 0
    v_mov_b32 v114, 0
    v_mov_b32 v130, 0
    v_mov_b32 v98, 0
    v_mov_b32 v115, 0
    v_mov_b32 v131, 0
    v_mov_b32 v99, 0
    v_mov_b32 v116, 0
    v_mov_b32 v132, 0
    v_mov_b32 v100, 0
    v_mov_b32 v117, 0
    v_mov_b32 v133, 0
    v_mov_b32 v101, 0
    v_mov_b32 v118, 0
    v_mov_b32 v134, 0
    v_mov_b32 v102, 0
    v_mov_b32 v119, 0
    v_mov_b32 v135, 0
    v_mov_b32 v103, 0
    v_mov_b32 v120, 0
    v_mov_b32 v136, 0
    v_mov_b32 v104, 0
    v_mov_b32 v121, 0
    v_mov_b32 v137, 0
    v_mov_b32 v105, 0
    v_mov_b32 v122, 0
    v_mov_b32 v138, 0
    v_mov_b32 v106, 0
    v_mov_b32 v123, 0
    v_mov_b32 v139, 0
    v_mov_b32 v107, 0
    v_mov_b32 v124, 0
    v_mov_b32 v140, 0
    v_mov_b32 v108, 0
    v_mov_b32 v125, 0
    v_mov_b32 v141, 0
    v_mov_b32 v109, 0
    v_mov_b32 v126, 0
    v_mov_b32 v142, 0
    v_mov_b32 v110, 0
    v_mov_b32 v127, 0
    v_mov_b32 v143, 0
    v_mov_b32 v111, 0
    v_mov_b32 v164, 0
    v_mov_b32 v165, 0
    v_mov_b32 v166, 0
    v_mov_b32 v167, 0
    v_lshlrev_b32 v3, 4, v1
    s_lshl_b32 s12, s3, 10
    v_add_u32 v8, s12, v3
    v_and_b32 v5, 15, v1
    v_lshl_add_u32 v5, v7, 4, v5
    v_lshlrev_b32 v5, 4, v5
    v_add_u32 v5, 16384, v5
    v_and_b32 v11, 27, v6
    v_cmp_eq_u32 vcc, 16, v11
    v_mov_b32 v9, 65552
    v_mov_b32 v10, 65536
    v_cndmask_b32 v9, v9, v10, vcc
    v_cmp_gt_u32 vcc, 16, v6
    s_nop 1
    v_cndmask_b32 v5, v9, v5, vcc
    v_cndmask_b32 v9, 0, 1, vcc
    v_lshlrev_b32 v11, 2, v1
    s_cmp_lg_u32 s3, 0
    s_cbranch_scc1 WGW_15
    v_mov_b32 v190, v3
    v_mov_b32 v2, 0
    global_load_dword v3, v2, s[36:37]
    s_waitcnt vmcnt(0)
    v_readfirstlane_b32 s74, v3
    s_cmp_lg_u32 s74, 0
    s_cbranch_scc1 TAGD_17
    s_mov_b32 s75, 0
TAG_16:
    s_sleep 4
    global_load_dword v3, v2, s[36:37] sc0 sc1
    s_waitcnt vmcnt(0)
    v_readfirstlane_b32 s74, v3
    s_cmp_lg_u32 s74, 0
    s_cbranch_scc1 TAGD_17
    s_add_u32 s75, s75, 1
    s_cmp_lt_u32 s75, 200000
    s_cbranch_scc1 TAG_16
TAGD_17:
    s_and_b32 s14, s2, 15
    s_lshl_b32 s14, s14, 8
    s_add_u32 s14, s14, 196608
    v_lshlrev_b32 v2, 2, v1
    s_mov_b32 s75, 0
    s_mov_b32 exec_lo, 0xffffffff
    s_mov_b32 exec_hi, 0x0
POLL_18:
    buffer_load_dword v3, v2, s[52:55], s14 offen sc0 sc1
    s_waitcnt vmcnt(0)
    v_cmp_ne_u32 vcc, s74, v3
    s_cbranch_vccz POLLD_19
    s_sleep 2
    s_add_u32 s75, s75, 1
    s_cmp_lt_u32 s75, 200000
    s_cbranch_scc1 POLL_18
POLLD_19:
    s_mov_b64 exec, -1
    v_mov_b32 v3, v190
WGW_15:
    s_barrier
    s_mov_b32 s14, 147456
    buffer_load_dword v188, v11, s[52:55], s14 offen sc1
    s_lshl_b32 s13, s4, 6
    s_lshl_b32 s14, s7, 5
    s_add_u32 s13, s13, s14
    v_add_u32 v2, s13, v6
    v_lshlrev_b32 v2, 2, v2
    s_mov_b32 s14, 131072
    buffer_load_dword v186, v2, s[52:55], s14 offen sc1
    s_mov_b32 s14, 139264
    buffer_load_dword v187, v2, s[52:55], s14 offen sc1
    s_add_u32 s13, s12, 0
    buffer_load_dwordx4 v[192:195], v3, s[60:63], s13 offen sc1
    buffer_load_dwordx4 v[196:199], v3, s[64:67], s13 offen sc1
    s_add_u32 s13, s12, 4096
    buffer_load_dwordx4 v[200:203], v3, s[60:63], s13 offen sc1
    buffer_load_dwordx4 v[204:207], v3, s[64:67], s13 offen sc1
    s_add_u32 s13, s12, 8192
    buffer_load_dwordx4 v[208:211], v3, s[60:63], s13 offen sc1
    buffer_load_dwordx4 v[212:215], v3, s[64:67], s13 offen sc1
    s_add_u32 s13, s12, 12288
    buffer_load_dwordx4 v[216:219], v3, s[60:63], s13 offen sc1
    buffer_load_dwordx4 v[220:223], v3, s[64:67], s13 offen sc1
    s_add_u32 s15, s12, 16384
    s_add_u32 s13, s15, 0
    buffer_load_dwordx4 v[224:227], v3, s[60:63], s13 offen sc1
    buffer_load_dwordx4 v[228:231], v3, s[64:67], s13 offen sc1
    s_add_u32 s13, s15, 4096
    buffer_load_dwordx4 v[232:235], v3, s[60:63], s13 offen sc1
    buffer_load_dwordx4 v[236:239], v3, s[64:67], s13 offen sc1
    s_add_u32 s13, s15, 8192
    buffer_load_dwordx4 v[240:243], v3, s[60:63], s13 offen sc1
    buffer_load_dwordx4 v[244:247], v3, s[64:67], s13 offen sc1
    s_add_u32 s13, s15, 12288
    buffer_load_dwordx4 v[248:251], v3, s[60:63], s13 offen sc1
    buffer_load_dwordx4 v[252:255], v3, s[64:67], s13 offen sc1
    s_waitcnt vmcnt(16)
    s_nop 1
    v_max_f32_dpp v188, v188, v188 quad_perm:[1,0,3,2] row_mask:0xf bank_mask:0xf
    s_nop 1
    v_max_f32_dpp v188, v188, v188 quad_perm:[2,3,0,1] row_mask:0xf bank_mask:0xf
    s_nop 1
    v_max_f32_dpp v188, v188, v188 row_half_mirror row_mask:0xf bank_mask:0xf
    s_nop 1
    v_max_f32_dpp v188, v188, v188 row_mirror row_mask:0xf bank_mask:0xf
    s_nop 1
    v_max_f32_dpp v188, v188, v188 row_bcast:15 row_mask:0xa bank_mask:0xf
    s_nop 1
    v_max_f32_dpp v188, v188, v188 row_bcast:31 row_mask:0xc bank_mask:0xf
    v_mul_f32 v186, 0.36067376022224085, v186
    v_mul_f32 v187, 0.36067376022224085, v187
    v_mul_f32 v48, v187, v48
    v_mul_f32 v49, v187, v49
    v_mul_f32 v50, v187, v50
    v_mul_f32 v51, v187, v51
    v_mul_f32 v52, v187, v52
    v_mul_f32 v53, v187, v53
    v_mul_f32 v54, v187, v54
    v_mul_f32 v55, v187, v55
    v_mul_f32 v56, v187, v56
    v_mul_f32 v57, v187, v57
    v_mul_f32 v58, v187, v58
    v_mul_f32 v59, v187, v59
    v_mul_f32 v60, v187, v60
    v_mul_f32 v61, v187, v61
    v_mul_f32 v62, v187, v62
    v_mul_f32 v63, v187, v63
    v_fma_f32 v16, v16, v186, v48
    v_fma_f32 v17, v17, v186, v49
    v_fma_f32 v18, v18, v186, v50
    v_fma_f32 v19, v19, v186, v51
    v_fma_f32 v20, v20, v186, v52
    v_fma_f32 v21, v21, v186, v53
    v_fma_f32 v22, v22, v186, v54
    v_fma_f32 v23, v23, v186, v55
    v_fma_f32 v24, v24, v186, v56
    v_fma_f32 v25, v25, v186, v57
    v_fma_f32 v26, v26, v186, v58
    v_fma_f32 v27, v27, v186, v59
    v_fma_f32 v28, v28, v186, v60
    v_fma_f32 v29, v29, v186, v61
    v_fma_f32 v30, v30, v186, v62
    v_fma_f32 v31, v31, v186, v63
    v_cvt_pk_bf16_f32 v144, v16, v17
    v_cvt_pk_bf16_f32 v145, v18, v19
    v_cvt_pk_bf16_f32 v146, v20, v21
    v_cvt_pk_bf16_f32 v147, v22, v23
    v_cvt_pk_bf16_f32 v148, v24, v25
    v_cvt_pk_bf16_f32 v149, v26, v27
    v_cvt_pk_bf16_f32 v150, v28, v29
    v_cvt_pk_bf16_f32 v151, v30, v31
    v_mul_f32 v186, v16, v16
    v_mul_f32 v187, v24, v24
    v_fmac_f32 v186, v17, v17
    v_fmac_f32 v187, v25, v25
    v_fmac_f32 v186, v18, v18
    v_fmac_f32 v187, v26, v26
    v_fmac_f32 v186, v19, v19
    v_fmac_f32 v187, v27, v27
    v_fmac_f32 v186, v20, v20
    v_fmac_f32 v187, v28, v28
    v_fmac_f32 v186, v21, v21
    v_fmac_f32 v187, v29, v29
    v_fmac_f32 v186, v22, v22
    v_fmac_f32 v187, v30, v30
    v_fmac_f32 v186, v23, v23
    v_fmac_f32 v187, v31, v31
    v_mov_b32 v189, v186
    s_nop 1
    v_permlane32_swap_b32 v186, v189
    s_nop 1
    v_add_f32 v186, v186, v189
    v_mov_b32 v190, v187
    s_nop 1
    v_permlane32_swap_b32 v187, v190
    s_nop 1
    v_add_f32 v187, v187, v190
    v_mul_f32 v186, 1.031494140625, v186
    v_mul_f32 v187, 1.031494140625, v187
    s_nop 1
    v_readlane_b32 s14, v188, 63
    s_nop 3
    v_mul_f32 v186, s14, v186
    v_mul_f32 v187, s14, v187
    v_sqrt_f32 v186, v186
    v_sqrt_f32 v187, v187
    s_nop 0
    v_max_f32 v189, v186, v187
    v_cmp_nge_f32 vcc, 48.0, v189
    s_cbranch_vccz A_fast_20
    v_mov_b32 v186, 0xff800000
    v_mov_b32 v187, 0xff800000
    s_mov_b32 s14, 0
A_mx_21:
    buffer_load_dwordx4 v[32:35], v3, s[60:63], s14 offen sc1
    s_waitcnt vmcnt(0)
    v_mfma_f32_32x32x16_bf16 v[80:95], v[32:35], v[144:147], 0
    v_mfma_f32_32x32x16_bf16 v[64:79], v[32:35], v[148:151], 0
    s_nop 15
    s_nop 7
    v_max3_f32 v186, v80, v81, v186
    v_max3_f32 v187, v64, v65, v187
    v_max3_f32 v186, v82, v83, v186
    v_max3_f32 v187, v66, v67, v187
    v_max3_f32 v186, v84, v85, v186
    v_max3_f32 v187, v68, v69, v187
    v_max3_f32 v186, v86, v87, v186
    v_max3_f32 v187, v70, v71, v187
    v_max3_f32 v186, v88, v89, v186
    v_max3_f32 v187, v72, v73, v187
    v_max3_f32 v186, v90, v91, v186
    v_max3_f32 v187, v74, v75, v187
    v_max3_f32 v186, v92, v93, v186
    v_max3_f32 v187, v76, v77, v187
    v_max3_f32 v186, v94, v95, v186
    v_max3_f32 v187, v78, v79, v187
    s_add_u32 s14, s14, 1024
    s_cmp_lt_u32 s14, 65536
    s_cbranch_scc1 A_mx_21
    v_mov_b32 v189, v186
    s_nop 1
    v_permlane32_swap_b32 v186, v189
    s_nop 1
    v_max_f32 v186, v186, v189
    v_mov_b32 v189, v187
    s_nop 1
    v_permlane32_swap_b32 v187, v189
    s_nop 1
    v_max_f32 v187, v187, v189
A_fast_20:
    v_sub_f32 v48, 0, v186
    v_sub_f32 v64, 0, v187
    v_sub_f32 v49, 0, v186
    v_sub_f32 v65, 0, v187
    v_sub_f32 v50, 0, v186
    v_sub_f32 v66, 0, v187
    v_sub_f32 v51, 0, v186
    v_sub_f32 v67, 0, v187
    v_sub_f32 v52, 0, v186
    v_sub_f32 v68, 0, v187
    v_sub_f32 v53, 0, v186
    v_sub_f32 v69, 0, v187
    v_sub_f32 v54, 0, v186
    v_sub_f32 v70, 0, v187
    v_sub_f32 v55, 0, v186
    v_sub_f32 v71, 0, v187
    v_sub_f32 v56, 0, v186
    v_sub_f32 v72, 0, v187
    v_sub_f32 v57, 0, v186
    v_sub_f32 v73, 0, v187
    v_sub_f32 v58, 0, v186
    v_sub_f32 v74, 0, v187
    v_sub_f32 v59, 0, v186
    v_sub_f32 v75, 0, v187
    v_sub_f32 v60, 0, v186
    v_sub_f32 v76, 0, v187
    v_sub_f32 v61, 0, v186
    v_sub_f32 v77, 0, v187
    v_sub_f32 v62, 0, v186
    v_sub_f32 v78, 0, v187
    v_sub_f32 v63, 0, v186
    v_sub_f32 v79, 0, v187
    s_waitcnt vmcnt(8)
    ds_write_b128 v8, v[192:195] offset:0
    ds_write_b128 v8, v[196:199] offset:16384
    ds_write_b128 v8, v[200:203] offset:4096
    ds_write_b128 v8, v[204:207] offset:20480
    ds_write_b128 v8, v[208:211] offset:8192
    ds_write_b128 v8, v[212:215] offset:24576
    ds_write_b128 v8, v[216:219] offset:12288
    ds_write_b128 v8, v[220:223] offset:28672
    s_waitcnt lgkmcnt(0)
    s_barrier
    s_setprio 2
    s_mov_b32 s71, 0
    v_mad_u32_u24 v12, v9, s71, v5
    ds_read_b128 v[32:35], v3 offset:0
    ds_read_b128 v[152:155], v12 offset:0
    ds_read_b128 v[156:159], v12 offset:512
    s_waitcnt lgkmcnt(0)
    v_mfma_f32_32x32x16_bf16 v[80:95], v[32:35], v[144:147], v[48:63]
    s_mov_b32 s71, 4096
    v_mad_u32_u24 v13, v9, s71, v5
    s_nop 7
    s_nop 7
    v_exp_f32 v80, v80
    v_exp_f32 v81, v81
    v_smfmac_f32_32x32x32_bf16 v[128:143], v[164:167], v[104:111], v184
    v_exp_f32 v82, v82
    v_exp_f32 v83, v83
    v_exp_f32 v84, v84
    ds_read_b128 v[36:39], v3 offset:1024
    ds_read_b128 v[160:163], v12 offset:1024
    ds_read_b128 v[164:167], v12 offset:1536
    v_exp_f32 v85, v85
    v_exp_f32 v86, v86
    v_mfma_f32_32x32x16_bf16 v[96:111], v[32:35], v[148:151], v[64:79]
    v_exp_f32 v87, v87
    v_exp_f32 v88, v88
    v_exp_f32 v89, v89
    v_exp_f32 v90, v90
    v_exp_f32 v91, v91
    v_smfmac_f32_32x32x32_bf16 v[112:127], v[152:155], v[80:87], v184
    v_exp_f32 v92, v92
    v_exp_f32 v93, v93
    v_exp_f32 v94, v94
    v_exp_f32 v95, v95
    v_exp_f32 v96, v96
    v_exp_f32 v97, v97
    v_smfmac_f32_32x32x32_bf16 v[112:127], v[156:159], v[88:95], v184
    v_exp_f32 v98, v98
    v_exp_f32 v99, v99
    v_exp_f32 v100, v100
    v_exp_f32 v101, v101
    s_waitcnt lgkmcnt(0)
    v_exp_f32 v102, v102
    v_mfma_f32_32x32x16_bf16 v[80:95], v[36:39], v[144:147], v[48:63]
    v_exp_f32 v103, v103
    v_exp_f32 v104, v104
    v_exp_f32 v105, v105
    v_exp_f32 v106, v106
    v_exp_f32 v107, v107
    v_smfmac_f32_32x32x32_bf16 v[128:143], v[152:155], v[96:103], v184
    v_exp_f32 v108, v108
    v_exp_f32 v109, v109
    v_exp_f32 v110, v110
    v_exp_f32 v111, v111
    v_exp_f32 v80, v80
    v_exp_f32 v81, v81
    v_smfmac_f32_32x32x32_bf16 v[128:143], v[156:159], v[104:111], v184
    v_exp_f32 v82, v82
    v_exp_f32 v83, v83
    v_exp_f32 v84, v84
    ds_read_b128 v[32:35], v3 offset:2048
    ds_read_b128 v[152:155], v12 offset:2048
    ds_read_b128 v[156:159], v12 offset:2560
    v_exp_f32 v85, v85
    v_exp_f32 v86, v86
    v_mfma_f32_32x32x16_bf16 v[96:111], v[36:39], v[148:151], v[64:79]
    v_exp_f32 v87, v87
    v_exp_f32 v88, v88
    s_waitcnt vmcnt(0)
    v_exp_f32 v89, v89
    ds_write_b128 v8, v[224:227] offset:32768
    v_exp_f32 v90, v90
    v_exp_f32 v91, v91
    v_smfmac_f32_32x32x32_bf16 v[112:127], v[160:163], v[80:87], v184
    v_exp_f32 v92, v92
    v_exp_f32 v93, v93
    v_exp_f32 v94, v94
    v_exp_f32 v95, v95
    ds_write_b128 v8, v[228:231] offset:49152
    v_exp_f32 v96, v96
    v_exp_f32 v97, v97
    v_smfmac_f32_32x32x32_bf16 v[112:127], v[164:167], v[88:95], v184
    v_exp_f32 v98, v98
    v_exp_f32 v99, v99
    v_exp_f32 v100, v100
    v_exp_f32 v101, v101
    s_waitcnt lgkmcnt(0)
    v_exp_f32 v102, v102
    v_mfma_f32_32x32x16_bf16 v[80:95], v[32:35], v[144:147], v[48:63]
    v_exp_f32 v103, v103
    v_exp_f32 v104, v104
    v_exp_f32 v105, v105
    v_exp_f32 v106, v106
    v_exp_f32 v107, v107
    v_smfmac_f32_32x32x32_bf16 v[128:143], v[160:163], v[96:103], v184
    v_exp_f32 v108, v108
    v_exp_f32 v109, v109
    v_exp_f32 v110, v110
    v_exp_f32 v111, v111
    v_exp_f32 v80, v80
    v_exp_f32 v81, v81
    v_smfmac_f32_32x32x32_bf16 v[128:143], v[164:167], v[104:111], v184
    v_exp_f32 v82, v82
    v_exp_f32 v83, v83
    v_exp_f32 v84, v84
    ds_read_b128 v[36:39], v3 offset:3072
    ds_read_b128 v[160:163], v12 offset:3072
    ds_read_b128 v[164:167], v12 offset:3584
    v_exp_f32 v85, v85
    v_exp_f32 v86, v86
    v_mfma_f32_32x32x16_bf16 v[96:111], v[32:35], v[148:151], v[64:79]
    v_exp_f32 v87, v87
    v_exp_f32 v88, v88
    v_exp_f32 v89, v89
    ds_write_b128 v8, v[232:235] offset:36864
    v_exp_f32 v90, v90
    v_exp_f32 v91, v91
    v_smfmac_f32_32x32x32_bf16 v[112:127], v[152:155], v[80:87], v184
    v_exp_f32 v92, v92
    v_exp_f32 v93, v93
    v_exp_f32 v94, v94
    v_exp_f32 v95, v95
    ds_write_b128 v8, v[236:239] offset:53248
    v_exp_f32 v96, v96
    v_exp_f32 v97, v97
    v_smfmac_f32_32x32x32_bf16 v[112:127], v[156:159], v[88:95], v184
    v_exp_f32 v98, v98
    v_exp_f32 v99, v99
    v_exp_f32 v100, v100
    v_exp_f32 v101, v101
    s_waitcnt lgkmcnt(0)
    v_exp_f32 v102, v102
    v_mfma_f32_32x32x16_bf16 v[80:95], v[36:39], v[144:147], v[48:63]
    v_exp_f32 v103, v103
    v_exp_f32 v104, v104
    v_exp_f32 v105, v105
    v_exp_f32 v106, v106
    v_exp_f32 v107, v107
    v_smfmac_f32_32x32x32_bf16 v[128:143], v[152:155], v[96:103], v184
    v_exp_f32 v108, v108
    v_exp_f32 v109, v109
    v_exp_f32 v110, v110
    v_exp_f32 v111, v111
    v_exp_f32 v80, v80
    v_exp_f32 v81, v81
    v_smfmac_f32_32x32x32_bf16 v[128:143], v[156:159], v[104:111], v184
    v_exp_f32 v82, v82
    v_exp_f32 v83, v83
    v_exp_f32 v84, v84
    ds_read_b128 v[32:35], v3 offset:4096
    ds_read_b128 v[152:155], v13 offset:0
    ds_read_b128 v[156:159], v13 offset:512
    v_exp_f32 v85, v85
    v_exp_f32 v86, v86
    v_mfma_f32_32x32x16_bf16 v[96:111], v[36:39], v[148:151], v[64:79]
    v_exp_f32 v87, v87
    v_exp_f32 v88, v88
    v_exp_f32 v89, v89
    ds_write_b128 v8, v[240:243] offset:40960
    v_exp_f32 v90, v90
    v_exp_f32 v91, v91
    v_smfmac_f32_32x32x32_bf16 v[112:127], v[160:163], v[80:87], v184
    v_exp_f32 v92, v92
    v_exp_f32 v93, v93
    v_exp_f32 v94, v94
    v_exp_f32 v95, v95
    ds_write_b128 v8, v[244:247] offset:57344
    v_exp_f32 v96, v96
    v_exp_f32 v97, v97
    v_smfmac_f32_32x32x32_bf16 v[112:127], v[164:167], v[88:95], v184
    v_exp_f32 v98, v98
    v_exp_f32 v99, v99
    v_exp_f32 v100, v100
    v_exp_f32 v101, v101
    s_waitcnt lgkmcnt(0)
    v_exp_f32 v102, v102
    v_mfma_f32_32x32x16_bf16 v[80:95], v[32:35], v[144:147], v[48:63]
    v_exp_f32 v103, v103
    v_exp_f32 v104, v104
    v_exp_f32 v105, v105
    v_exp_f32 v106, v106
    v_exp_f32 v107, v107
    v_smfmac_f32_32x32x32_bf16 v[128:143], v[160:163], v[96:103], v184
    v_exp_f32 v108, v108
    v_exp_f32 v109, v109
    v_exp_f32 v110, v110
    v_exp_f32 v111, v111
    v_exp_f32 v80, v80
    v_exp_f32 v81, v81
    v_smfmac_f32_32x32x32_bf16 v[128:143], v[164:167], v[104:111], v184
    v_exp_f32 v82, v82
    v_exp_f32 v83, v83
    v_exp_f32 v84, v84
    ds_read_b128 v[36:39], v3 offset:5120
    ds_read_b128 v[160:163], v13 offset:1024
    ds_read_b128 v[164:167], v13 offset:1536
    v_exp_f32 v85, v85
    v_exp_f32 v86, v86
    v_mfma_f32_32x32x16_bf16 v[96:111], v[32:35], v[148:151], v[64:79]
    v_exp_f32 v87, v87
    v_exp_f32 v88, v88
    s_mov_b32 s71, 8192
    v_mad_u32_u24 v12, v9, s71, v5
    v_exp_f32 v89, v89
    ds_write_b128 v8, v[248:251] offset:45056
    v_exp_f32 v90, v90
    v_exp_f32 v91, v91
    v_smfmac_f32_32x32x32_bf16 v[112:127], v[152:155], v[80:87], v184
    v_exp_f32 v92, v92
    v_exp_f32 v93, v93
    v_exp_f32 v94, v94
    v_exp_f32 v95, v95
    ds_write_b128 v8, v[252:255] offset:61440
    v_exp_f32 v96, v96
    v_exp_f32 v97, v97
    v_smfmac_f32_32x32x32_bf16 v[112:127], v[156:159], v[88:95], v184
    v_exp_f32 v98, v98
    v_exp_f32 v99, v99
    v_exp_f32 v100, v100
    v_exp_f32 v101, v101
    s_waitcnt lgkmcnt(0)
    v_exp_f32 v102, v102
    v_mfma_f32_32x32x16_bf16 v[80:95], v[36:39], v[144:147], v[48:63]
    v_exp_f32 v103, v103
    v_exp_f32 v104, v104
    v_exp_f32 v105, v105
    v_exp_f32 v106, v106
    v_exp_f32 v107, v107
    v_smfmac_f32_32x32x32_bf16 v[128:143], v[152:155], v[96:103], v184
    v_exp_f32 v108, v108
    v_exp_f32 v109, v109
    v_exp_f32 v110, v110
    v_exp_f32 v111, v111
    v_exp_f32 v80, v80
    v_exp_f32 v81, v81
    v_smfmac_f32_32x32x32_bf16 v[128:143], v[156:159], v[104:111], v184
    v_exp_f32 v82, v82
    v_exp_f32 v83, v83
    v_exp_f32 v84, v84
    ds_read_b128 v[32:35], v3 offset:6144
    ds_read_b128 v[152:155], v13 offset:2048
    ds_read_b128 v[156:159], v13 offset:2560
    v_exp_f32 v85, v85
    v_exp_f32 v86, v86
    v_mfma_f32_32x32x16_bf16 v[96:111], v[36:39], v[148:151], v[64:79]
    v_exp_f32 v87, v87
    v_exp_f32 v88, v88
    v_exp_f32 v89, v89
    v_exp_f32 v90, v90
    v_exp_f32 v91, v91
    s_add_u32 s13, s12, 32768
    buffer_load_dwordx4 v[192:195], v3, s[60:63], s13 offen sc1
    v_smfmac_f32_32x32x32_bf16 v[112:127], v[160:163], v[80:87], v184
    v_exp_f32 v92, v92
    v_exp_f32 v93, v93
    v_exp_f32 v94, v94
    v_exp_f32 v95, v95
    v_exp_f32 v96, v96
    v_exp_f32 v97, v97
    v_smfmac_f32_32x32x32_bf16 v[112:127], v[164:167], v[88:95], v184
    v_exp_f32 v98, v98
    s_add_u32 s13, s12, 32768
    buffer_load_dwordx4 v[196:199], v3, s[64:67], s13 offen sc1
    v_exp_f32 v99, v99
    v_exp_f32 v100, v100
    v_exp_f32 v101, v101
    s_waitcnt lgkmcnt(0)
    v_exp_f32 v102, v102
    v_mfma_f32_32x32x16_bf16 v[80:95], v[32:35], v[144:147], v[48:63]
    v_exp_f32 v103, v103
    v_exp_f32 v104, v104
    v_exp_f32 v105, v105
    v_exp_f32 v106, v106
    v_exp_f32 v107, v107
    v_smfmac_f32_32x32x32_bf16 v[128:143], v[160:163], v[96:103], v184
    v_exp_f32 v108, v108
    v_exp_f32 v109, v109
    v_exp_f32 v110, v110
    v_exp_f32 v111, v111
    v_exp_f32 v80, v80
    v_exp_f32 v81, v81
    v_smfmac_f32_32x32x32_bf16 v[128:143], v[164:167], v[104:111], v184
    v_exp_f32 v82, v82
    v_exp_f32 v83, v83
    v_exp_f32 v84, v84
    ds_read_b128 v[36:39], v3 offset:7168
    ds_read_b128 v[160:163], v13 offset:3072
    ds_read_b128 v[164:167], v13 offset:3584
    v_exp_f32 v85, v85
    v_exp_f32 v86, v86
    v_mfma_f32_32x32x16_bf16 v[96:111], v[32:35], v[148:151], v[64:79]
    v_exp_f32 v87, v87
    v_exp_f32 v88, v88
    v_exp_f32 v89, v89
    v_exp_f32 v90, v90
    v_exp_f32 v91, v91
    s_add_u32 s13, s12, 36864
    buffer_load_dwordx4 v[200:203], v3, s[60:63], s13 offen sc1
    v_smfmac_f32_32x32x32_bf16 v[112:127], v[152:155], v[80:87], v184
    v_exp_f32 v92, v92
    v_exp_f32 v93, v93
    v_exp_f32 v94, v94
    v_exp_f32 v95, v95
    v_exp_f32 v96, v96
    v_exp_f32 v97, v97
    v_smfmac_f32_32x32x32_bf16 v[112:127], v[156:159], v[88:95], v184
    v_exp_f32 v98, v98
    s_add_u32 s13, s12, 36864
    buffer_load_dwordx4 v[204:207], v3, s[64:67], s13 offen sc1
    v_exp_f32 v99, v99
    v_exp_f32 v100, v100
    v_exp_f32 v101, v101
    s_waitcnt lgkmcnt(0)
    v_exp_f32 v102, v102
    v_mfma_f32_32x32x16_bf16 v[80:95], v[36:39], v[144:147], v[48:63]
    v_exp_f32 v103, v103
    v_exp_f32 v104, v104
    v_exp_f32 v105, v105
    v_exp_f32 v106, v106
    v_exp_f32 v107, v107
    v_smfmac_f32_32x32x32_bf16 v[128:143], v[152:155], v[96:103], v184
    v_exp_f32 v108, v108
    v_exp_f32 v109, v109
    v_exp_f32 v110, v110
    v_exp_f32 v111, v111
    v_exp_f32 v80, v80
    v_exp_f32 v81, v81
    v_smfmac_f32_32x32x32_bf16 v[128:143], v[156:159], v[104:111], v184
    v_exp_f32 v82, v82
    v_exp_f32 v83, v83
    v_exp_f32 v84, v84
    ds_read_b128 v[32:35], v3 offset:8192
    ds_read_b128 v[152:155], v12 offset:0
    ds_read_b128 v[156:159], v12 offset:512
    v_exp_f32 v85, v85
    v_exp_f32 v86, v86
    v_mfma_f32_32x32x16_bf16 v[96:111], v[36:39], v[148:151], v[64:79]
    v_exp_f32 v87, v87
    v_exp_f32 v88, v88
    v_exp_f32 v89, v89
    v_exp_f32 v90, v90
    v_exp_f32 v91, v91
    s_add_u32 s13, s12, 40960
    buffer_load_dwordx4 v[208:211], v3, s[60:63], s13 offen sc1
    v_smfmac_f32_32x32x32_bf16 v[112:127], v[160:163], v[80:87], v184
    v_exp_f32 v92, v92
    v_exp_f32 v93, v93
    v_exp_f32 v94, v94
    v_exp_f32 v95, v95
    v_exp_f32 v96, v96
    v_exp_f32 v97, v97
    v_smfmac_f32_32x32x32_bf16 v[112:127], v[164:167], v[88:95], v184
    v_exp_f32 v98, v98
    s_add_u32 s13, s12, 40960
    buffer_load_dwordx4 v[212:215], v3, s[64:67], s13 offen sc1
    v_exp_f32 v99, v99
    v_exp_f32 v100, v100
    v_exp_f32 v101, v101
    s_waitcnt lgkmcnt(0)
    v_exp_f32 v102, v102
    v_mfma_f32_32x32x16_bf16 v[80:95], v[32:35], v[144:147], v[48:63]
    v_exp_f32 v103, v103
    v_exp_f32 v104, v104
    v_exp_f32 v105, v105
    v_exp_f32 v106, v106
    v_exp_f32 v107, v107
    v_smfmac_f32_32x32x32_bf16 v[128:143], v[160:163], v[96:103], v184
    v_exp_f32 v108, v108
    v_exp_f32 v109, v109
    v_exp_f32 v110, v110
    v_exp_f32 v111, v111
    v_exp_f32 v80, v80
    v_exp_f32 v81, v81
    v_smfmac_f32_32x32x32_bf16 v[128:143], v[164:167], v[104:111], v184
    v_exp_f32 v82, v82
    v_exp_f32 v83, v83
    v_exp_f32 v84, v84
    ds_read_b128 v[36:39], v3 offset:9216
    ds_read_b128 v[160:163], v12 offset:1024
    ds_read_b128 v[164:167], v12 offset:1536
    v_exp_f32 v85, v85
    v_exp_f32 v86, v86
    v_mfma_f32_32x32x16_bf16 v[96:111], v[32:35], v[148:151], v[64:79]
    v_exp_f32 v87, v87
    v_exp_f32 v88, v88
    s_mov_b32 s71, 12288
    v_mad_u32_u24 v13, v9, s71, v5
    v_exp_f32 v89, v89
    v_exp_f32 v90, v90
    v_exp_f32 v91, v91
    s_add_u32 s13, s12, 45056
    buffer_load_dwordx4 v[216:219], v3, s[60:63], s13 offen sc1
    v_smfmac_f32_32x32x32_bf16 v[112:127], v[152:155], v[80:87], v184
    v_exp_f32 v92, v92
    v_exp_f32 v93, v93
    v_exp_f32 v94, v94
    v_exp_f32 v95, v95
    v_exp_f32 v96, v96
    v_exp_f32 v97, v97
    v_smfmac_f32_32x32x32_bf16 v[112:127], v[156:159], v[88:95], v184
    v_exp_f32 v98, v98
    s_add_u32 s13, s12, 45056
    buffer_load_dwordx4 v[220:223], v3, s[64:67], s13 offen sc1
    v_exp_f32 v99, v99
    v_exp_f32 v100, v100
    v_exp_f32 v101, v101
    s_waitcnt lgkmcnt(0)
    v_exp_f32 v102, v102
    v_mfma_f32_32x32x16_bf16 v[80:95], v[36:39], v[144:147], v[48:63]
    v_exp_f32 v103, v103
    v_exp_f32 v104, v104
    v_exp_f32 v105, v105
    v_exp_f32 v106, v106
    v_exp_f32 v107, v107
    v_smfmac_f32_32x32x32_bf16 v[128:143], v[152:155], v[96:103], v184
    v_exp_f32 v108, v108
    v_exp_f32 v109, v109
    v_exp_f32 v110, v110
    v_exp_f32 v111, v111
    v_exp_f32 v80, v80
    v_exp_f32 v81, v81
    v_smfmac_f32_32x32x32_bf16 v[128:143], v[156:159], v[104:111], v184
    v_exp_f32 v82, v82
    v_exp_f32 v83, v83
    v_exp_f32 v84, v84
    ds_read_b128 v[32:35], v3 offset:10240
    ds_read_b128 v[152:155], v12 offset:2048
    ds_read_b128 v[156:159], v12 offset:2560
    v_exp_f32 v85, v85
    v_exp_f32 v86, v86
    v_mfma_f32_32x32x16_bf16 v[96:111], v[36:39], v[148:151], v[64:79]
    v_exp_f32 v87, v87
    v_exp_f32 v88, v88
    v_exp_f32 v89, v89
    v_exp_f32 v90, v90
    v_exp_f32 v91, v91
    s_add_u32 s13, s12, 49152
    buffer_load_dwordx4 v[224:227], v3, s[60:63], s13 offen sc1
    v_smfmac_f32_32x32x32_bf16 v[112:127], v[160:163], v[80:87], v184
    v_exp_f32 v92, v92
    v_exp_f32 v93, v93
    v_exp_f32 v94, v94
    v_exp_f32 v95, v95
    v_exp_f32 v96, v96
    v_exp_f32 v97, v97
    v_smfmac_f32_32x32x32_bf16 v[112:127], v[164:167], v[88:95], v184
    v_exp_f32 v98, v98
    s_add_u32 s13, s12, 49152
    buffer_load_dwordx4 v[228:231], v3, s[64:67], s13 offen sc1
    v_exp_f32 v99, v99
    v_exp_f32 v100, v100
    v_exp_f32 v101, v101
    s_waitcnt lgkmcnt(0)
    v_exp_f32 v102, v102
    v_mfma_f32_32x32x16_bf16 v[80:95], v[32:35], v[144:147], v[48:63]
    v_exp_f32 v103, v103
    v_exp_f32 v104, v104
    v_exp_f32 v105, v105
    v_exp_f32 v106, v106
    v_exp_f32 v107, v107
    v_smfmac_f32_32x32x32_bf16 v[128:143], v[160:163], v[96:103], v184
    v_exp_f32 v108, v108
    v_exp_f32 v109, v109
    v_exp_f32 v110, v110
    v_exp_f32 v111, v111
    v_exp_f32 v80, v80
    v_exp_f32 v81, v81
    v_smfmac_f32_32x32x32_bf16 v[128:143], v[164:167], v[104:111], v184
    v_exp_f32 v82, v82
    v_exp_f32 v83, v83
    v_exp_f32 v84, v84
    ds_read_b128 v[36:39], v3 offset:11264
    ds_read_b128 v[160:163], v12 offset:3072
    ds_read_b128 v[164:167], v12 offset:3584
    v_exp_f32 v85, v85
    v_exp_f32 v86, v86
    v_mfma_f32_32x32x16_bf16 v[96:111], v[32:35], v[148:151], v[64:79]
    v_exp_f32 v87, v87
    v_exp_f32 v88, v88
    v_exp_f32 v89, v89
    v_exp_f32 v90, v90
    v_exp_f32 v91, v91
    s_add_u32 s13, s12, 53248
    buffer_load_dwordx4 v[232:235], v3, s[60:63], s13 offen sc1
    v_smfmac_f32_32x32x32_bf16 v[112:127], v[152:155], v[80:87], v184
    v_exp_f32 v92, v92
    v_exp_f32 v93, v93
    v_exp_f32 v94, v94
    v_exp_f32 v95, v95
    v_exp_f32 v96, v96
    v_exp_f32 v97, v97
    v_smfmac_f32_32x32x32_bf16 v[112:127], v[156:159], v[88:95], v184
    v_exp_f32 v98, v98
    s_add_u32 s13, s12, 53248
    buffer_load_dwordx4 v[236:239], v3, s[64:67], s13 offen sc1
    v_exp_f32 v99, v99
    v_exp_f32 v100, v100
    v_exp_f32 v101, v101
    s_waitcnt lgkmcnt(0)
    v_exp_f32 v102, v102
    v_mfma_f32_32x32x16_bf16 v[80:95], v[36:39], v[144:147], v[48:63]
    v_exp_f32 v103, v103
    v_exp_f32 v104, v104
    v_exp_f32 v105, v105
    v_exp_f32 v106, v106
    v_exp_f32 v107, v107
    v_smfmac_f32_32x32x32_bf16 v[128:143], v[152:155], v[96:103], v184
    v_exp_f32 v108, v108
    v_exp_f32 v109, v109
    v_exp_f32 v110, v110
    v_exp_f32 v111, v111
    v_exp_f32 v80, v80
    v_exp_f32 v81, v81
    v_smfmac_f32_32x32x32_bf16 v[128:143], v[156:159], v[104:111], v184
    v_exp_f32 v82, v82
    v_exp_f32 v83, v83
    v_exp_f32 v84, v84
    ds_read_b128 v[32:35], v3 offset:12288
    ds_read_b128 v[152:155], v13 offset:0
    ds_read_b128 v[156:159], v13 offset:512
    v_exp_f32 v85, v85
    v_exp_f32 v86, v86
    v_mfma_f32_32x32x16_bf16 v[96:111], v[36:39], v[148:151], v[64:79]
    v_exp_f32 v87, v87
    v_exp_f32 v88, v88
    v_exp_f32 v89, v89
    v_exp_f32 v90, v90
    v_exp_f32 v91, v91
    s_add_u32 s13, s12, 57344
    buffer_load_dwordx4 v[240:243], v3, s[60:63], s13 offen sc1
    v_smfmac_f32_32x32x32_bf16 v[112:127], v[160:163], v[80:87], v184
    v_exp_f32 v92, v92
    v_exp_f32 v93, v93
    v_exp_f32 v94, v94
    v_exp_f32 v95, v95
    v_exp_f32 v96, v96
    v_exp_f32 v97, v97
    v_smfmac_f32_32x32x32_bf16 v[112:127], v[164:167], v[88:95], v184
    v_exp_f32 v98, v98
    s_add_u32 s13, s12, 57344
    buffer_load_dwordx4 v[244:247], v3, s[64:67], s13 offen sc1
    v_exp_f32 v99, v99
    v_exp_f32 v100, v100
    v_exp_f32 v101, v101
    s_waitcnt lgkmcnt(0)
    v_exp_f32 v102, v102
    v_mfma_f32_32x32x16_bf16 v[80:95], v[32:35], v[144:147], v[48:63]
    v_exp_f32 v103, v103
    v_exp_f32 v104, v104
    v_exp_f32 v105, v105
    v_exp_f32 v106, v106
    v_exp_f32 v107, v107
    v_smfmac_f32_32x32x32_bf16 v[128:143], v[160:163], v[96:103], v184
    v_exp_f32 v108, v108
    v_exp_f32 v109, v109
    v_exp_f32 v110, v110
    v_exp_f32 v111, v111
    v_exp_f32 v80, v80
    s_barrier
    v_exp_f32 v81, v81
    v_smfmac_f32_32x32x32_bf16 v[128:143], v[164:167], v[104:111], v184
    v_exp_f32 v82, v82
    v_exp_f32 v83, v83
    v_exp_f32 v84, v84
    ds_read_b128 v[36:39], v3 offset:13312
    ds_read_b128 v[160:163], v13 offset:1024
    ds_read_b128 v[164:167], v13 offset:1536
    v_exp_f32 v85, v85
    v_exp_f32 v86, v86
    v_mfma_f32_32x32x16_bf16 v[96:111], v[32:35], v[148:151], v[64:79]
    v_exp_f32 v87, v87
    v_exp_f32 v88, v88
    s_mov_b32 s71, 32768
    v_mad_u32_u24 v12, v9, s71, v5
    v_exp_f32 v89, v89
    v_exp_f32 v90, v90
    v_exp_f32 v91, v91
    s_add_u32 s13, s12, 61440
    buffer_load_dwordx4 v[248:251], v3, s[60:63], s13 offen sc1
    v_smfmac_f32_32x32x32_bf16 v[112:127], v[152:155], v[80:87], v184
    v_exp_f32 v92, v92
    v_exp_f32 v93, v93
    v_exp_f32 v94, v94
    v_exp_f32 v95, v95
    v_exp_f32 v96, v96
    v_exp_f32 v97, v97
    v_smfmac_f32_32x32x32_bf16 v[112:127], v[156:159], v[88:95], v184
    v_exp_f32 v98, v98
    s_add_u32 s13, s12, 61440
    buffer_load_dwordx4 v[252:255], v3, s[64:67], s13 offen sc1
    v_exp_f32 v99, v99
    v_exp_f32 v100, v100
    v_exp_f32 v101, v101
    s_waitcnt lgkmcnt(0)
    v_exp_f32 v102, v102
    v_mfma_f32_32x32x16_bf16 v[80:95], v[36:39], v[144:147], v[48:63]
    v_exp_f32 v103, v103
    v_exp_f32 v104, v104
    v_exp_f32 v105, v105
    v_exp_f32 v106, v106
    v_exp_f32 v107, v107
    v_smfmac_f32_32x32x32_bf16 v[128:143], v[152:155], v[96:103], v184
    v_exp_f32 v108, v108
    v_exp_f32 v109, v109
    v_exp_f32 v110, v110
    v_exp_f32 v111, v111
    v_exp_f32 v80, v80
    v_exp_f32 v81, v81
    v_smfmac_f32_32x32x32_bf16 v[128:143], v[156:159], v[104:111], v184
    v_exp_f32 v82, v82
    v_exp_f32 v83, v83
    v_exp_f32 v84, v84
    ds_read_b128 v[32:35], v3 offset:14336
    ds_read_b128 v[152:155], v13 offset:2048
    ds_read_b128 v[156:159], v13 offset:2560
    v_exp_f32 v85, v85
    v_exp_f32 v86, v86
    v_mfma_f32_32x32x16_bf16 v[96:111], v[36:39], v[148:151], v[64:79]
    v_exp_f32 v87, v87
    v_exp_f32 v88, v88
    v_exp_f32 v89, v89
    v_exp_f32 v90, v90
    v_exp_f32 v91, v91
    v_smfmac_f32_32x32x32_bf16 v[112:127], v[160:163], v[80:87], v184
    v_exp_f32 v92, v92
    v_exp_f32 v93, v93
    v_exp_f32 v94, v94
    v_exp_f32 v95, v95
    v_exp_f32 v96, v96
    v_exp_f32 v97, v97
    v_smfmac_f32_32x32x32_bf16 v[112:127], v[164:167], v[88:95], v184
    v_exp_f32 v98, v98
    v_exp_f32 v99, v99
    v_exp_f32 v100, v100
    v_exp_f32 v101, v101
    s_waitcnt lgkmcnt(0)
    v_exp_f32 v102, v102
    v_mfma_f32_32x32x16_bf16 v[80:95], v[32:35], v[144:147], v[48:63]
    v_exp_f32 v103, v103
    v_exp_f32 v104, v104
    v_exp_f32 v105, v105
    v_exp_f32 v106, v106
    v_exp_f32 v107, v107
    v_smfmac_f32_32x32x32_bf16 v[128:143], v[160:163], v[96:103], v184
    v_exp_f32 v108, v108
    v_exp_f32 v109, v109
    v_exp_f32 v110, v110
    v_exp_f32 v111, v111
    v_exp_f32 v80, v80
    v_exp_f32 v81, v81
    v_smfmac_f32_32x32x32_bf16 v[128:143], v[164:167], v[104:111], v184
    v_exp_f32 v82, v82
    v_exp_f32 v83, v83
    v_exp_f32 v84, v84
    ds_read_b128 v[36:39], v3 offset:15360
    ds_read_b128 v[160:163], v13 offset:3072
    ds_read_b128 v[164:167], v13 offset:3584
    v_exp_f32 v85, v85
    v_exp_f32 v86, v86
    v_mfma_f32_32x32x16_bf16 v[96:111], v[32:35], v[148:151], v[64:79]
    v_exp_f32 v87, v87
    v_exp_f32 v88, v88
    v_exp_f32 v89, v89
    v_exp_f32 v90, v90
    v_exp_f32 v91, v91
    v_smfmac_f32_32x32x32_bf16 v[112:127], v[152:155], v[80:87], v184
    v_exp_f32 v92, v92
    v_exp_f32 v93, v93
    v_exp_f32 v94, v94
    v_exp_f32 v95, v95
    v_exp_f32 v96, v96
    v_exp_f32 v97, v97
    v_smfmac_f32_32x32x32_bf16 v[112:127], v[156:159], v[88:95], v184
    v_exp_f32 v98, v98
    v_exp_f32 v99, v99
    v_exp_f32 v100, v100
    v_exp_f32 v101, v101
    s_waitcnt lgkmcnt(0)
    v_exp_f32 v102, v102
    v_mfma_f32_32x32x16_bf16 v[80:95], v[36:39], v[144:147], v[48:63]
    v_exp_f32 v103, v103
    v_exp_f32 v104, v104
    v_exp_f32 v105, v105
    v_exp_f32 v106, v106
    v_exp_f32 v107, v107
    v_smfmac_f32_32x32x32_bf16 v[128:143], v[152:155], v[96:103], v184
    v_exp_f32 v108, v108
    v_exp_f32 v109, v109
    v_exp_f32 v110, v110
    v_exp_f32 v111, v111
    v_exp_f32 v80, v80
    v_exp_f32 v81, v81
    v_smfmac_f32_32x32x32_bf16 v[128:143], v[156:159], v[104:111], v184
    v_exp_f32 v82, v82
    v_exp_f32 v83, v83
    v_exp_f32 v84, v84
    ds_read_b128 v[32:35], v3 offset:32768
    ds_read_b128 v[152:155], v12 offset:0
    ds_read_b128 v[156:159], v12 offset:512
    v_exp_f32 v85, v85
    v_exp_f32 v86, v86
    v_mfma_f32_32x32x16_bf16 v[96:111], v[36:39], v[148:151], v[64:79]
    v_exp_f32 v87, v87
    v_exp_f32 v88, v88
    v_exp_f32 v89, v89
    v_exp_f32 v90, v90
    v_exp_f32 v91, v91
    v_smfmac_f32_32x32x32_bf16 v[112:127], v[160:163], v[80:87], v184
    v_exp_f32 v92, v92
    v_exp_f32 v93, v93
    v_exp_f32 v94, v94
    v_exp_f32 v95, v95
    v_exp_f32 v96, v96
    v_exp_f32 v97, v97
    v_smfmac_f32_32x32x32_bf16 v[112:127], v[164:167], v[88:95], v184
    v_exp_f32 v98, v98
    v_exp_f32 v99, v99
    v_exp_f32 v100, v100
    v_exp_f32 v101, v101
    s_waitcnt lgkmcnt(0)
    v_exp_f32 v102, v102
    v_mfma_f32_32x32x16_bf16 v[80:95], v[32:35], v[144:147], v[48:63]
    v_exp_f32 v103, v103
    v_exp_f32 v104, v104
    v_exp_f32 v105, v105
    v_exp_f32 v106, v106
    v_exp_f32 v107, v107
    v_smfmac_f32_32x32x32_bf16 v[128:143], v[160:163], v[96:103], v184
    v_exp_f32 v108, v108
    v_exp_f32 v109, v109
    v_exp_f32 v110, v110
    v_exp_f32 v111, v111
    v_exp_f32 v80, v80
    s_barrier
    v_exp_f32 v81, v81
    v_smfmac_f32_32x32x32_bf16 v[128:143], v[164:167], v[104:111], v184
    v_exp_f32 v82, v82
    v_exp_f32 v83, v83
    v_exp_f32 v84, v84
    ds_read_b128 v[36:39], v3 offset:33792
    ds_read_b128 v[160:163], v12 offset:1024
    ds_read_b128 v[164:167], v12 offset:1536
    v_exp_f32 v85, v85
    v_exp_f32 v86, v86
    v_mfma_f32_32x32x16_bf16 v[96:111], v[32:35], v[148:151], v[64:79]
    v_exp_f32 v87, v87
    v_exp_f32 v88, v88
    s_mov_b32 s71, 36864
    v_mad_u32_u24 v13, v9, s71, v5
    v_exp_f32 v89, v89
    v_exp_f32 v90, v90
    v_exp_f32 v91, v91
    v_smfmac_f32_32x32x32_bf16 v[112:127], v[152:155], v[80:87], v184
    v_exp_f32 v92, v92
    v_exp_f32 v93, v93
    v_exp_f32 v94, v94
    v_exp_f32 v95, v95
    v_exp_f32 v96, v96
    v_exp_f32 v97, v97
    v_smfmac_f32_32x32x32_bf16 v[112:127], v[156:159], v[88:95], v184
    v_exp_f32 v98, v98
    v_exp_f32 v99, v99
    v_exp_f32 v100, v100
    v_exp_f32 v101, v101
    s_waitcnt lgkmcnt(0)
    v_exp_f32 v102, v102
    v_mfma_f32_32x32x16_bf16 v[80:95], v[36:39], v[144:147], v[48:63]
    v_exp_f32 v103, v103
    v_exp_f32 v104, v104
    v_exp_f32 v105, v105
    v_exp_f32 v106, v106
    v_exp_f32 v107, v107
    v_smfmac_f32_32x32x32_bf16 v[128:143], v[152:155], v[96:103], v184
    v_exp_f32 v108, v108
    v_exp_f32 v109, v109
    v_exp_f32 v110, v110
    v_exp_f32 v111, v111
    v_exp_f32 v80, v80
    v_exp_f32 v81, v81
    v_smfmac_f32_32x32x32_bf16 v[128:143], v[156:159], v[104:111], v184
    v_exp_f32 v82, v82
    v_exp_f32 v83, v83
    v_exp_f32 v84, v84
    ds_read_b128 v[32:35], v3 offset:34816
    ds_read_b128 v[152:155], v12 offset:2048
    ds_read_b128 v[156:159], v12 offset:2560
    v_exp_f32 v85, v85
    v_exp_f32 v86, v86
    v_mfma_f32_32x32x16_bf16 v[96:111], v[36:39], v[148:151], v[64:79]
    v_exp_f32 v87, v87
    v_exp_f32 v88, v88
    v_exp_f32 v89, v89
    v_exp_f32 v90, v90
    v_exp_f32 v91, v91
    v_smfmac_f32_32x32x32_bf16 v[112:127], v[160:163], v[80:87], v184
    v_exp_f32 v92, v92
    v_exp_f32 v93, v93
    v_exp_f32 v94, v94
    v_exp_f32 v95, v95
    v_exp_f32 v96, v96
    v_exp_f32 v97, v97
    v_smfmac_f32_32x32x32_bf16 v[112:127], v[164:167], v[88:95], v184
    v_exp_f32 v98, v98
    v_exp_f32 v99, v99
    v_exp_f32 v100, v100
    v_exp_f32 v101, v101
    s_waitcnt lgkmcnt(0)
    v_exp_f32 v102, v102
    v_mfma_f32_32x32x16_bf16 v[80:95], v[32:35], v[144:147], v[48:63]
    v_exp_f32 v103, v103
    v_exp_f32 v104, v104
    v_exp_f32 v105, v105
    v_exp_f32 v106, v106
    v_exp_f32 v107, v107
    v_smfmac_f32_32x32x32_bf16 v[128:143], v[160:163], v[96:103], v184
    v_exp_f32 v108, v108
    v_exp_f32 v109, v109
    v_exp_f32 v110, v110
    v_exp_f32 v111, v111
    v_exp_f32 v80, v80
    v_exp_f32 v81, v81
    v_smfmac_f32_32x32x32_bf16 v[128:143], v[164:167], v[104:111], v184
    v_exp_f32 v82, v82
    v_exp_f32 v83, v83
    v_exp_f32 v84, v84
    ds_read_b128 v[36:39], v3 offset:35840
    ds_read_b128 v[160:163], v12 offset:3072
    ds_read_b128 v[164:167], v12 offset:3584
    v_exp_f32 v85, v85
    v_exp_f32 v86, v86
    v_mfma_f32_32x32x16_bf16 v[96:111], v[32:35], v[148:151], v[64:79]
    v_exp_f32 v87, v87
    v_exp_f32 v88, v88
    v_exp_f32 v89, v89
    v_exp_f32 v90, v90
    v_exp_f32 v91, v91
    v_smfmac_f32_32x32x32_bf16 v[112:127], v[152:155], v[80:87], v184
    v_exp_f32 v92, v92
    v_exp_f32 v93, v93
    v_exp_f32 v94, v94
    v_exp_f32 v95, v95
    v_exp_f32 v96, v96
    v_exp_f32 v97, v97
    v_smfmac_f32_32x32x32_bf16 v[112:127], v[156:159], v[88:95], v184
    v_exp_f32 v98, v98
    v_exp_f32 v99, v99
    v_exp_f32 v100, v100
    v_exp_f32 v101, v101
    s_waitcnt lgkmcnt(0)
    v_exp_f32 v102, v102
    v_mfma_f32_32x32x16_bf16 v[80:95], v[36:39], v[144:147], v[48:63]
    v_exp_f32 v103, v103
    v_exp_f32 v104, v104
    v_exp_f32 v105, v105
    v_exp_f32 v106, v106
    v_exp_f32 v107, v107
    v_smfmac_f32_32x32x32_bf16 v[128:143], v[152:155], v[96:103], v184
    v_exp_f32 v108, v108
    v_exp_f32 v109, v109
    v_exp_f32 v110, v110
    v_exp_f32 v111, v111
    v_exp_f32 v80, v80
    v_exp_f32 v81, v81
    v_smfmac_f32_32x32x32_bf16 v[128:143], v[156:159], v[104:111], v184
    v_exp_f32 v82, v82
    v_exp_f32 v83, v83
    v_exp_f32 v84, v84
    ds_read_b128 v[32:35], v3 offset:36864
    ds_read_b128 v[152:155], v13 offset:0
    ds_read_b128 v[156:159], v13 offset:512
    v_exp_f32 v85, v85
    v_exp_f32 v86, v86
    v_mfma_f32_32x32x16_bf16 v[96:111], v[36:39], v[148:151], v[64:79]
    v_exp_f32 v87, v87
    v_exp_f32 v88, v88
    v_exp_f32 v89, v89
    v_exp_f32 v90, v90
    v_exp_f32 v91, v91
    v_smfmac_f32_32x32x32_bf16 v[112:127], v[160:163], v[80:87], v184
    v_exp_f32 v92, v92
    v_exp_f32 v93, v93
    v_exp_f32 v94, v94
    v_exp_f32 v95, v95
    v_exp_f32 v96, v96
    v_exp_f32 v97, v97
    v_smfmac_f32_32x32x32_bf16 v[112:127], v[164:167], v[88:95], v184
    v_exp_f32 v98, v98
    v_exp_f32 v99, v99
    v_exp_f32 v100, v100
    v_exp_f32 v101, v101
    s_waitcnt lgkmcnt(0)
    v_exp_f32 v102, v102
    v_mfma_f32_32x32x16_bf16 v[80:95], v[32:35], v[144:147], v[48:63]
    v_exp_f32 v103, v103
    v_exp_f32 v104, v104
    v_exp_f32 v105, v105
    v_exp_f32 v106, v106
    v_exp_f32 v107, v107
    v_smfmac_f32_32x32x32_bf16 v[128:143], v[160:163], v[96:103], v184
    v_exp_f32 v108, v108
    v_exp_f32 v109, v109
    v_exp_f32 v110, v110
    v_exp_f32 v111, v111
    v_exp_f32 v80, v80
    v_exp_f32 v81, v81
    v_smfmac_f32_32x32x32_bf16 v[128:143], v[164:167], v[104:111], v184
    v_exp_f32 v82, v82
    v_exp_f32 v83, v83
    v_exp_f32 v84, v84
    ds_read_b128 v[36:39], v3 offset:37888
    ds_read_b128 v[160:163], v13 offset:1024
    ds_read_b128 v[164:167], v13 offset:1536
    v_exp_f32 v85, v85
    v_exp_f32 v86, v86
    v_mfma_f32_32x32x16_bf16 v[96:111], v[32:35], v[148:151], v[64:79]
    v_exp_f32 v87, v87
    v_exp_f32 v88, v88
    s_mov_b32 s71, 40960
    v_mad_u32_u24 v12, v9, s71, v5
    s_waitcnt vmcnt(0)
    v_exp_f32 v89, v89
    ds_write_b128 v8, v[192:195] offset:0
    v_exp_f32 v90, v90
    v_exp_f32 v91, v91
    v_smfmac_f32_32x32x32_bf16 v[112:127], v[152:155], v[80:87], v184
    v_exp_f32 v92, v92
    v_exp_f32 v93, v93
    v_exp_f32 v94, v94
    v_exp_f32 v95, v95
    ds_write_b128 v8, v[196:199] offset:16384
    v_exp_f32 v96, v96
    v_exp_f32 v97, v97
    v_smfmac_f32_32x32x32_bf16 v[112:127], v[156:159], v[88:95], v184
    v_exp_f32 v98, v98
    v_exp_f32 v99, v99
    v_exp_f32 v100, v100
    v_exp_f32 v101, v101
    s_waitcnt lgkmcnt(0)
    v_exp_f32 v102, v102
    v_mfma_f32_32x32x16_bf16 v[80:95], v[36:39], v[144:147], v[48:63]
    v_exp_f32 v103, v103
    v_exp_f32 v104, v104
    v_exp_f32 v105, v105
    v_exp_f32 v106, v106
    v_exp_f32 v107, v107
    v_smfmac_f32_32x32x32_bf16 v[128:143], v[152:155], v[96:103], v184
    v_exp_f32 v108, v108
    v_exp_f32 v109, v109
    v_exp_f32 v110, v110
    v_exp_f32 v111, v111
    v_exp_f32 v80, v80
    v_exp_f32 v81, v81
    v_smfmac_f32_32x32x32_bf16 v[128:143], v[156:159], v[104:111], v184
    v_exp_f32 v82, v82
    v_exp_f32 v83, v83
    v_exp_f32 v84, v84
    ds_read_b128 v[32:35], v3 offset:38912
    ds_read_b128 v[152:155], v13 offset:2048
    ds_read_b128 v[156:159], v13 offset:2560
    v_exp_f32 v85, v85
    v_exp_f32 v86, v86
    v_mfma_f32_32x32x16_bf16 v[96:111], v[36:39], v[148:151], v[64:79]
    v_exp_f32 v87, v87
    v_exp_f32 v88, v88
    v_exp_f32 v89, v89
    ds_write_b128 v8, v[200:203] offset:4096
    v_exp_f32 v90, v90
    v_exp_f32 v91, v91
    v_smfmac_f32_32x32x32_bf16 v[112:127], v[160:163], v[80:87], v184
    v_exp_f32 v92, v92
    v_exp_f32 v93, v93
    v_exp_f32 v94, v94
    v_exp_f32 v95, v95
    ds_write_b128 v8, v[204:207] offset:20480
    v_exp_f32 v96, v96
    v_exp_f32 v97, v97
    v_smfmac_f32_32x32x32_bf16 v[112:127], v[164:167], v[88:95], v184
    v_exp_f32 v98, v98
    v_exp_f32 v99, v99
    v_exp_f32 v100, v100
    v_exp_f32 v101, v101
    s_waitcnt lgkmcnt(0)
    v_exp_f32 v102, v102
    v_mfma_f32_32x32x16_bf16 v[80:95], v[32:35], v[144:147], v[48:63]
    v_exp_f32 v103, v103
    v_exp_f32 v104, v104
    v_exp_f32 v105, v105
    v_exp_f32 v106, v106
    v_exp_f32 v107, v107
    v_smfmac_f32_32x32x32_bf16 v[128:143], v[160:163], v[96:103], v184
    v_exp_f32 v108, v108
    v_exp_f32 v109, v109
    v_exp_f32 v110, v110
    v_exp_f32 v111, v111
    v_exp_f32 v80, v80
    v_exp_f32 v81, v81
    v_smfmac_f32_32x32x32_bf16 v[128:143], v[164:167], v[104:111], v184
    v_exp_f32 v82, v82
    v_exp_f32 v83, v83
    v_exp_f32 v84, v84
    ds_read_b128 v[36:39], v3 offset:39936
    ds_read_b128 v[160:163], v13 offset:3072
    ds_read_b128 v[164:167], v13 offset:3584
    v_exp_f32 v85, v85
    v_exp_f32 v86, v86
    v_mfma_f32_32x32x16_bf16 v[96:111], v[32:35], v[148:151], v[64:79]
    v_exp_f32 v87, v87
    v_exp_f32 v88, v88
    v_exp_f32 v89, v89
    ds_write_b128 v8, v[208:211] offset:8192
    v_exp_f32 v90, v90
    v_exp_f32 v91, v91
    v_smfmac_f32_32x32x32_bf16 v[112:127], v[152:155], v[80:87], v184
    v_exp_f32 v92, v92
    v_exp_f32 v93, v93
    v_exp_f32 v94, v94
    v_exp_f32 v95, v95
    ds_write_b128 v8, v[212:215] offset:24576
    v_exp_f32 v96, v96
    v_exp_f32 v97, v97
    v_smfmac_f32_32x32x32_bf16 v[112:127], v[156:159], v[88:95], v184
    v_exp_f32 v98, v98
    v_exp_f32 v99, v99
    v_exp_f32 v100, v100
    v_exp_f32 v101, v101
    s_waitcnt lgkmcnt(0)
    v_exp_f32 v102, v102
    v_mfma_f32_32x32x16_bf16 v[80:95], v[36:39], v[144:147], v[48:63]
    v_exp_f32 v103, v103
    v_exp_f32 v104, v104
    v_exp_f32 v105, v105
    v_exp_f32 v106, v106
    v_exp_f32 v107, v107
    v_smfmac_f32_32x32x32_bf16 v[128:143], v[152:155], v[96:103], v184
    v_exp_f32 v108, v108
    v_exp_f32 v109, v109
    v_exp_f32 v110, v110
    v_exp_f32 v111, v111
    v_exp_f32 v80, v80
    v_exp_f32 v81, v81
    v_smfmac_f32_32x32x32_bf16 v[128:143], v[156:159], v[104:111], v184
    v_exp_f32 v82, v82
    v_exp_f32 v83, v83
    v_exp_f32 v84, v84
    ds_read_b128 v[32:35], v3 offset:40960
    ds_read_b128 v[152:155], v12 offset:0
    ds_read_b128 v[156:159], v12 offset:512
    v_exp_f32 v85, v85
    v_exp_f32 v86, v86
    v_mfma_f32_32x32x16_bf16 v[96:111], v[36:39], v[148:151], v[64:79]
    v_exp_f32 v87, v87
    v_exp_f32 v88, v88
    v_exp_f32 v89, v89
    ds_write_b128 v8, v[216:219] offset:12288
    v_exp_f32 v90, v90
    v_exp_f32 v91, v91
    v_smfmac_f32_32x32x32_bf16 v[112:127], v[160:163], v[80:87], v184
    v_exp_f32 v92, v92
    v_exp_f32 v93, v93
    v_exp_f32 v94, v94
    v_exp_f32 v95, v95
    ds_write_b128 v8, v[220:223] offset:28672
    v_exp_f32 v96, v96
    v_exp_f32 v97, v97
    v_smfmac_f32_32x32x32_bf16 v[112:127], v[164:167], v[88:95], v184
    v_exp_f32 v98, v98
    v_exp_f32 v99, v99
    v_exp_f32 v100, v100
    v_exp_f32 v101, v101
    s_waitcnt lgkmcnt(0)
    v_exp_f32 v102, v102
    v_mfma_f32_32x32x16_bf16 v[80:95], v[32:35], v[144:147], v[48:63]
    v_exp_f32 v103, v103
    v_exp_f32 v104, v104
    v_exp_f32 v105, v105
    v_exp_f32 v106, v106
    v_exp_f32 v107, v107
    v_smfmac_f32_32x32x32_bf16 v[128:143], v[160:163], v[96:103], v184
    v_exp_f32 v108, v108
    v_exp_f32 v109, v109
    v_exp_f32 v110, v110
    v_exp_f32 v111, v111
    v_exp_f32 v80, v80
    v_exp_f32 v81, v81
    v_smfmac_f32_32x32x32_bf16 v[128:143], v[164:167], v[104:111], v184
    v_exp_f32 v82, v82
    v_exp_f32 v83, v83
    v_exp_f32 v84, v84
    ds_read_b128 v[36:39], v3 offset:41984
    ds_read_b128 v[160:163], v12 offset:1024
    ds_read_b128 v[164:167], v12 offset:1536
    v_exp_f32 v85, v85
    v_exp_f32 v86, v86
    v_mfma_f32_32x32x16_bf16 v[96:111], v[32:35], v[148:151], v[64:79]
    v_exp_f32 v87, v87
    v_exp_f32 v88, v88
    s_mov_b32 s71, 45056
    v_mad_u32_u24 v13, v9, s71, v5
    v_exp_f32 v89, v89
    v_exp_f32 v90, v90
    v_exp_f32 v91, v91
    v_smfmac_f32_32x32x32_bf16 v[112:127], v[152:155], v[80:87], v184
    v_exp_f32 v92, v92
    v_exp_f32 v93, v93
    v_exp_f32 v94, v94
    v_exp_f32 v95, v95
    v_exp_f32 v96, v96
    v_exp_f32 v97, v97
    v_smfmac_f32_32x32x32_bf16 v[112:127], v[156:159], v[88:95], v184
    v_exp_f32 v98, v98
    v_exp_f32 v99, v99
    v_exp_f32 v100, v100
    v_exp_f32 v101, v101
    s_waitcnt lgkmcnt(0)
    v_exp_f32 v102, v102
    v_mfma_f32_32x32x16_bf16 v[80:95], v[36:39], v[144:147], v[48:63]
    v_exp_f32 v103, v103
    v_exp_f32 v104, v104
    v_exp_f32 v105, v105
    v_exp_f32 v106, v106
    v_exp_f32 v107, v107
    v_smfmac_f32_32x32x32_bf16 v[128:143], v[152:155], v[96:103], v184
    v_exp_f32 v108, v108
    v_exp_f32 v109, v109
    v_exp_f32 v110, v110
    v_exp_f32 v111, v111
    v_exp_f32 v80, v80
    v_exp_f32 v81, v81
    v_smfmac_f32_32x32x32_bf16 v[128:143], v[156:159], v[104:111], v184
    v_exp_f32 v82, v82
    v_exp_f32 v83, v83
    v_exp_f32 v84, v84
    ds_read_b128 v[32:35], v3 offset:43008
    ds_read_b128 v[152:155], v12 offset:2048
    ds_read_b128 v[156:159], v12 offset:2560
    v_exp_f32 v85, v85
    v_exp_f32 v86, v86
    v_mfma_f32_32x32x16_bf16 v[96:111], v[36:39], v[148:151], v[64:79]
    v_exp_f32 v87, v87
    v_exp_f32 v88, v88
    v_exp_f32 v89, v89
    v_exp_f32 v90, v90
    v_exp_f32 v91, v91
    v_smfmac_f32_32x32x32_bf16 v[112:127], v[160:163], v[80:87], v184
    v_exp_f32 v92, v92
    v_exp_f32 v93, v93
    v_exp_f32 v94, v94
    v_exp_f32 v95, v95
    v_exp_f32 v96, v96
    v_exp_f32 v97, v97
    v_smfmac_f32_32x32x32_bf16 v[112:127], v[164:167], v[88:95], v184
    v_exp_f32 v98, v98
    v_exp_f32 v99, v99
    v_exp_f32 v100, v100
    v_exp_f32 v101, v101
    s_waitcnt lgkmcnt(0)
    v_exp_f32 v102, v102
    v_mfma_f32_32x32x16_bf16 v[80:95], v[32:35], v[144:147], v[48:63]
    v_exp_f32 v103, v103
    v_exp_f32 v104, v104
    v_exp_f32 v105, v105
    v_exp_f32 v106, v106
    v_exp_f32 v107, v107
    v_smfmac_f32_32x32x32_bf16 v[128:143], v[160:163], v[96:103], v184
    v_exp_f32 v108, v108
    v_exp_f32 v109, v109
    v_exp_f32 v110, v110
    v_exp_f32 v111, v111
    v_exp_f32 v80, v80
    v_exp_f32 v81, v81
    v_smfmac_f32_32x32x32_bf16 v[128:143], v[164:167], v[104:111], v184
    v_exp_f32 v82, v82
    v_exp_f32 v83, v83
    v_exp_f32 v84, v84
    ds_read_b128 v[36:39], v3 offset:44032
    ds_read_b128 v[160:163], v12 offset:3072
    ds_read_b128 v[164:167], v12 offset:3584
    v_exp_f32 v85, v85
    v_exp_f32 v86, v86
    v_mfma_f32_32x32x16_bf16 v[96:111], v[32:35], v[148:151], v[64:79]
    v_exp_f32 v87, v87
    v_exp_f32 v88, v88
    v_exp_f32 v89, v89
    v_exp_f32 v90, v90
    v_exp_f32 v91, v91
    v_smfmac_f32_32x32x32_bf16 v[112:127], v[152:155], v[80:87], v184
    v_exp_f32 v92, v92
    v_exp_f32 v93, v93
    v_exp_f32 v94, v94
    v_exp_f32 v95, v95
    v_exp_f32 v96, v96
    v_exp_f32 v97, v97
    v_smfmac_f32_32x32x32_bf16 v[112:127], v[156:159], v[88:95], v184
    v_exp_f32 v98, v98
    v_exp_f32 v99, v99
    v_exp_f32 v100, v100
    v_exp_f32 v101, v101
    s_waitcnt lgkmcnt(0)
    v_exp_f32 v102, v102
    v_mfma_f32_32x32x16_bf16 v[80:95], v[36:39], v[144:147], v[48:63]
    v_exp_f32 v103, v103
    v_exp_f32 v104, v104
    v_exp_f32 v105, v105
    v_exp_f32 v106, v106
    v_exp_f32 v107, v107
    v_smfmac_f32_32x32x32_bf16 v[128:143], v[152:155], v[96:103], v184
    v_exp_f32 v108, v108
    v_exp_f32 v109, v109
    v_exp_f32 v110, v110
    v_exp_f32 v111, v111
    v_exp_f32 v80, v80
    v_exp_f32 v81, v81
    v_smfmac_f32_32x32x32_bf16 v[128:143], v[156:159], v[104:111], v184
    v_exp_f32 v82, v82
    v_exp_f32 v83, v83
    v_exp_f32 v84, v84
    ds_read_b128 v[32:35], v3 offset:45056
    ds_read_b128 v[152:155], v13 offset:0
    ds_read_b128 v[156:159], v13 offset:512
    v_exp_f32 v85, v85
    v_exp_f32 v86, v86
    v_mfma_f32_32x32x16_bf16 v[96:111], v[36:39], v[148:151], v[64:79]
    v_exp_f32 v87, v87
    v_exp_f32 v88, v88
    v_exp_f32 v89, v89
    v_exp_f32 v90, v90
    v_exp_f32 v91, v91
    v_smfmac_f32_32x32x32_bf16 v[112:127], v[160:163], v[80:87], v184
    v_exp_f32 v92, v92
    v_exp_f32 v93, v93
    v_exp_f32 v94, v94
    v_exp_f32 v95, v95
    v_exp_f32 v96, v96
    v_exp_f32 v97, v97
    v_smfmac_f32_32x32x32_bf16 v[112:127], v[164:167], v[88:95], v184
    v_exp_f32 v98, v98
    v_exp_f32 v99, v99
    v_exp_f32 v100, v100
    v_exp_f32 v101, v101
    s_waitcnt lgkmcnt(0)
    v_exp_f32 v102, v102
    v_mfma_f32_32x32x16_bf16 v[80:95], v[32:35], v[144:147], v[48:63]
    v_exp_f32 v103, v103
    v_exp_f32 v104, v104
    v_exp_f32 v105, v105
    v_exp_f32 v106, v106
    v_exp_f32 v107, v107
    v_smfmac_f32_32x32x32_bf16 v[128:143], v[160:163], v[96:103], v184
    v_exp_f32 v108, v108
    v_exp_f32 v109, v109
    v_exp_f32 v110, v110
    v_exp_f32 v111, v111
    v_exp_f32 v80, v80
    s_barrier
    v_exp_f32 v81, v81
    v_smfmac_f32_32x32x32_bf16 v[128:143], v[164:167], v[104:111], v184
    v_exp_f32 v82, v82
    v_exp_f32 v83, v83
    v_exp_f32 v84, v84
    ds_read_b128 v[36:39], v3 offset:46080
    ds_read_b128 v[160:163], v13 offset:1024
    ds_read_b128 v[164:167], v13 offset:1536
    v_exp_f32 v85, v85
    v_exp_f32 v86, v86
    v_mfma_f32_32x32x16_bf16 v[96:111], v[32:35], v[148:151], v[64:79]
    v_exp_f32 v87, v87
    v_exp_f32 v88, v88
    s_mov_b32 s71, 0
    v_mad_u32_u24 v12, v9, s71, v5
    v_exp_f32 v89, v89
    v_exp_f32 v90, v90
    v_exp_f32 v91, v91
    v_smfmac_f32_32x32x32_bf16 v[112:127], v[152:155], v[80:87], v184
    v_exp_f32 v92, v92
    v_exp_f32 v93, v93
    v_exp_f32 v94, v94
    v_exp_f32 v95, v95
    v_exp_f32 v96, v96
    v_exp_f32 v97, v97
    v_smfmac_f32_32x32x32_bf16 v[112:127], v[156:159], v[88:95], v184
    v_exp_f32 v98, v98
    v_exp_f32 v99, v99
    v_exp_f32 v100, v100
    v_exp_f32 v101, v101
    s_waitcnt lgkmcnt(0)
    v_exp_f32 v102, v102
    v_mfma_f32_32x32x16_bf16 v[80:95], v[36:39], v[144:147], v[48:63]
    v_exp_f32 v103, v103
    v_exp_f32 v104, v104
    v_exp_f32 v105, v105
    v_exp_f32 v106, v106
    v_exp_f32 v107, v107
    v_smfmac_f32_32x32x32_bf16 v[128:143], v[152:155], v[96:103], v184
    v_exp_f32 v108, v108
    v_exp_f32 v109, v109
    v_exp_f32 v110, v110
    v_exp_f32 v111, v111
    v_exp_f32 v80, v80
    v_exp_f32 v81, v81
    v_smfmac_f32_32x32x32_bf16 v[128:143], v[156:159], v[104:111], v184
    v_exp_f32 v82, v82
    v_exp_f32 v83, v83
    v_exp_f32 v84, v84
    ds_read_b128 v[32:35], v3 offset:47104
    ds_read_b128 v[152:155], v13 offset:2048
    ds_read_b128 v[156:159], v13 offset:2560
    v_exp_f32 v85, v85
    v_exp_f32 v86, v86
    v_mfma_f32_32x32x16_bf16 v[96:111], v[36:39], v[148:151], v[64:79]
    v_exp_f32 v87, v87
    v_exp_f32 v88, v88
    v_exp_f32 v89, v89
    v_exp_f32 v90, v90
    v_exp_f32 v91, v91
    v_smfmac_f32_32x32x32_bf16 v[112:127], v[160:163], v[80:87], v184
    v_exp_f32 v92, v92
    v_exp_f32 v93, v93
    v_exp_f32 v94, v94
    v_exp_f32 v95, v95
    v_exp_f32 v96, v96
    v_exp_f32 v97, v97
    v_smfmac_f32_32x32x32_bf16 v[112:127], v[164:167], v[88:95], v184
    v_exp_f32 v98, v98
    v_exp_f32 v99, v99
    v_exp_f32 v100, v100
    v_exp_f32 v101, v101
    s_waitcnt lgkmcnt(0)
    v_exp_f32 v102, v102
    v_mfma_f32_32x32x16_bf16 v[80:95], v[32:35], v[144:147], v[48:63]
    v_exp_f32 v103, v103
    v_exp_f32 v104, v104
    v_exp_f32 v105, v105
    v_exp_f32 v106, v106
    v_exp_f32 v107, v107
    v_smfmac_f32_32x32x32_bf16 v[128:143], v[160:163], v[96:103], v184
    v_exp_f32 v108, v108
    v_exp_f32 v109, v109
    v_exp_f32 v110, v110
    v_exp_f32 v111, v111
    v_exp_f32 v80, v80
    v_exp_f32 v81, v81
    v_smfmac_f32_32x32x32_bf16 v[128:143], v[164:167], v[104:111], v184
    v_exp_f32 v82, v82
    v_exp_f32 v83, v83
    v_exp_f32 v84, v84
    ds_read_b128 v[36:39], v3 offset:48128
    ds_read_b128 v[160:163], v13 offset:3072
    ds_read_b128 v[164:167], v13 offset:3584
    v_exp_f32 v85, v85
    v_exp_f32 v86, v86
    v_mfma_f32_32x32x16_bf16 v[96:111], v[32:35], v[148:151], v[64:79]
    v_exp_f32 v87, v87
    v_exp_f32 v88, v88
    v_exp_f32 v89, v89
    v_exp_f32 v90, v90
    v_exp_f32 v91, v91
    v_smfmac_f32_32x32x32_bf16 v[112:127], v[152:155], v[80:87], v184
    v_exp_f32 v92, v92
    v_exp_f32 v93, v93
    v_exp_f32 v94, v94
    v_exp_f32 v95, v95
    v_exp_f32 v96, v96
    v_exp_f32 v97, v97
    v_smfmac_f32_32x32x32_bf16 v[112:127], v[156:159], v[88:95], v184
    v_exp_f32 v98, v98
    v_exp_f32 v99, v99
    v_exp_f32 v100, v100
    v_exp_f32 v101, v101
    s_waitcnt lgkmcnt(0)
    v_exp_f32 v102, v102
    v_mfma_f32_32x32x16_bf16 v[80:95], v[36:39], v[144:147], v[48:63]
    v_exp_f32 v103, v103
    v_exp_f32 v104, v104
    v_exp_f32 v105, v105
    v_exp_f32 v106, v106
    v_exp_f32 v107, v107
    v_smfmac_f32_32x32x32_bf16 v[128:143], v[152:155], v[96:103], v184
    v_exp_f32 v108, v108
    v_exp_f32 v109, v109
    v_exp_f32 v110, v110
    v_exp_f32 v111, v111
    v_exp_f32 v80, v80
    v_exp_f32 v81, v81
    v_smfmac_f32_32x32x32_bf16 v[128:143], v[156:159], v[104:111], v184
    v_exp_f32 v82, v82
    v_exp_f32 v83, v83
    v_exp_f32 v84, v84
    ds_read_b128 v[32:35], v3 offset:0
    ds_read_b128 v[152:155], v12 offset:0
    ds_read_b128 v[156:159], v12 offset:512
    v_exp_f32 v85, v85
    v_exp_f32 v86, v86
    v_mfma_f32_32x32x16_bf16 v[96:111], v[36:39], v[148:151], v[64:79]
    v_exp_f32 v87, v87
    v_exp_f32 v88, v88
    v_exp_f32 v89, v89
    v_exp_f32 v90, v90
    v_exp_f32 v91, v91
    v_smfmac_f32_32x32x32_bf16 v[112:127], v[160:163], v[80:87], v184
    v_exp_f32 v92, v92
    v_exp_f32 v93, v93
    v_exp_f32 v94, v94
    v_exp_f32 v95, v95
    v_exp_f32 v96, v96
    v_exp_f32 v97, v97
    v_smfmac_f32_32x32x32_bf16 v[112:127], v[164:167], v[88:95], v184
    v_exp_f32 v98, v98
    v_exp_f32 v99, v99
    v_exp_f32 v100, v100
    v_exp_f32 v101, v101
    s_waitcnt lgkmcnt(0)
    v_exp_f32 v102, v102
    v_mfma_f32_32x32x16_bf16 v[80:95], v[32:35], v[144:147], v[48:63]
    v_exp_f32 v103, v103
    v_exp_f32 v104, v104
    v_exp_f32 v105, v105
    v_exp_f32 v106, v106
    v_exp_f32 v107, v107
    v_smfmac_f32_32x32x32_bf16 v[128:143], v[160:163], v[96:103], v184
    v_exp_f32 v108, v108
    v_exp_f32 v109, v109
    v_exp_f32 v110, v110
    v_exp_f32 v111, v111
    v_exp_f32 v80, v80
    s_barrier
    v_exp_f32 v81, v81
    v_smfmac_f32_32x32x32_bf16 v[128:143], v[164:167], v[104:111], v184
    v_exp_f32 v82, v82
    v_exp_f32 v83, v83
    v_exp_f32 v84, v84
    ds_read_b128 v[36:39], v3 offset:1024
    ds_read_b128 v[160:163], v12 offset:1024
    ds_read_b128 v[164:167], v12 offset:1536
    v_exp_f32 v85, v85
    v_exp_f32 v86, v86
    v_mfma_f32_32x32x16_bf16 v[96:111], v[32:35], v[148:151], v[64:79]
    v_exp_f32 v87, v87
    v_exp_f32 v88, v88
    s_mov_b32 s71, 4096
    v_mad_u32_u24 v13, v9, s71, v5
    v_exp_f32 v89, v89
    v_exp_f32 v90, v90
    v_exp_f32 v91, v91
    v_smfmac_f32_32x32x32_bf16 v[112:127], v[152:155], v[80:87], v184
    v_exp_f32 v92, v92
    v_exp_f32 v93, v93
    v_exp_f32 v94, v94
    v_exp_f32 v95, v95
    v_exp_f32 v96, v96
    v_exp_f32 v97, v97
    v_smfmac_f32_32x32x32_bf16 v[112:127], v[156:159], v[88:95], v184
    v_exp_f32 v98, v98
    v_exp_f32 v99, v99
    v_exp_f32 v100, v100
    v_exp_f32 v101, v101
    s_waitcnt lgkmcnt(0)
    v_exp_f32 v102, v102
    v_mfma_f32_32x32x16_bf16 v[80:95], v[36:39], v[144:147], v[48:63]
    v_exp_f32 v103, v103
    v_exp_f32 v104, v104
    v_exp_f32 v105, v105
    v_exp_f32 v106, v106
    v_exp_f32 v107, v107
    v_smfmac_f32_32x32x32_bf16 v[128:143], v[152:155], v[96:103], v184
    v_exp_f32 v108, v108
    v_exp_f32 v109, v109
    v_exp_f32 v110, v110
    v_exp_f32 v111, v111
    v_exp_f32 v80, v80
    v_exp_f32 v81, v81
    v_smfmac_f32_32x32x32_bf16 v[128:143], v[156:159], v[104:111], v184
    v_exp_f32 v82, v82
    v_exp_f32 v83, v83
    v_exp_f32 v84, v84
    ds_read_b128 v[32:35], v3 offset:2048
    ds_read_b128 v[152:155], v12 offset:2048
    ds_read_b128 v[156:159], v12 offset:2560
    v_exp_f32 v85, v85
    v_exp_f32 v86, v86
    v_mfma_f32_32x32x16_bf16 v[96:111], v[36:39], v[148:151], v[64:79]
    v_exp_f32 v87, v87
    v_exp_f32 v88, v88
    v_exp_f32 v89, v89
    v_exp_f32 v90, v90
    v_exp_f32 v91, v91
    v_smfmac_f32_32x32x32_bf16 v[112:127], v[160:163], v[80:87], v184
    v_exp_f32 v92, v92
    v_exp_f32 v93, v93
    v_exp_f32 v94, v94
    v_exp_f32 v95, v95
    v_exp_f32 v96, v96
    v_exp_f32 v97, v97
    v_smfmac_f32_32x32x32_bf16 v[112:127], v[164:167], v[88:95], v184
    v_exp_f32 v98, v98
    v_exp_f32 v99, v99
    v_exp_f32 v100, v100
    v_exp_f32 v101, v101
    s_waitcnt lgkmcnt(0)
    v_exp_f32 v102, v102
    v_mfma_f32_32x32x16_bf16 v[80:95], v[32:35], v[144:147], v[48:63]
    v_exp_f32 v103, v103
    v_exp_f32 v104, v104
    v_exp_f32 v105, v105
    v_exp_f32 v106, v106
    v_exp_f32 v107, v107
    v_smfmac_f32_32x32x32_bf16 v[128:143], v[160:163], v[96:103], v184
    v_exp_f32 v108, v108
    v_exp_f32 v109, v109
    v_exp_f32 v110, v110
    v_exp_f32 v111, v111
    v_exp_f32 v80, v80
    v_exp_f32 v81, v81
    v_smfmac_f32_32x32x32_bf16 v[128:143], v[164:167], v[104:111], v184
    v_exp_f32 v82, v82
    v_exp_f32 v83, v83
    v_exp_f32 v84, v84
    ds_read_b128 v[36:39], v3 offset:3072
    ds_read_b128 v[160:163], v12 offset:3072
    ds_read_b128 v[164:167], v12 offset:3584
    v_exp_f32 v85, v85
    v_exp_f32 v86, v86
    v_mfma_f32_32x32x16_bf16 v[96:111], v[32:35], v[148:151], v[64:79]
    v_exp_f32 v87, v87
    v_exp_f32 v88, v88
    v_exp_f32 v89, v89
    v_exp_f32 v90, v90
    v_exp_f32 v91, v91
    v_smfmac_f32_32x32x32_bf16 v[112:127], v[152:155], v[80:87], v184
    v_exp_f32 v92, v92
    v_exp_f32 v93, v93
    v_exp_f32 v94, v94
    v_exp_f32 v95, v95
    v_exp_f32 v96, v96
    v_exp_f32 v97, v97
    v_smfmac_f32_32x32x32_bf16 v[112:127], v[156:159], v[88:95], v184
    v_exp_f32 v98, v98
    v_exp_f32 v99, v99
    v_exp_f32 v100, v100
    v_exp_f32 v101, v101
    s_waitcnt lgkmcnt(0)
    v_exp_f32 v102, v102
    v_mfma_f32_32x32x16_bf16 v[80:95], v[36:39], v[144:147], v[48:63]
    v_exp_f32 v103, v103
    v_exp_f32 v104, v104
    v_exp_f32 v105, v105
    v_exp_f32 v106, v106
    v_exp_f32 v107, v107
    v_smfmac_f32_32x32x32_bf16 v[128:143], v[152:155], v[96:103], v184
    v_exp_f32 v108, v108
    v_exp_f32 v109, v109
    v_exp_f32 v110, v110
    v_exp_f32 v111, v111
    v_exp_f32 v80, v80
    v_exp_f32 v81, v81
    v_smfmac_f32_32x32x32_bf16 v[128:143], v[156:159], v[104:111], v184
    v_exp_f32 v82, v82
    v_exp_f32 v83, v83
    v_exp_f32 v84, v84
    ds_read_b128 v[32:35], v3 offset:4096
    ds_read_b128 v[152:155], v13 offset:0
    ds_read_b128 v[156:159], v13 offset:512
    v_exp_f32 v85, v85
    v_exp_f32 v86, v86
    v_mfma_f32_32x32x16_bf16 v[96:111], v[36:39], v[148:151], v[64:79]
    v_exp_f32 v87, v87
    v_exp_f32 v88, v88
    v_exp_f32 v89, v89
    v_exp_f32 v90, v90
    v_exp_f32 v91, v91
    v_smfmac_f32_32x32x32_bf16 v[112:127], v[160:163], v[80:87], v184
    v_exp_f32 v92, v92
    v_exp_f32 v93, v93
    v_exp_f32 v94, v94
    v_exp_f32 v95, v95
    v_exp_f32 v96, v96
    v_exp_f32 v97, v97
    v_smfmac_f32_32x32x32_bf16 v[112:127], v[164:167], v[88:95], v184
    v_exp_f32 v98, v98
    v_exp_f32 v99, v99
    v_exp_f32 v100, v100
    v_exp_f32 v101, v101
    s_waitcnt lgkmcnt(0)
    v_exp_f32 v102, v102
    v_mfma_f32_32x32x16_bf16 v[80:95], v[32:35], v[144:147], v[48:63]
    v_exp_f32 v103, v103
    v_exp_f32 v104, v104
    v_exp_f32 v105, v105
    v_exp_f32 v106, v106
    v_exp_f32 v107, v107
    v_smfmac_f32_32x32x32_bf16 v[128:143], v[160:163], v[96:103], v184
    v_exp_f32 v108, v108
    v_exp_f32 v109, v109
    v_exp_f32 v110, v110
    v_exp_f32 v111, v111
    v_exp_f32 v80, v80
    v_exp_f32 v81, v81
    v_smfmac_f32_32x32x32_bf16 v[128:143], v[164:167], v[104:111], v184
    v_exp_f32 v82, v82
    v_exp_f32 v83, v83
    v_exp_f32 v84, v84
    ds_read_b128 v[36:39], v3 offset:5120
    ds_read_b128 v[160:163], v13 offset:1024
    ds_read_b128 v[164:167], v13 offset:1536
    v_exp_f32 v85, v85
    v_exp_f32 v86, v86
    v_mfma_f32_32x32x16_bf16 v[96:111], v[32:35], v[148:151], v[64:79]
    v_exp_f32 v87, v87
    v_exp_f32 v88, v88
    s_mov_b32 s71, 8192
    v_mad_u32_u24 v12, v9, s71, v5
    s_waitcnt vmcnt(0)
    v_exp_f32 v89, v89
    ds_write_b128 v8, v[224:227] offset:32768
    v_exp_f32 v90, v90
    v_exp_f32 v91, v91
    v_smfmac_f32_32x32x32_bf16 v[112:127], v[152:155], v[80:87], v184
    v_exp_f32 v92, v92
    v_exp_f32 v93, v93
    v_exp_f32 v94, v94
    v_exp_f32 v95, v95
    ds_write_b128 v8, v[228:231] offset:49152
    v_exp_f32 v96, v96
    v_exp_f32 v97, v97
    v_smfmac_f32_32x32x32_bf16 v[112:127], v[156:159], v[88:95], v184
    v_exp_f32 v98, v98
    v_exp_f32 v99, v99
    v_exp_f32 v100, v100
    v_exp_f32 v101, v101
    s_waitcnt lgkmcnt(0)
    v_exp_f32 v102, v102
    v_mfma_f32_32x32x16_bf16 v[80:95], v[36:39], v[144:147], v[48:63]
    v_exp_f32 v103, v103
    v_exp_f32 v104, v104
    v_exp_f32 v105, v105
    v_exp_f32 v106, v106
    v_exp_f32 v107, v107
    v_smfmac_f32_32x32x32_bf16 v[128:143], v[152:155], v[96:103], v184
    v_exp_f32 v108, v108
    v_exp_f32 v109, v109
    v_exp_f32 v110, v110
    v_exp_f32 v111, v111
    v_exp_f32 v80, v80
    v_exp_f32 v81, v81
    v_smfmac_f32_32x32x32_bf16 v[128:143], v[156:159], v[104:111], v184
    v_exp_f32 v82, v82
    v_exp_f32 v83, v83
    v_exp_f32 v84, v84
    ds_read_b128 v[32:35], v3 offset:6144
    ds_read_b128 v[152:155], v13 offset:2048
    ds_read_b128 v[156:159], v13 offset:2560
    v_exp_f32 v85, v85
    v_exp_f32 v86, v86
    v_mfma_f32_32x32x16_bf16 v[96:111], v[36:39], v[148:151], v[64:79]
    v_exp_f32 v87, v87
    v_exp_f32 v88, v88
    v_exp_f32 v89, v89
    ds_write_b128 v8, v[232:235] offset:36864
    v_exp_f32 v90, v90
    v_exp_f32 v91, v91
    v_smfmac_f32_32x32x32_bf16 v[112:127], v[160:163], v[80:87], v184
    v_exp_f32 v92, v92
    v_exp_f32 v93, v93
    v_exp_f32 v94, v94
    v_exp_f32 v95, v95
    ds_write_b128 v8, v[236:239] offset:53248
    v_exp_f32 v96, v96
    v_exp_f32 v97, v97
    v_smfmac_f32_32x32x32_bf16 v[112:127], v[164:167], v[88:95], v184
    v_exp_f32 v98, v98
    v_exp_f32 v99, v99
    v_exp_f32 v100, v100
    v_exp_f32 v101, v101
    s_waitcnt lgkmcnt(0)
    v_exp_f32 v102, v102
    v_mfma_f32_32x32x16_bf16 v[80:95], v[32:35], v[144:147], v[48:63]
    v_exp_f32 v103, v103
    v_exp_f32 v104, v104
    v_exp_f32 v105, v105
    v_exp_f32 v106, v106
    v_exp_f32 v107, v107
    v_smfmac_f32_32x32x32_bf16 v[128:143], v[160:163], v[96:103], v184
    v_exp_f32 v108, v108
    v_exp_f32 v109, v109
    v_exp_f32 v110, v110
    v_exp_f32 v111, v111
    v_exp_f32 v80, v80
    v_exp_f32 v81, v81
    v_smfmac_f32_32x32x32_bf16 v[128:143], v[164:167], v[104:111], v184
    v_exp_f32 v82, v82
    v_exp_f32 v83, v83
    v_exp_f32 v84, v84
    ds_read_b128 v[36:39], v3 offset:7168
    ds_read_b128 v[160:163], v13 offset:3072
    ds_read_b128 v[164:167], v13 offset:3584
    v_exp_f32 v85, v85
    v_exp_f32 v86, v86
    v_mfma_f32_32x32x16_bf16 v[96:111], v[32:35], v[148:151], v[64:79]
    v_exp_f32 v87, v87
    v_exp_f32 v88, v88
    v_exp_f32 v89, v89
    ds_write_b128 v8, v[240:243] offset:40960
    v_exp_f32 v90, v90
    v_exp_f32 v91, v91
    v_smfmac_f32_32x32x32_bf16 v[112:127], v[152:155], v[80:87], v184
    v_exp_f32 v92, v92
    v_exp_f32 v93, v93
    v_exp_f32 v94, v94
    v_exp_f32 v95, v95
    ds_write_b128 v8, v[244:247] offset:57344
    v_exp_f32 v96, v96
    v_exp_f32 v97, v97
    v_smfmac_f32_32x32x32_bf16 v[112:127], v[156:159], v[88:95], v184
    v_exp_f32 v98, v98
    v_exp_f32 v99, v99
    v_exp_f32 v100, v100
    v_exp_f32 v101, v101
    s_waitcnt lgkmcnt(0)
    v_exp_f32 v102, v102
    v_mfma_f32_32x32x16_bf16 v[80:95], v[36:39], v[144:147], v[48:63]
    v_exp_f32 v103, v103
    v_exp_f32 v104, v104
    v_exp_f32 v105, v105
    v_exp_f32 v106, v106
    v_exp_f32 v107, v107
    v_smfmac_f32_32x32x32_bf16 v[128:143], v[152:155], v[96:103], v184
    v_exp_f32 v108, v108
    v_exp_f32 v109, v109
    v_exp_f32 v110, v110
    v_exp_f32 v111, v111
    v_exp_f32 v80, v80
    v_exp_f32 v81, v81
    v_smfmac_f32_32x32x32_bf16 v[128:143], v[156:159], v[104:111], v184
    v_exp_f32 v82, v82
    v_exp_f32 v83, v83
    v_exp_f32 v84, v84
    ds_read_b128 v[32:35], v3 offset:8192
    ds_read_b128 v[152:155], v12 offset:0
    ds_read_b128 v[156:159], v12 offset:512
    v_exp_f32 v85, v85
    v_exp_f32 v86, v86
    v_mfma_f32_32x32x16_bf16 v[96:111], v[36:39], v[148:151], v[64:79]
    v_exp_f32 v87, v87
    v_exp_f32 v88, v88
    v_exp_f32 v89, v89
    ds_write_b128 v8, v[248:251] offset:45056
    v_exp_f32 v90, v90
    v_exp_f32 v91, v91
    v_smfmac_f32_32x32x32_bf16 v[112:127], v[160:163], v[80:87], v184
    v_exp_f32 v92, v92
    v_exp_f32 v93, v93
    v_exp_f32 v94, v94
    v_exp_f32 v95, v95
    ds_write_b128 v8, v[252:255] offset:61440
    v_exp_f32 v96, v96
    v_exp_f32 v97, v97
    v_smfmac_f32_32x32x32_bf16 v[112:127], v[164:167], v[88:95], v184
    v_exp_f32 v98, v98
    v_exp_f32 v99, v99
    v_exp_f32 v100, v100
    v_exp_f32 v101, v101
    s_waitcnt lgkmcnt(0)
    v_exp_f32 v102, v102
    v_mfma_f32_32x32x16_bf16 v[80:95], v[32:35], v[144:147], v[48:63]
    v_exp_f32 v103, v103
    v_exp_f32 v104, v104
    v_exp_f32 v105, v105
    v_exp_f32 v106, v106
    v_exp_f32 v107, v107
    v_smfmac_f32_32x32x32_bf16 v[128:143], v[160:163], v[96:103], v184
    v_exp_f32 v108, v108
    v_exp_f32 v109, v109
    v_exp_f32 v110, v110
    v_exp_f32 v111, v111
    v_exp_f32 v80, v80
    v_exp_f32 v81, v81
    v_smfmac_f32_32x32x32_bf16 v[128:143], v[164:167], v[104:111], v184
    v_exp_f32 v82, v82
    v_exp_f32 v83, v83
    v_exp_f32 v84, v84
    ds_read_b128 v[36:39], v3 offset:9216
    ds_read_b128 v[160:163], v12 offset:1024
    ds_read_b128 v[164:167], v12 offset:1536
    v_exp_f32 v85, v85
    v_exp_f32 v86, v86
    v_mfma_f32_32x32x16_bf16 v[96:111], v[32:35], v[148:151], v[64:79]
    v_exp_f32 v87, v87
    v_exp_f32 v88, v88
    s_mov_b32 s71, 12288
    v_mad_u32_u24 v13, v9, s71, v5
    v_exp_f32 v89, v89
    v_exp_f32 v90, v90
    v_exp_f32 v91, v91
    v_smfmac_f32_32x32x32_bf16 v[112:127], v[152:155], v[80:87], v184
    v_exp_f32 v92, v92
    v_exp_f32 v93, v93
    v_exp_f32 v94, v94
    v_exp_f32 v95, v95
    v_exp_f32 v96, v96
    v_exp_f32 v97, v97
    v_smfmac_f32_32x32x32_bf16 v[112:127], v[156:159], v[88:95], v184
    v_exp_f32 v98, v98
    v_exp_f32 v99, v99
    v_exp_f32 v100, v100
    v_exp_f32 v101, v101
    s_waitcnt lgkmcnt(0)
    v_exp_f32 v102, v102
    v_mfma_f32_32x32x16_bf16 v[80:95], v[36:39], v[144:147], v[48:63]
    v_exp_f32 v103, v103
    v_exp_f32 v104, v104
    v_exp_f32 v105, v105
    v_exp_f32 v106, v106
    v_exp_f32 v107, v107
    v_smfmac_f32_32x32x32_bf16 v[128:143], v[152:155], v[96:103], v184
    v_exp_f32 v108, v108
    v_exp_f32 v109, v109
    v_exp_f32 v110, v110
    v_exp_f32 v111, v111
    v_exp_f32 v80, v80
    v_exp_f32 v81, v81
    v_smfmac_f32_32x32x32_bf16 v[128:143], v[156:159], v[104:111], v184
    v_exp_f32 v82, v82
    v_exp_f32 v83, v83
    v_exp_f32 v84, v84
    ds_read_b128 v[32:35], v3 offset:10240
    ds_read_b128 v[152:155], v12 offset:2048
    ds_read_b128 v[156:159], v12 offset:2560
    v_exp_f32 v85, v85
    v_exp_f32 v86, v86
    v_mfma_f32_32x32x16_bf16 v[96:111], v[36:39], v[148:151], v[64:79]
    v_exp_f32 v87, v87
    v_exp_f32 v88, v88
    v_exp_f32 v89, v89
    v_exp_f32 v90, v90
    v_exp_f32 v91, v91
    v_smfmac_f32_32x32x32_bf16 v[112:127], v[160:163], v[80:87], v184
    v_exp_f32 v92, v92
    v_exp_f32 v93, v93
    v_exp_f32 v94, v94
    v_exp_f32 v95, v95
    v_exp_f32 v96, v96
    v_exp_f32 v97, v97
    v_smfmac_f32_32x32x32_bf16 v[112:127], v[164:167], v[88:95], v184
    v_exp_f32 v98, v98
    v_exp_f32 v99, v99
    v_exp_f32 v100, v100
    v_exp_f32 v101, v101
    s_waitcnt lgkmcnt(0)
    v_exp_f32 v102, v102
    v_mfma_f32_32x32x16_bf16 v[80:95], v[32:35], v[144:147], v[48:63]
    v_exp_f32 v103, v103
    v_exp_f32 v104, v104
    v_exp_f32 v105, v105
    v_exp_f32 v106, v106
    v_exp_f32 v107, v107
    v_smfmac_f32_32x32x32_bf16 v[128:143], v[160:163], v[96:103], v184
    v_exp_f32 v108, v108
    v_exp_f32 v109, v109
    v_exp_f32 v110, v110
    v_exp_f32 v111, v111
    v_exp_f32 v80, v80
    v_exp_f32 v81, v81
    v_smfmac_f32_32x32x32_bf16 v[128:143], v[164:167], v[104:111], v184
    v_exp_f32 v82, v82
    v_exp_f32 v83, v83
    v_exp_f32 v84, v84
    ds_read_b128 v[36:39], v3 offset:11264
    ds_read_b128 v[160:163], v12 offset:3072
    ds_read_b128 v[164:167], v12 offset:3584
    v_exp_f32 v85, v85
    v_exp_f32 v86, v86
    v_mfma_f32_32x32x16_bf16 v[96:111], v[32:35], v[148:151], v[64:79]
    v_exp_f32 v87, v87
    v_exp_f32 v88, v88
    v_exp_f32 v89, v89
    v_exp_f32 v90, v90
    v_exp_f32 v91, v91
    v_smfmac_f32_32x32x32_bf16 v[112:127], v[152:155], v[80:87], v184
    v_exp_f32 v92, v92
    v_exp_f32 v93, v93
    v_exp_f32 v94, v94
    v_exp_f32 v95, v95
    v_exp_f32 v96, v96
    v_exp_f32 v97, v97
    v_smfmac_f32_32x32x32_bf16 v[112:127], v[156:159], v[88:95], v184
    v_exp_f32 v98, v98
    v_exp_f32 v99, v99
    v_exp_f32 v100, v100
    v_exp_f32 v101, v101
    s_waitcnt lgkmcnt(0)
    v_exp_f32 v102, v102
    v_mfma_f32_32x32x16_bf16 v[80:95], v[36:39], v[144:147], v[48:63]
    v_exp_f32 v103, v103
    v_exp_f32 v104, v104
    v_exp_f32 v105, v105
    v_exp_f32 v106, v106
    v_exp_f32 v107, v107
    v_smfmac_f32_32x32x32_bf16 v[128:143], v[152:155], v[96:103], v184
    v_exp_f32 v108, v108
    v_exp_f32 v109, v109
    v_exp_f32 v110, v110
    v_exp_f32 v111, v111
    v_exp_f32 v80, v80
    v_exp_f32 v81, v81
    v_smfmac_f32_32x32x32_bf16 v[128:143], v[156:159], v[104:111], v184
    v_exp_f32 v82, v82
    v_exp_f32 v83, v83
    v_exp_f32 v84, v84
    ds_read_b128 v[32:35], v3 offset:12288
    ds_read_b128 v[152:155], v13 offset:0
    ds_read_b128 v[156:159], v13 offset:512
    v_exp_f32 v85, v85
    v_exp_f32 v86, v86
    v_mfma_f32_32x32x16_bf16 v[96:111], v[36:39], v[148:151], v[64:79]
    v_exp_f32 v87, v87
    v_exp_f32 v88, v88
    v_exp_f32 v89, v89
    v_exp_f32 v90, v90
    v_exp_f32 v91, v91
    v_smfmac_f32_32x32x32_bf16 v[112:127], v[160:163], v[80:87], v184
    v_exp_f32 v92, v92
    v_exp_f32 v93, v93
    v_exp_f32 v94, v94
    v_exp_f32 v95, v95
    v_exp_f32 v96, v96
    v_exp_f32 v97, v97
    v_smfmac_f32_32x32x32_bf16 v[112:127], v[164:167], v[88:95], v184
    v_exp_f32 v98, v98
    v_exp_f32 v99, v99
    v_exp_f32 v100, v100
    v_exp_f32 v101, v101
    s_waitcnt lgkmcnt(0)
    v_exp_f32 v102, v102
    v_mfma_f32_32x32x16_bf16 v[80:95], v[32:35], v[144:147], v[48:63]
    v_exp_f32 v103, v103
    v_exp_f32 v104, v104
    v_exp_f32 v105, v105
    v_exp_f32 v106, v106
    v_exp_f32 v107, v107
    v_smfmac_f32_32x32x32_bf16 v[128:143], v[160:163], v[96:103], v184
    v_exp_f32 v108, v108
    v_exp_f32 v109, v109
    v_exp_f32 v110, v110
    v_exp_f32 v111, v111
    v_exp_f32 v80, v80
    s_barrier
    v_exp_f32 v81, v81
    v_smfmac_f32_32x32x32_bf16 v[128:143], v[164:167], v[104:111], v184
    v_exp_f32 v82, v82
    v_exp_f32 v83, v83
    v_exp_f32 v84, v84
    ds_read_b128 v[36:39], v3 offset:13312
    ds_read_b128 v[160:163], v13 offset:1024
    ds_read_b128 v[164:167], v13 offset:1536
    v_exp_f32 v85, v85
    v_exp_f32 v86, v86
    v_mfma_f32_32x32x16_bf16 v[96:111], v[32:35], v[148:151], v[64:79]
    v_exp_f32 v87, v87
    v_exp_f32 v88, v88
    s_mov_b32 s71, 32768
    v_mad_u32_u24 v12, v9, s71, v5
    v_exp_f32 v89, v89
    v_exp_f32 v90, v90
    v_exp_f32 v91, v91
    v_smfmac_f32_32x32x32_bf16 v[112:127], v[152:155], v[80:87], v184
    v_exp_f32 v92, v92
    v_exp_f32 v93, v93
    v_exp_f32 v94, v94
    v_exp_f32 v95, v95
    v_exp_f32 v96, v96
    v_exp_f32 v97, v97
    v_smfmac_f32_32x32x32_bf16 v[112:127], v[156:159], v[88:95], v184
    v_exp_f32 v98, v98
    v_exp_f32 v99, v99
    v_exp_f32 v100, v100
    v_exp_f32 v101, v101
    s_waitcnt lgkmcnt(0)
    v_exp_f32 v102, v102
    v_mfma_f32_32x32x16_bf16 v[80:95], v[36:39], v[144:147], v[48:63]
    v_exp_f32 v103, v103
    v_exp_f32 v104, v104
    v_exp_f32 v105, v105
    v_exp_f32 v106, v106
    v_exp_f32 v107, v107
    v_smfmac_f32_32x32x32_bf16 v[128:143], v[152:155], v[96:103], v184
    v_exp_f32 v108, v108
    v_exp_f32 v109, v109
    v_exp_f32 v110, v110
    v_exp_f32 v111, v111
    v_exp_f32 v80, v80
    v_exp_f32 v81, v81
    v_smfmac_f32_32x32x32_bf16 v[128:143], v[156:159], v[104:111], v184
    v_exp_f32 v82, v82
    v_exp_f32 v83, v83
    v_exp_f32 v84, v84
    ds_read_b128 v[32:35], v3 offset:14336
    ds_read_b128 v[152:155], v13 offset:2048
    ds_read_b128 v[156:159], v13 offset:2560
    v_exp_f32 v85, v85
    v_exp_f32 v86, v86
    v_mfma_f32_32x32x16_bf16 v[96:111], v[36:39], v[148:151], v[64:79]
    v_exp_f32 v87, v87
    v_exp_f32 v88, v88
    v_exp_f32 v89, v89
    v_exp_f32 v90, v90
    v_exp_f32 v91, v91
    v_smfmac_f32_32x32x32_bf16 v[112:127], v[160:163], v[80:87], v184
    v_exp_f32 v92, v92
    v_exp_f32 v93, v93
    v_exp_f32 v94, v94
    v_exp_f32 v95, v95
    v_exp_f32 v96, v96
    v_exp_f32 v97, v97
    v_smfmac_f32_32x32x32_bf16 v[112:127], v[164:167], v[88:95], v184
    v_exp_f32 v98, v98
    v_exp_f32 v99, v99
    v_exp_f32 v100, v100
    v_exp_f32 v101, v101
    s_waitcnt lgkmcnt(0)
    v_exp_f32 v102, v102
    v_mfma_f32_32x32x16_bf16 v[80:95], v[32:35], v[144:147], v[48:63]
    v_exp_f32 v103, v103
    v_exp_f32 v104, v104
    v_exp_f32 v105, v105
    v_exp_f32 v106, v106
    v_exp_f32 v107, v107
    v_smfmac_f32_32x32x32_bf16 v[128:143], v[160:163], v[96:103], v184
    v_exp_f32 v108, v108
    v_exp_f32 v109, v109
    v_exp_f32 v110, v110
    v_exp_f32 v111, v111
    v_exp_f32 v80, v80
    v_exp_f32 v81, v81
    v_smfmac_f32_32x32x32_bf16 v[128:143], v[164:167], v[104:111], v184
    v_exp_f32 v82, v82
    v_exp_f32 v83, v83
    v_exp_f32 v84, v84
    ds_read_b128 v[36:39], v3 offset:15360
    ds_read_b128 v[160:163], v13 offset:3072
    ds_read_b128 v[164:167], v13 offset:3584
    v_exp_f32 v85, v85
    v_exp_f32 v86, v86
    v_mfma_f32_32x32x16_bf16 v[96:111], v[32:35], v[148:151], v[64:79]
    v_exp_f32 v87, v87
    v_exp_f32 v88, v88
    v_exp_f32 v89, v89
    v_exp_f32 v90, v90
    v_exp_f32 v91, v91
    v_smfmac_f32_32x32x32_bf16 v[112:127], v[152:155], v[80:87], v184
    v_exp_f32 v92, v92
    v_exp_f32 v93, v93
    v_exp_f32 v94, v94
    v_exp_f32 v95, v95
    v_exp_f32 v96, v96
    v_exp_f32 v97, v97
    v_smfmac_f32_32x32x32_bf16 v[112:127], v[156:159], v[88:95], v184
    v_exp_f32 v98, v98
    v_exp_f32 v99, v99
    v_exp_f32 v100, v100
    v_exp_f32 v101, v101
    s_waitcnt lgkmcnt(0)
    v_exp_f32 v102, v102
    v_mfma_f32_32x32x16_bf16 v[80:95], v[36:39], v[144:147], v[48:63]
    v_exp_f32 v103, v103
    v_exp_f32 v104, v104
    v_exp_f32 v105, v105
    v_exp_f32 v106, v106
    v_exp_f32 v107, v107
    v_smfmac_f32_32x32x32_bf16 v[128:143], v[152:155], v[96:103], v184
    v_exp_f32 v108, v108
    v_exp_f32 v109, v109
    v_exp_f32 v110, v110
    v_exp_f32 v111, v111
    v_exp_f32 v80, v80
    v_exp_f32 v81, v81
    v_smfmac_f32_32x32x32_bf16 v[128:143], v[156:159], v[104:111], v184
    v_exp_f32 v82, v82
    v_exp_f32 v83, v83
    v_exp_f32 v84, v84
    ds_read_b128 v[32:35], v3 offset:32768
    ds_read_b128 v[152:155], v12 offset:0
    ds_read_b128 v[156:159], v12 offset:512
    v_exp_f32 v85, v85
    v_exp_f32 v86, v86
    v_mfma_f32_32x32x16_bf16 v[96:111], v[36:39], v[148:151], v[64:79]
    v_exp_f32 v87, v87
    v_exp_f32 v88, v88
    v_exp_f32 v89, v89
    v_exp_f32 v90, v90
    v_exp_f32 v91, v91
    v_smfmac_f32_32x32x32_bf16 v[112:127], v[160:163], v[80:87], v184
    v_exp_f32 v92, v92
    v_exp_f32 v93, v93
    v_exp_f32 v94, v94
    v_exp_f32 v95, v95
    v_exp_f32 v96, v96
    v_exp_f32 v97, v97
    v_smfmac_f32_32x32x32_bf16 v[112:127], v[164:167], v[88:95], v184
    v_exp_f32 v98, v98
    v_exp_f32 v99, v99
    v_exp_f32 v100, v100
    v_exp_f32 v101, v101
    s_waitcnt lgkmcnt(0)
    v_exp_f32 v102, v102
    v_mfma_f32_32x32x16_bf16 v[80:95], v[32:35], v[144:147], v[48:63]
    v_exp_f32 v103, v103
    v_exp_f32 v104, v104
    v_exp_f32 v105, v105
    v_exp_f32 v106, v106
    v_exp_f32 v107, v107
    v_smfmac_f32_32x32x32_bf16 v[128:143], v[160:163], v[96:103], v184
    v_exp_f32 v108, v108
    v_exp_f32 v109, v109
    v_exp_f32 v110, v110
    v_exp_f32 v111, v111
    v_exp_f32 v80, v80
    v_exp_f32 v81, v81
    v_smfmac_f32_32x32x32_bf16 v[128:143], v[164:167], v[104:111], v184
    v_exp_f32 v82, v82
    v_exp_f32 v83, v83
    v_exp_f32 v84, v84
    ds_read_b128 v[36:39], v3 offset:33792
    ds_read_b128 v[160:163], v12 offset:1024
    ds_read_b128 v[164:167], v12 offset:1536
    v_exp_f32 v85, v85
    v_exp_f32 v86, v86
    v_mfma_f32_32x32x16_bf16 v[96:111], v[32:35], v[148:151], v[64:79]
    v_exp_f32 v87, v87
    v_exp_f32 v88, v88
    s_mov_b32 s71, 36864
    v_mad_u32_u24 v13, v9, s71, v5
    v_exp_f32 v89, v89
    v_exp_f32 v90, v90
    v_exp_f32 v91, v91
    v_smfmac_f32_32x32x32_bf16 v[112:127], v[152:155], v[80:87], v184
    v_exp_f32 v92, v92
    v_exp_f32 v93, v93
    v_exp_f32 v94, v94
    v_exp_f32 v95, v95
    v_exp_f32 v96, v96
    v_exp_f32 v97, v97
    v_smfmac_f32_32x32x32_bf16 v[112:127], v[156:159], v[88:95], v184
    v_exp_f32 v98, v98
    v_exp_f32 v99, v99
    v_exp_f32 v100, v100
    v_exp_f32 v101, v101
    s_waitcnt lgkmcnt(0)
    v_exp_f32 v102, v102
    v_mfma_f32_32x32x16_bf16 v[80:95], v[36:39], v[144:147], v[48:63]
    v_exp_f32 v103, v103
    v_exp_f32 v104, v104
    v_exp_f32 v105, v105
    v_exp_f32 v106, v106
    v_exp_f32 v107, v107
    v_smfmac_f32_32x32x32_bf16 v[128:143], v[152:155], v[96:103], v184
    v_exp_f32 v108, v108
    v_exp_f32 v109, v109
    v_exp_f32 v110, v110
    v_exp_f32 v111, v111
    v_exp_f32 v80, v80
    v_exp_f32 v81, v81
    v_smfmac_f32_32x32x32_bf16 v[128:143], v[156:159], v[104:111], v184
    v_exp_f32 v82, v82
    v_exp_f32 v83, v83
    v_exp_f32 v84, v84
    ds_read_b128 v[32:35], v3 offset:34816
    ds_read_b128 v[152:155], v12 offset:2048
    ds_read_b128 v[156:159], v12 offset:2560
    v_exp_f32 v85, v85
    v_exp_f32 v86, v86
    v_mfma_f32_32x32x16_bf16 v[96:111], v[36:39], v[148:151], v[64:79]
    v_exp_f32 v87, v87
    v_exp_f32 v88, v88
    v_exp_f32 v89, v89
    v_exp_f32 v90, v90
    v_exp_f32 v91, v91
    v_smfmac_f32_32x32x32_bf16 v[112:127], v[160:163], v[80:87], v184
    v_exp_f32 v92, v92
    v_exp_f32 v93, v93
    v_exp_f32 v94, v94
    v_exp_f32 v95, v95
    v_exp_f32 v96, v96
    v_exp_f32 v97, v97
    v_smfmac_f32_32x32x32_bf16 v[112:127], v[164:167], v[88:95], v184
    v_exp_f32 v98, v98
    v_exp_f32 v99, v99
    v_exp_f32 v100, v100
    v_exp_f32 v101, v101
    s_waitcnt lgkmcnt(0)
    v_exp_f32 v102, v102
    v_mfma_f32_32x32x16_bf16 v[80:95], v[32:35], v[144:147], v[48:63]
    v_exp_f32 v103, v103
    v_exp_f32 v104, v104
    v_exp_f32 v105, v105
    v_exp_f32 v106, v106
    v_exp_f32 v107, v107
    v_smfmac_f32_32x32x32_bf16 v[128:143], v[160:163], v[96:103], v184
    v_exp_f32 v108, v108
    v_exp_f32 v109, v109
    v_exp_f32 v110, v110
    v_exp_f32 v111, v111
    v_exp_f32 v80, v80
    v_exp_f32 v81, v81
    v_smfmac_f32_32x32x32_bf16 v[128:143], v[164:167], v[104:111], v184
    v_exp_f32 v82, v82
    v_exp_f32 v83, v83
    v_exp_f32 v84, v84
    ds_read_b128 v[36:39], v3 offset:35840
    ds_read_b128 v[160:163], v12 offset:3072
    ds_read_b128 v[164:167], v12 offset:3584
    v_exp_f32 v85, v85
    v_exp_f32 v86, v86
    v_mfma_f32_32x32x16_bf16 v[96:111], v[32:35], v[148:151], v[64:79]
    v_exp_f32 v87, v87
    v_exp_f32 v88, v88
    v_exp_f32 v89, v89
    v_exp_f32 v90, v90
    v_exp_f32 v91, v91
    v_smfmac_f32_32x32x32_bf16 v[112:127], v[152:155], v[80:87], v184
    v_exp_f32 v92, v92
    v_exp_f32 v93, v93
    v_exp_f32 v94, v94
    v_exp_f32 v95, v95
    v_exp_f32 v96, v96
    v_exp_f32 v97, v97
    v_smfmac_f32_32x32x32_bf16 v[112:127], v[156:159], v[88:95], v184
    v_exp_f32 v98, v98
    v_exp_f32 v99, v99
    v_exp_f32 v100, v100
    v_exp_f32 v101, v101
    s_waitcnt lgkmcnt(0)
    v_exp_f32 v102, v102
    v_mfma_f32_32x32x16_bf16 v[80:95], v[36:39], v[144:147], v[48:63]
    v_exp_f32 v103, v103
    v_exp_f32 v104, v104
    v_exp_f32 v105, v105
    v_exp_f32 v106, v106
    v_exp_f32 v107, v107
    v_smfmac_f32_32x32x32_bf16 v[128:143], v[152:155], v[96:103], v184
    v_exp_f32 v108, v108
    v_exp_f32 v109, v109
    v_exp_f32 v110, v110
    v_exp_f32 v111, v111
    v_exp_f32 v80, v80
    v_exp_f32 v81, v81
    v_smfmac_f32_32x32x32_bf16 v[128:143], v[156:159], v[104:111], v184
    v_exp_f32 v82, v82
    v_exp_f32 v83, v83
    v_exp_f32 v84, v84
    ds_read_b128 v[32:35], v3 offset:36864
    ds_read_b128 v[152:155], v13 offset:0
    ds_read_b128 v[156:159], v13 offset:512
    v_exp_f32 v85, v85
    v_exp_f32 v86, v86
    v_mfma_f32_32x32x16_bf16 v[96:111], v[36:39], v[148:151], v[64:79]
    v_exp_f32 v87, v87
    v_exp_f32 v88, v88
    v_exp_f32 v89, v89
    v_exp_f32 v90, v90
    v_exp_f32 v91, v91
    v_smfmac_f32_32x32x32_bf16 v[112:127], v[160:163], v[80:87], v184
    v_exp_f32 v92, v92
    v_exp_f32 v93, v93
    v_exp_f32 v94, v94
    v_exp_f32 v95, v95
    v_exp_f32 v96, v96
    v_exp_f32 v97, v97
    v_smfmac_f32_32x32x32_bf16 v[112:127], v[164:167], v[88:95], v184
    v_exp_f32 v98, v98
    v_exp_f32 v99, v99
    v_exp_f32 v100, v100
    v_exp_f32 v101, v101
    s_waitcnt lgkmcnt(0)
    v_exp_f32 v102, v102
    v_mfma_f32_32x32x16_bf16 v[80:95], v[32:35], v[144:147], v[48:63]
    v_exp_f32 v103, v103
    v_exp_f32 v104, v104
    v_exp_f32 v105, v105
    v_exp_f32 v106, v106
    v_exp_f32 v107, v107
    v_smfmac_f32_32x32x32_bf16 v[128:143], v[160:163], v[96:103], v184
    v_exp_f32 v108, v108
    v_exp_f32 v109, v109
    v_exp_f32 v110, v110
    v_exp_f32 v111, v111
    v_exp_f32 v80, v80
    v_exp_f32 v81, v81
    v_smfmac_f32_32x32x32_bf16 v[128:143], v[164:167], v[104:111], v184
    v_exp_f32 v82, v82
    v_exp_f32 v83, v83
    v_exp_f32 v84, v84
    ds_read_b128 v[36:39], v3 offset:37888
    ds_read_b128 v[160:163], v13 offset:1024
    ds_read_b128 v[164:167], v13 offset:1536
    v_exp_f32 v85, v85
    v_exp_f32 v86, v86
    v_mfma_f32_32x32x16_bf16 v[96:111], v[32:35], v[148:151], v[64:79]
    v_exp_f32 v87, v87
    v_exp_f32 v88, v88
    s_mov_b32 s71, 40960
    v_mad_u32_u24 v12, v9, s71, v5
    v_exp_f32 v89, v89
    v_exp_f32 v90, v90
    v_exp_f32 v91, v91
    v_smfmac_f32_32x32x32_bf16 v[112:127], v[152:155], v[80:87], v184
    v_exp_f32 v92, v92
    v_exp_f32 v93, v93
    v_exp_f32 v94, v94
    v_exp_f32 v95, v95
    v_exp_f32 v96, v96
    v_exp_f32 v97, v97
    v_smfmac_f32_32x32x32_bf16 v[112:127], v[156:159], v[88:95], v184
    v_exp_f32 v98, v98
    v_exp_f32 v99, v99
    v_exp_f32 v100, v100
    v_exp_f32 v101, v101
    s_waitcnt lgkmcnt(0)
    v_exp_f32 v102, v102
    v_mfma_f32_32x32x16_bf16 v[80:95], v[36:39], v[144:147], v[48:63]
    v_exp_f32 v103, v103
    v_exp_f32 v104, v104
    v_exp_f32 v105, v105
    v_exp_f32 v106, v106
    v_exp_f32 v107, v107
    v_smfmac_f32_32x32x32_bf16 v[128:143], v[152:155], v[96:103], v184
    v_exp_f32 v108, v108
    v_exp_f32 v109, v109
    v_exp_f32 v110, v110
    v_exp_f32 v111, v111
    v_exp_f32 v80, v80
    v_exp_f32 v81, v81
    v_smfmac_f32_32x32x32_bf16 v[128:143], v[156:159], v[104:111], v184
    v_exp_f32 v82, v82
    v_exp_f32 v83, v83
    v_exp_f32 v84, v84
    ds_read_b128 v[32:35], v3 offset:38912
    ds_read_b128 v[152:155], v13 offset:2048
    ds_read_b128 v[156:159], v13 offset:2560
    v_exp_f32 v85, v85
    v_exp_f32 v86, v86
    v_mfma_f32_32x32x16_bf16 v[96:111], v[36:39], v[148:151], v[64:79]
    v_exp_f32 v87, v87
    v_exp_f32 v88, v88
    v_exp_f32 v89, v89
    v_exp_f32 v90, v90
    v_exp_f32 v91, v91
    v_smfmac_f32_32x32x32_bf16 v[112:127], v[160:163], v[80:87], v184
    v_exp_f32 v92, v92
    v_exp_f32 v93, v93
    v_exp_f32 v94, v94
    v_exp_f32 v95, v95
    v_exp_f32 v96, v96
    v_exp_f32 v97, v97
    v_smfmac_f32_32x32x32_bf16 v[112:127], v[164:167], v[88:95], v184
    v_exp_f32 v98, v98
    v_exp_f32 v99, v99
    v_exp_f32 v100, v100
    v_exp_f32 v101, v101
    s_waitcnt lgkmcnt(0)
    v_exp_f32 v102, v102
    v_mfma_f32_32x32x16_bf16 v[80:95], v[32:35], v[144:147], v[48:63]
    v_exp_f32 v103, v103
    v_exp_f32 v104, v104
    v_exp_f32 v105, v105
    v_exp_f32 v106, v106
    v_exp_f32 v107, v107
    v_smfmac_f32_32x32x32_bf16 v[128:143], v[160:163], v[96:103], v184
    v_exp_f32 v108, v108
    v_exp_f32 v109, v109
    v_exp_f32 v110, v110
    v_exp_f32 v111, v111
    v_exp_f32 v80, v80
    v_exp_f32 v81, v81
    v_smfmac_f32_32x32x32_bf16 v[128:143], v[164:167], v[104:111], v184
    v_exp_f32 v82, v82
    v_exp_f32 v83, v83
    v_exp_f32 v84, v84
    ds_read_b128 v[36:39], v3 offset:39936
    ds_read_b128 v[160:163], v13 offset:3072
    ds_read_b128 v[164:167], v13 offset:3584
    v_exp_f32 v85, v85
    v_exp_f32 v86, v86
    v_mfma_f32_32x32x16_bf16 v[96:111], v[32:35], v[148:151], v[64:79]
    v_exp_f32 v87, v87
    v_exp_f32 v88, v88
    v_exp_f32 v89, v89
    v_exp_f32 v90, v90
    v_exp_f32 v91, v91
    v_smfmac_f32_32x32x32_bf16 v[112:127], v[152:155], v[80:87], v184
    v_exp_f32 v92, v92
    v_exp_f32 v93, v93
    v_exp_f32 v94, v94
    v_exp_f32 v95, v95
    v_exp_f32 v96, v96
    v_exp_f32 v97, v97
    v_smfmac_f32_32x32x32_bf16 v[112:127], v[156:159], v[88:95], v184
    v_exp_f32 v98, v98
    v_exp_f32 v99, v99
    v_exp_f32 v100, v100
    v_exp_f32 v101, v101
    s_waitcnt lgkmcnt(0)
    v_exp_f32 v102, v102
    v_mfma_f32_32x32x16_bf16 v[80:95], v[36:39], v[144:147], v[48:63]
    v_exp_f32 v103, v103
    v_exp_f32 v104, v104
    v_exp_f32 v105, v105
    v_exp_f32 v106, v106
    v_exp_f32 v107, v107
    v_smfmac_f32_32x32x32_bf16 v[128:143], v[152:155], v[96:103], v184
    v_exp_f32 v108, v108
    v_exp_f32 v109, v109
    v_exp_f32 v110, v110
    v_exp_f32 v111, v111
    v_exp_f32 v80, v80
    v_exp_f32 v81, v81
    v_smfmac_f32_32x32x32_bf16 v[128:143], v[156:159], v[104:111], v184
    v_exp_f32 v82, v82
    v_exp_f32 v83, v83
    v_exp_f32 v84, v84
    ds_read_b128 v[32:35], v3 offset:40960
    ds_read_b128 v[152:155], v12 offset:0
    ds_read_b128 v[156:159], v12 offset:512
    v_exp_f32 v85, v85
    v_exp_f32 v86, v86
    v_mfma_f32_32x32x16_bf16 v[96:111], v[36:39], v[148:151], v[64:79]
    v_exp_f32 v87, v87
    v_exp_f32 v88, v88
    v_exp_f32 v89, v89
    v_exp_f32 v90, v90
    v_exp_f32 v91, v91
    v_smfmac_f32_32x32x32_bf16 v[112:127], v[160:163], v[80:87], v184
    v_exp_f32 v92, v92
    v_exp_f32 v93, v93
    v_exp_f32 v94, v94
    v_exp_f32 v95, v95
    v_exp_f32 v96, v96
    v_exp_f32 v97, v97
    v_smfmac_f32_32x32x32_bf16 v[112:127], v[164:167], v[88:95], v184
    v_exp_f32 v98, v98
    v_exp_f32 v99, v99
    v_exp_f32 v100, v100
    v_exp_f32 v101, v101
    s_waitcnt lgkmcnt(0)
    v_exp_f32 v102, v102
    v_mfma_f32_32x32x16_bf16 v[80:95], v[32:35], v[144:147], v[48:63]
    v_exp_f32 v103, v103
    v_exp_f32 v104, v104
    v_exp_f32 v105, v105
    v_exp_f32 v106, v106
    v_exp_f32 v107, v107
    v_smfmac_f32_32x32x32_bf16 v[128:143], v[160:163], v[96:103], v184
    v_exp_f32 v108, v108
    v_exp_f32 v109, v109
    v_exp_f32 v110, v110
    v_exp_f32 v111, v111
    v_exp_f32 v80, v80
    v_exp_f32 v81, v81
    v_smfmac_f32_32x32x32_bf16 v[128:143], v[164:167], v[104:111], v184
    v_exp_f32 v82, v82
    v_exp_f32 v83, v83
    v_exp_f32 v84, v84
    ds_read_b128 v[36:39], v3 offset:41984
    ds_read_b128 v[160:163], v12 offset:1024
    ds_read_b128 v[164:167], v12 offset:1536
    v_exp_f32 v85, v85
    v_exp_f32 v86, v86
    v_mfma_f32_32x32x16_bf16 v[96:111], v[32:35], v[148:151], v[64:79]
    v_exp_f32 v87, v87
    v_exp_f32 v88, v88
    s_mov_b32 s71, 45056
    v_mad_u32_u24 v13, v9, s71, v5
    v_exp_f32 v89, v89
    v_exp_f32 v90, v90
    v_exp_f32 v91, v91
    v_smfmac_f32_32x32x32_bf16 v[112:127], v[152:155], v[80:87], v184
    v_exp_f32 v92, v92
    v_exp_f32 v93, v93
    v_exp_f32 v94, v94
    v_exp_f32 v95, v95
    v_exp_f32 v96, v96
    v_exp_f32 v97, v97
    v_smfmac_f32_32x32x32_bf16 v[112:127], v[156:159], v[88:95], v184
    v_exp_f32 v98, v98
    v_exp_f32 v99, v99
    v_exp_f32 v100, v100
    v_exp_f32 v101, v101
    s_waitcnt lgkmcnt(0)
    v_exp_f32 v102, v102
    v_mfma_f32_32x32x16_bf16 v[80:95], v[36:39], v[144:147], v[48:63]
    v_exp_f32 v103, v103
    v_exp_f32 v104, v104
    v_exp_f32 v105, v105
    v_exp_f32 v106, v106
    v_exp_f32 v107, v107
    v_smfmac_f32_32x32x32_bf16 v[128:143], v[152:155], v[96:103], v184
    v_exp_f32 v108, v108
    v_exp_f32 v109, v109
    v_exp_f32 v110, v110
    v_exp_f32 v111, v111
    v_exp_f32 v80, v80
    v_exp_f32 v81, v81
    v_smfmac_f32_32x32x32_bf16 v[128:143], v[156:159], v[104:111], v184
    v_exp_f32 v82, v82
    v_exp_f32 v83, v83
    v_exp_f32 v84, v84
    ds_read_b128 v[32:35], v3 offset:43008
    ds_read_b128 v[152:155], v12 offset:2048
    ds_read_b128 v[156:159], v12 offset:2560
    v_exp_f32 v85, v85
    v_exp_f32 v86, v86
    v_mfma_f32_32x32x16_bf16 v[96:111], v[36:39], v[148:151], v[64:79]
    v_exp_f32 v87, v87
    v_exp_f32 v88, v88
    v_exp_f32 v89, v89
    v_exp_f32 v90, v90
    v_exp_f32 v91, v91
    v_smfmac_f32_32x32x32_bf16 v[112:127], v[160:163], v[80:87], v184
    v_exp_f32 v92, v92
    v_exp_f32 v93, v93
    v_exp_f32 v94, v94
    v_exp_f32 v95, v95
    v_exp_f32 v96, v96
    v_exp_f32 v97, v97
    v_smfmac_f32_32x32x32_bf16 v[112:127], v[164:167], v[88:95], v184
    v_exp_f32 v98, v98
    v_exp_f32 v99, v99
    v_exp_f32 v100, v100
    v_exp_f32 v101, v101
    s_waitcnt lgkmcnt(0)
    v_exp_f32 v102, v102
    v_mfma_f32_32x32x16_bf16 v[80:95], v[32:35], v[144:147], v[48:63]
    v_exp_f32 v103, v103
    v_exp_f32 v104, v104
    v_exp_f32 v105, v105
    v_exp_f32 v106, v106
    v_exp_f32 v107, v107
    v_smfmac_f32_32x32x32_bf16 v[128:143], v[160:163], v[96:103], v184
    v_exp_f32 v108, v108
    v_exp_f32 v109, v109
    v_exp_f32 v110, v110
    v_exp_f32 v111, v111
    v_exp_f32 v80, v80
    v_exp_f32 v81, v81
    v_smfmac_f32_32x32x32_bf16 v[128:143], v[164:167], v[104:111], v184
    v_exp_f32 v82, v82
    v_exp_f32 v83, v83
    v_exp_f32 v84, v84
    ds_read_b128 v[36:39], v3 offset:44032
    ds_read_b128 v[160:163], v12 offset:3072
    ds_read_b128 v[164:167], v12 offset:3584
    v_exp_f32 v85, v85
    v_exp_f32 v86, v86
    v_mfma_f32_32x32x16_bf16 v[96:111], v[32:35], v[148:151], v[64:79]
    v_exp_f32 v87, v87
    v_exp_f32 v88, v88
    v_exp_f32 v89, v89
    v_exp_f32 v90, v90
    v_exp_f32 v91, v91
    v_smfmac_f32_32x32x32_bf16 v[112:127], v[152:155], v[80:87], v184
    v_exp_f32 v92, v92
    v_exp_f32 v93, v93
    v_exp_f32 v94, v94
    v_exp_f32 v95, v95
    v_exp_f32 v96, v96
    v_exp_f32 v97, v97
    v_smfmac_f32_32x32x32_bf16 v[112:127], v[156:159], v[88:95], v184
    v_exp_f32 v98, v98
    v_exp_f32 v99, v99
    v_exp_f32 v100, v100
    v_exp_f32 v101, v101
    s_waitcnt lgkmcnt(0)
    v_exp_f32 v102, v102
    v_mfma_f32_32x32x16_bf16 v[80:95], v[36:39], v[144:147], v[48:63]
    v_exp_f32 v103, v103
    v_exp_f32 v104, v104
    v_exp_f32 v105, v105
    v_exp_f32 v106, v106
    v_exp_f32 v107, v107
    v_smfmac_f32_32x32x32_bf16 v[128:143], v[152:155], v[96:103], v184
    v_exp_f32 v108, v108
    v_exp_f32 v109, v109
    v_exp_f32 v110, v110
    v_exp_f32 v111, v111
    v_exp_f32 v80, v80
    v_exp_f32 v81, v81
    v_smfmac_f32_32x32x32_bf16 v[128:143], v[156:159], v[104:111], v184
    v_exp_f32 v82, v82
    v_exp_f32 v83, v83
    v_exp_f32 v84, v84
    ds_read_b128 v[32:35], v3 offset:45056
    ds_read_b128 v[152:155], v13 offset:0
    ds_read_b128 v[156:159], v13 offset:512
    v_exp_f32 v85, v85
    v_exp_f32 v86, v86
    v_mfma_f32_32x32x16_bf16 v[96:111], v[36:39], v[148:151], v[64:79]
    v_exp_f32 v87, v87
    v_exp_f32 v88, v88
    v_exp_f32 v89, v89
    v_exp_f32 v90, v90
    v_exp_f32 v91, v91
    v_smfmac_f32_32x32x32_bf16 v[112:127], v[160:163], v[80:87], v184
    v_exp_f32 v92, v92
    v_exp_f32 v93, v93
    v_exp_f32 v94, v94
    v_exp_f32 v95, v95
    v_exp_f32 v96, v96
    v_exp_f32 v97, v97
    v_smfmac_f32_32x32x32_bf16 v[112:127], v[164:167], v[88:95], v184
    v_exp_f32 v98, v98
    v_exp_f32 v99, v99
    v_exp_f32 v100, v100
    v_exp_f32 v101, v101
    s_waitcnt lgkmcnt(0)
    v_exp_f32 v102, v102
    v_mfma_f32_32x32x16_bf16 v[80:95], v[32:35], v[144:147], v[48:63]
    v_exp_f32 v103, v103
    v_exp_f32 v104, v104
    v_exp_f32 v105, v105
    v_exp_f32 v106, v106
    v_exp_f32 v107, v107
    v_smfmac_f32_32x32x32_bf16 v[128:143], v[160:163], v[96:103], v184
    v_exp_f32 v108, v108
    v_exp_f32 v109, v109
    v_exp_f32 v110, v110
    v_exp_f32 v111, v111
    v_exp_f32 v80, v80
    v_exp_f32 v81, v81
    v_smfmac_f32_32x32x32_bf16 v[128:143], v[164:167], v[104:111], v184
    v_exp_f32 v82, v82
    v_exp_f32 v83, v83
    v_exp_f32 v84, v84
    ds_read_b128 v[36:39], v3 offset:46080
    ds_read_b128 v[160:163], v13 offset:1024
    ds_read_b128 v[164:167], v13 offset:1536
    v_exp_f32 v85, v85
    v_exp_f32 v86, v86
    v_mfma_f32_32x32x16_bf16 v[96:111], v[32:35], v[148:151], v[64:79]
    v_exp_f32 v87, v87
    v_exp_f32 v88, v88
    s_mov_b32 s71, 0
    v_mad_u32_u24 v12, v9, s71, v5
    v_exp_f32 v89, v89
    v_exp_f32 v90, v90
    v_exp_f32 v91, v91
    v_smfmac_f32_32x32x32_bf16 v[112:127], v[152:155], v[80:87], v184
    v_exp_f32 v92, v92
    v_exp_f32 v93, v93
    v_exp_f32 v94, v94
    v_exp_f32 v95, v95
    v_exp_f32 v96, v96
    v_exp_f32 v97, v97
    v_smfmac_f32_32x32x32_bf16 v[112:127], v[156:159], v[88:95], v184
    v_exp_f32 v98, v98
    v_exp_f32 v99, v99
    v_exp_f32 v100, v100
    v_exp_f32 v101, v101
    s_waitcnt lgkmcnt(0)
    v_exp_f32 v102, v102
    v_mfma_f32_32x32x16_bf16 v[80:95], v[36:39], v[144:147], v[48:63]
    v_exp_f32 v103, v103
    v_exp_f32 v104, v104
    v_exp_f32 v105, v105
    v_exp_f32 v106, v106
    v_exp_f32 v107, v107
    v_smfmac_f32_32x32x32_bf16 v[128:143], v[152:155], v[96:103], v184
    v_exp_f32 v108, v108
    v_exp_f32 v109, v109
    v_exp_f32 v110, v110
    v_exp_f32 v111, v111
    v_exp_f32 v80, v80
    v_exp_f32 v81, v81
    v_smfmac_f32_32x32x32_bf16 v[128:143], v[156:159], v[104:111], v184
    v_exp_f32 v82, v82
    v_exp_f32 v83, v83
    v_exp_f32 v84, v84
    ds_read_b128 v[32:35], v3 offset:47104
    ds_read_b128 v[152:155], v13 offset:2048
    ds_read_b128 v[156:159], v13 offset:2560
    v_exp_f32 v85, v85
    v_exp_f32 v86, v86
    v_mfma_f32_32x32x16_bf16 v[96:111], v[36:39], v[148:151], v[64:79]
    v_exp_f32 v87, v87
    v_exp_f32 v88, v88
    v_exp_f32 v89, v89
    v_exp_f32 v90, v90
    v_exp_f32 v91, v91
    v_smfmac_f32_32x32x32_bf16 v[112:127], v[160:163], v[80:87], v184
    v_exp_f32 v92, v92
    v_exp_f32 v93, v93
    v_exp_f32 v94, v94
    v_exp_f32 v95, v95
    v_exp_f32 v96, v96
    v_exp_f32 v97, v97
    v_smfmac_f32_32x32x32_bf16 v[112:127], v[164:167], v[88:95], v184
    v_exp_f32 v98, v98
    v_exp_f32 v99, v99
    v_exp_f32 v100, v100
    v_exp_f32 v101, v101
    s_waitcnt lgkmcnt(0)
    v_exp_f32 v102, v102
    v_mfma_f32_32x32x16_bf16 v[80:95], v[32:35], v[144:147], v[48:63]
    v_exp_f32 v103, v103
    v_exp_f32 v104, v104
    v_exp_f32 v105, v105
    v_exp_f32 v106, v106
    v_exp_f32 v107, v107
    v_smfmac_f32_32x32x32_bf16 v[128:143], v[160:163], v[96:103], v184
    v_exp_f32 v108, v108
    v_exp_f32 v109, v109
    v_exp_f32 v110, v110
    v_exp_f32 v111, v111
    v_exp_f32 v80, v80
    v_exp_f32 v81, v81
    v_smfmac_f32_32x32x32_bf16 v[128:143], v[164:167], v[104:111], v184
    v_exp_f32 v82, v82
    v_exp_f32 v83, v83
    v_exp_f32 v84, v84
    ds_read_b128 v[36:39], v3 offset:48128
    ds_read_b128 v[160:163], v13 offset:3072
    ds_read_b128 v[164:167], v13 offset:3584
    v_exp_f32 v85, v85
    v_exp_f32 v86, v86
    v_mfma_f32_32x32x16_bf16 v[96:111], v[32:35], v[148:151], v[64:79]
    v_exp_f32 v87, v87
    v_exp_f32 v88, v88
    v_exp_f32 v89, v89
    v_exp_f32 v90, v90
    v_exp_f32 v91, v91
    v_smfmac_f32_32x32x32_bf16 v[112:127], v[152:155], v[80:87], v184
    v_exp_f32 v92, v92
    v_exp_f32 v93, v93
    v_exp_f32 v94, v94
    v_exp_f32 v95, v95
    v_exp_f32 v96, v96
    v_exp_f32 v97, v97
    v_smfmac_f32_32x32x32_bf16 v[112:127], v[156:159], v[88:95], v184
    v_exp_f32 v98, v98
    v_exp_f32 v99, v99
    v_exp_f32 v100, v100
    v_exp_f32 v101, v101
    s_waitcnt lgkmcnt(0)
    v_exp_f32 v102, v102
    v_mfma_f32_32x32x16_bf16 v[80:95], v[36:39], v[144:147], v[48:63]
    v_exp_f32 v103, v103
    v_exp_f32 v104, v104
    v_exp_f32 v105, v105
    v_exp_f32 v106, v106
    v_exp_f32 v107, v107
    v_smfmac_f32_32x32x32_bf16 v[128:143], v[152:155], v[96:103], v184
    v_exp_f32 v108, v108
    v_exp_f32 v109, v109
    v_exp_f32 v110, v110
    v_exp_f32 v111, v111
    v_exp_f32 v80, v80
    v_exp_f32 v81, v81
    v_smfmac_f32_32x32x32_bf16 v[128:143], v[156:159], v[104:111], v184
    v_exp_f32 v82, v82
    v_exp_f32 v83, v83
    v_exp_f32 v84, v84
    ds_read_b128 v[32:35], v3 offset:0
    ds_read_b128 v[152:155], v12 offset:0
    ds_read_b128 v[156:159], v12 offset:512
    v_exp_f32 v85, v85
    v_exp_f32 v86, v86
    v_mfma_f32_32x32x16_bf16 v[96:111], v[36:39], v[148:151], v[64:79]
    v_exp_f32 v87, v87
    v_exp_f32 v88, v88
    v_exp_f32 v89, v89
    v_exp_f32 v90, v90
    v_exp_f32 v91, v91
    v_smfmac_f32_32x32x32_bf16 v[112:127], v[160:163], v[80:87], v184
    v_exp_f32 v92, v92
    v_exp_f32 v93, v93
    v_exp_f32 v94, v94
    v_exp_f32 v95, v95
    v_exp_f32 v96, v96
    v_exp_f32 v97, v97
    v_smfmac_f32_32x32x32_bf16 v[112:127], v[164:167], v[88:95], v184
    v_exp_f32 v98, v98
    v_exp_f32 v99, v99
    v_exp_f32 v100, v100
    v_exp_f32 v101, v101
    s_waitcnt lgkmcnt(0)
    v_exp_f32 v102, v102
    v_mfma_f32_32x32x16_bf16 v[80:95], v[32:35], v[144:147], v[48:63]
    v_exp_f32 v103, v103
    v_exp_f32 v104, v104
    v_exp_f32 v105, v105
    v_exp_f32 v106, v106
    v_exp_f32 v107, v107
    v_smfmac_f32_32x32x32_bf16 v[128:143], v[160:163], v[96:103], v184
    v_exp_f32 v108, v108
    v_exp_f32 v109, v109
    v_exp_f32 v110, v110
    v_exp_f32 v111, v111
    s_nop 1
    v_smfmac_f32_32x32x32_bf16 v[128:143], v[164:167], v[104:111], v184
    s_nop 15
    s_nop 7
    v_rcp_f32 v186, v120
    v_rcp_f32 v187, v136
    s_nop 0
    v_mul_f32 v112, v112, v186
    v_mul_f32 v128, v128, v187
    v_mul_f32 v113, v113, v186
    v_mul_f32 v129, v129, v187
    v_mul_f32 v114, v114, v186
    v_mul_f32 v130, v130, v187
    v_mul_f32 v115, v115, v186
    v_mul_f32 v131, v131, v187
    v_mul_f32 v116, v116, v186
    v_mul_f32 v132, v132, v187
    v_mul_f32 v117, v117, v186
    v_mul_f32 v133, v133, v187
    v_mul_f32 v118, v118, v186
    v_mul_f32 v134, v134, v187
    v_mul_f32 v119, v119, v186
    v_mul_f32 v135, v135, v187
    v_cvt_pk_bf16_f32 v80, v112, v113
    v_cvt_pk_bf16_f32 v84, v128, v129
    v_cvt_pk_bf16_f32 v81, v114, v115
    v_cvt_pk_bf16_f32 v85, v130, v131
    v_cvt_pk_bf16_f32 v82, v116, v117
    v_cvt_pk_bf16_f32 v86, v132, v133
    v_cvt_pk_bf16_f32 v83, v118, v119
    v_cvt_pk_bf16_f32 v87, v134, v135
    s_lshl_b32 s13, s4, 1
    s_add_u32 s13, s13, s7
    s_lshl_b32 s13, s13, 5
    s_lshl_b32 s14, s5, 2
    s_add_u32 s13, s13, s14
    s_lshl_b32 s14, s6, 1
    s_add_u32 s13, s13, s14
    s_lshl_b32 s13, s13, 10
    buffer_store_dwordx4 v[80:83], v3, s[56:59], s13 offen sc1
    buffer_store_dwordx4 v[84:87], v3, s[56:59], s13 offen offset:1024 sc1
    s_lshl_b32 s12, s4, 7
    s_lshl_b32 s13, s5, 2
    s_add_u32 s12, s12, s13
    s_add_u32 s12, s12, 208896
    s_waitcnt vmcnt(0)
    s_barrier
    s_cmp_lg_u32 s3, 0
    s_cbranch_scc1 SIG_22
    v_mul_u32_u24 v2, 0, v1
    v_mov_b32 v3, s74
    s_mov_b32 exec_lo, 0x1
    s_mov_b32 exec_hi, 0x0
    buffer_store_dword v3, v2, s[52:55], s12 offen sc0 sc1
    s_mov_b64 exec, -1
SIG_22:
    s_branch K_flush
K_gu:
    s_setprio 1
    s_sub_u32 s9, s2, 288
    s_and_b32 s6, s9, 7
    s_lshr_b32 s7, s9, 3
    s_lshr_b32 s4, s6, 1
    s_lshl_b32 s4, s4, 2
    s_and_b32 s8, s7, 3
    s_add_u32 s4, s4, s8
    s_and_b32 s5, s6, 1
    s_mul_i32 s5, s5, 7
    s_lshr_b32 s7, s7, 2
    s_add_u32 s5, s5, s7
    s_mov_b32 s40, s16
    s_and_b32 s41, s17, 0xffff
    s_mov_b32 s42, 2097152
    s_mov_b32 s43, 0x00020000
    s_mov_b32 s44, s28
    s_and_b32 s45, s29, 0xffff
    s_mov_b32 s46, 1835008
    s_mov_b32 s47, 0x00020000
    s_mov_b32 s48, s30
    s_and_b32 s49, s31, 0xffff
    s_mov_b32 s50, 1835008
    s_mov_b32 s51, 0x00020000
    s_and_b32 s6, s3, 1
    s_lshr_b32 s7, s3, 1
    v_lshrrev_b32 v3, 2, v1
    v_lshlrev_b32 v3, 10, v3
    v_and_b32 v4, 3, v1
    v_lshrrev_b32 v5, 4, v1
    v_xor_b32 v2, v4, v5
    v_lshl_add_u32 v8, v2, 4, v3
    v_mul_u32_u24 v9, 3584, v5
    v_bfe_u32 v3, v1, 2, 2
    v_xor_b32 v3, v3, v5
    v_lshl_add_u32 v9, v3, 6, v9
    v_lshl_add_u32 v9, v4, 4, v9
    s_lshl_b32 s8, s4, 7
    s_lshl_b32 s9, s3, 5
    s_add_u32 s8, s8, s9
    s_lshl_b32 s8, s8, 10
    s_mul_i32 s9, s3, 28672
    s_lshl_b32 s10, s5, 8
    s_add_u32 s9, s9, s10
    s_lshl_b32 s10, s3, 11
    s_and_b32 s66, s4, 3
    s_lshl_b32 s66, s66, 2
    s_setprio 3
    s_lshl_b32 s12, s66, 6
    s_add_u32 s12, s12, s8
    s_mul_i32 s13, s66, 114688
    s_add_u32 s13, s13, s9
    s_add_u32 s66, s66, 1
    s_and_b32 s66, s66, 15
    s_add_u32 m0, s10, 0
    s_add_u32 s14, s12, 0
    buffer_load_dwordx4 v8, s[40:43], s14 offen lds
    s_add_u32 m0, s10, 1024
    s_add_u32 s14, s12, 16384
    buffer_load_dwordx4 v8, s[40:43], s14 offen lds
    s_add_u32 m0, s10, 8192
    s_add_u32 s14, s13, 0
    buffer_load_dwordx4 v9, s[44:47], s14 offen lds
    s_add_u32 m0, s10, 9216
    s_add_u32 s14, s13, 14336
    buffer_load_dwordx4 v9, s[44:47], s14 offen lds
    s_add_u32 m0, s10, 16384
    s_add_u32 s14, s13, 0
    buffer_load_dwordx4 v9, s[48:51], s14 offen lds
    s_add_u32 m0, s10, 17408
    s_add_u32 s14, s13, 14336
    buffer_load_dwordx4 v9, s[48:51], s14 offen lds
    s_lshl_b32 s12, s66, 6
    s_add_u32 s12, s12, s8
    s_mul_i32 s13, s66, 114688
    s_add_u32 s13, s13, s9
    s_add_u32 s66, s66, 1
    s_and_b32 s66, s66, 15
    s_add_u32 m0, s10, 24576
    s_add_u32 s14, s12, 0
    buffer_load_dwordx4 v8, s[40:43], s14 offen lds
    s_add_u32 m0, s10, 25600
    s_add_u32 s14, s12, 16384
    buffer_load_dwordx4 v8, s[40:43], s14 offen lds
    s_add_u32 m0, s10, 32768
    s_add_u32 s14, s13, 0
    buffer_load_dwordx4 v9, s[44:47], s14 offen lds
    s_add_u32 m0, s10, 33792
    s_add_u32 s14, s13, 14336
    buffer_load_dwordx4 v9, s[44:47], s14 offen lds
    s_add_u32 m0, s10, 40960
    s_add_u32 s14, s13, 0
    buffer_load_dwordx4 v9, s[48:51], s14 offen lds
    s_add_u32 m0, s10, 41984
    s_add_u32 s14, s13, 14336
    buffer_load_dwordx4 v9, s[48:51], s14 offen lds
    s_lshl_b32 s12, s66, 6
    s_add_u32 s12, s12, s8
    s_mul_i32 s13, s66, 114688
    s_add_u32 s13, s13, s9
    s_add_u32 s66, s66, 1
    s_and_b32 s66, s66, 15
    s_add_u32 m0, s10, 49152
    s_add_u32 s14, s12, 0
    buffer_load_dwordx4 v8, s[40:43], s14 offen lds
    s_add_u32 m0, s10, 50176
    s_add_u32 s14, s12, 16384
    buffer_load_dwordx4 v8, s[40:43], s14 offen lds
    s_add_u32 m0, s10, 57344
    s_add_u32 s14, s13, 0
    buffer_load_dwordx4 v9, s[44:47], s14 offen lds
    s_add_u32 m0, s10, 58368
    s_add_u32 s14, s13, 14336
    buffer_load_dwordx4 v9, s[44:47], s14 offen lds
    s_add_u32 m0, s10, 65536
    s_add_u32 s14, s13, 0
    buffer_load_dwordx4 v9, s[48:51], s14 offen lds
    s_add_u32 m0, s10, 66560
    s_add_u32 s14, s13, 14336
    buffer_load_dwordx4 v9, s[48:51], s14 offen lds
    v_mov_b32 v128, 0
    v_mov_b32 v129, 0
    v_mov_b32 v130, 0
    v_mov_b32 v131, 0
    v_mov_b32 v132, 0
    v_mov_b32 v133, 0
    v_mov_b32 v134, 0
    v_mov_b32 v135, 0
    v_mov_b32 v136, 0
    v_mov_b32 v137, 0
    v_mov_b32 v138, 0
    v_mov_b32 v139, 0
    v_mov_b32 v140, 0
    v_mov_b32 v141, 0
    v_mov_b32 v142, 0
    v_mov_b32 v143, 0
    v_mov_b32 v144, 0
    v_mov_b32 v145, 0
    v_mov_b32 v146, 0
    v_mov_b32 v147, 0
    v_mov_b32 v148, 0
    v_mov_b32 v149, 0
    v_mov_b32 v150, 0
    v_mov_b32 v151, 0
    v_mov_b32 v152, 0
    v_mov_b32 v153, 0
    v_mov_b32 v154, 0
    v_mov_b32 v155, 0
    v_mov_b32 v156, 0
    v_mov_b32 v157, 0
    v_mov_b32 v158, 0
    v_mov_b32 v159, 0
    v_mov_b32 v160, 0
    v_mov_b32 v161, 0
    v_mov_b32 v162, 0
    v_mov_b32 v163, 0
    v_mov_b32 v164, 0
    v_mov_b32 v165, 0
    v_mov_b32 v166, 0
    v_mov_b32 v167, 0
    v_mov_b32 v168, 0
    v_mov_b32 v169, 0
    v_mov_b32 v170, 0
    v_mov_b32 v171, 0
    v_mov_b32 v172, 0
    v_mov_b32 v173, 0
    v_mov_b32 v174, 0
    v_mov_b32 v175, 0
    v_mov_b32 v176, 0
    v_mov_b32 v177, 0
    v_mov_b32 v178, 0
    v_mov_b32 v179, 0
    v_mov_b32 v180, 0
    v_mov_b32 v181, 0
    v_mov_b32 v182, 0
    v_mov_b32 v183, 0
    v_mov_b32 v184, 0
    v_mov_b32 v185, 0
    v_mov_b32 v186, 0
    v_mov_b32 v187, 0
    v_mov_b32 v188, 0
    v_mov_b32 v189, 0
    v_mov_b32 v190, 0
    v_mov_b32 v191, 0
    v_mov_b32 v192, 0
    v_mov_b32 v193, 0
    v_mov_b32 v194, 0
    v_mov_b32 v195, 0
    v_mov_b32 v196, 0
    v_mov_b32 v197, 0
    v_mov_b32 v198, 0
    v_mov_b32 v199, 0
    v_mov_b32 v200, 0
    v_mov_b32 v201, 0
    v_mov_b32 v202, 0
    v_mov_b32 v203, 0
    v_mov_b32 v204, 0
    v_mov_b32 v205, 0
    v_mov_b32 v206, 0
    v_mov_b32 v207, 0
    v_mov_b32 v208, 0
    v_mov_b32 v209, 0
    v_mov_b32 v210, 0
    v_mov_b32 v211, 0
    v_mov_b32 v212, 0
    v_mov_b32 v213, 0
    v_mov_b32 v214, 0
    v_mov_b32 v215, 0
    v_mov_b32 v216, 0
    v_mov_b32 v217, 0
    v_mov_b32 v218, 0
    v_mov_b32 v219, 0
    v_mov_b32 v220, 0
    v_mov_b32 v221, 0
    v_mov_b32 v222, 0
    v_mov_b32 v223, 0
    v_mov_b32 v224, 0
    v_mov_b32 v225, 0
    v_mov_b32 v226, 0
    v_mov_b32 v227, 0
    v_mov_b32 v228, 0
    v_mov_b32 v229, 0
    v_mov_b32 v230, 0
    v_mov_b32 v231, 0
    v_mov_b32 v232, 0
    v_mov_b32 v233, 0
    v_mov_b32 v234, 0
    v_mov_b32 v235, 0
    v_mov_b32 v236, 0
    v_mov_b32 v237, 0
    v_mov_b32 v238, 0
    v_mov_b32 v239, 0
    v_mov_b32 v240, 0
    v_mov_b32 v241, 0
    v_mov_b32 v242, 0
    v_mov_b32 v243, 0
    v_mov_b32 v244, 0
    v_mov_b32 v245, 0
    v_mov_b32 v246, 0
    v_mov_b32 v247, 0
    v_mov_b32 v248, 0
    v_mov_b32 v249, 0
    v_mov_b32 v250, 0
    v_mov_b32 v251, 0
    v_mov_b32 v252, 0
    v_mov_b32 v253, 0
    v_mov_b32 v254, 0
    v_mov_b32 v255, 0
    v_lshrrev_b32 v2, 1, v1
    v_mul_u32_u24 v2, 3584, v2
    v_and_b32 v3, 1, v1
    v_lshl_add_u32 v2, v3, 7, v2
    s_and_b32 s14, s4, 3
    s_lshl_b32 s14, s14, 2
    s_add_u32 s14, s14, s3
    s_mul_i32 s14, s14, 114688
    s_lshl_b32 s15, s5, 8
    s_add_u32 s14, s14, s15
    buffer_load_dword v60, v2, s[44:47], s14 offen
    buffer_load_dword v61, v2, s[48:51], s14 offen
    v_lshrrev_b32 v2, 3, v1
    v_lshlrev_b32 v2, 10, v2
    v_and_b32 v3, 7, v1
    v_lshl_add_u32 v2, v3, 7, v2
    s_cmp_ge_u32 s5, 7
    s_cselect_b32 s14, 7, 0
    s_sub_u32 s14, s5, s14
    s_cmp_ge_u32 s3, 2
    s_cselect_b32 s14, 7, s14
    s_lshl_b32 s14, s14, 4
    s_and_b32 s15, s3, 1
    s_lshl_b32 s15, s15, 3
    s_add_u32 s14, s14, s15
    s_lshl_b32 s15, s4, 7
    s_add_u32 s14, s14, s15
    s_lshl_b32 s14, s14, 10
    buffer_load_dword v62, v2, s[40:43], s14 offen
    s_mov_b32 s52, s38
    s_and_b32 s53, s39, 0xffff
    s_mov_b32 s54, 524288
    s_mov_b32 s55, 0x00020000
    s_add_u32 s56, s38, 1048576
    s_addc_u32 s57, s39, 0
    s_and_b32 s57, s57, 0xffff
    s_mov_b32 s58, 7340032
    s_mov_b32 s59, 0x00020000
    v_and_b32 v6, 31, v1
    v_lshrrev_b32 v7, 5, v1
    v_bfe_u32 v10, v1, 2, 2
    v_xor_b32 v10, v10, v7
    v_lshlrev_b32 v10, 4, v10
    v_lshl_add_u32 v10, v6, 6, v10
    s_lshl_b32 s14, s6, 12
    v_add_u32 v10, s14, v10
    v_xor_b32 v11, 32, v10
    v_bfe_u32 v2, v1, 2, 2
    v_lshl_add_u32 v12, v7, 3, v2
    v_lshlrev_b32 v12, 8, v12
    s_lshl_b32 s14, s7, 1
    v_xor_b32 v2, s14, v2
    v_lshl_add_u32 v12, v2, 6, v12
    v_bfe_u32 v2, v1, 4, 1
    v_lshl_add_u32 v12, v2, 5, v12
    v_and_b32 v2, 3, v1
    v_lshl_add_u32 v12, v2, 3, v12
    v_add_u32 v12, 8192, v12
    v_xor_b32 v13, 64, v12
    v_mov_b32 v20, 0
    v_mov_b32 v21, 0
    v_mov_b32 v22, 0
    v_mov_b32 v23, 0
    v_mov_b32 v24, 0
    v_mov_b32 v25, 0
    v_mov_b32 v26, 0
    v_mov_b32 v27, 0
    v_mov_b32 v28, 0
    v_mov_b32 v29, 0
    v_mov_b32 v30, 0
    v_mov_b32 v31, 0
    v_mov_b32 v32, 0
    v_mov_b32 v33, 0
    v_mov_b32 v34, 0
    v_mov_b32 v35, 0
    v_mov_b32 v36, 0
    v_mov_b32 v37, 0
    v_mov_b32 v38, 0
    v_mov_b32 v39, 0
    v_mov_b32 v40, 0
    v_mov_b32 v41, 0
    v_mov_b32 v42, 0
    v_mov_b32 v43, 0
    v_mov_b32 v44, 0
    v_mov_b32 v45, 0
    v_mov_b32 v46, 0
    v_mov_b32 v47, 0
    v_mov_b32 v48, 0
    v_mov_b32 v49, 0
    v_mov_b32 v50, 0
    v_mov_b32 v51, 0
    v_mov_b32 v52, 0x3f803f80
    v_mov_b32 v53, 0x3f803f80
    v_mov_b32 v54, 0x3f803f80
    v_mov_b32 v55, 0x3f803f80
    v_add_u32 v14, 49152, v10
    v_add_u32 v15, 49152, v11
    v_add_u32 v16, 49152, v12
    v_add_u32 v17, 49152, v13
    s_waitcnt vmcnt(15)
    s_barrier
    s_setprio 1
    ds_read_b128 v[64:67], v10 offset:0
    ds_read_b128 v[68:71], v10 offset:2048
    ds_read_b64_tr_b16 v[80:81], v12 offset:0
    ds_read_b64_tr_b16 v[82:83], v12 offset:1024
    ds_read_b64_tr_b16 v[84:85], v12 offset:8192
    ds_read_b64_tr_b16 v[86:87], v12 offset:9216
    ds_read_b64_tr_b16 v[88:89], v13 offset:0
    ds_read_b64_tr_b16 v[90:91], v13 offset:1024
    ds_read_b64_tr_b16 v[92:93], v13 offset:8192
    ds_read_b64_tr_b16 v[94:95], v13 offset:9216
    s_cmp_eq_u32 s6, 1
    s_cbranch_scc1 GU_wm1_23
    s_waitcnt lgkmcnt(0)
    v_mfma_f32_32x32x16_bf16 v[128:143], v[80:83], v[64:67], v[128:143]
    ds_read_b128 v[72:75], v11 offset:0
    ds_read_b128 v[76:79], v11 offset:2048
    v_mfma_f32_32x32x16_bf16 v[192:207], v[80:83], v[68:71], v[192:207]
    ds_read_b64_tr_b16 v[96:97], v12 offset:4096
    ds_read_b64_tr_b16 v[98:99], v12 offset:5120
    v_mfma_f32_32x32x16_bf16 v[144:159], v[84:87], v[64:67], v[144:159]
    ds_read_b64_tr_b16 v[100:101], v12 offset:12288
    ds_read_b64_tr_b16 v[102:103], v12 offset:13312
    v_mfma_f32_32x32x16_bf16 v[208:223], v[84:87], v[68:71], v[208:223]
    ds_read_b64_tr_b16 v[104:105], v13 offset:4096
    ds_read_b64_tr_b16 v[106:107], v13 offset:5120
    v_mfma_f32_32x32x16_bf16 v[160:175], v[88:91], v[64:67], v[160:175]
    ds_read_b64_tr_b16 v[108:109], v13 offset:12288
    ds_read_b64_tr_b16 v[110:111], v13 offset:13312
    v_mfma_f32_32x32x16_bf16 v[224:239], v[88:91], v[68:71], v[224:239]
    v_mfma_f32_32x32x16_bf16 v[176:191], v[92:95], v[64:67], v[176:191]
    v_mfma_f32_32x32x16_bf16 v[240:255], v[92:95], v[68:71], v[240:255]
    v_mfma_f32_32x32x16_bf16 v[20:35], v[80:83], v[52:55], v[20:35]
    v_mfma_f32_32x32x16_bf16 v[36:51], v[84:87], v[52:55], v[36:51]
    s_waitcnt vmcnt(9) lgkmcnt(0)
    s_barrier
    v_mfma_f32_32x32x16_bf16 v[128:143], v[96:99], v[72:75], v[128:143]
    ds_read_b128 v[64:67], v10 offset:24576
    ds_read_b128 v[68:71], v10 offset:26624
    v_mfma_f32_32x32x16_bf16 v[192:207], v[96:99], v[76:79], v[192:207]
    ds_read_b64_tr_b16 v[80:81], v12 offset:24576
    ds_read_b64_tr_b16 v[82:83], v12 offset:25600
    v_mfma_f32_32x32x16_bf16 v[144:159], v[100:103], v[72:75], v[144:159]
    ds_read_b64_tr_b16 v[84:85], v12 offset:32768
    ds_read_b64_tr_b16 v[86:87], v12 offset:33792
    v_mfma_f32_32x32x16_bf16 v[208:223], v[100:103], v[76:79], v[208:223]
    ds_read_b64_tr_b16 v[88:89], v13 offset:24576
    ds_read_b64_tr_b16 v[90:91], v13 offset:25600
    v_mfma_f32_32x32x16_bf16 v[160:175], v[104:107], v[72:75], v[160:175]
    ds_read_b64_tr_b16 v[92:93], v13 offset:32768
    ds_read_b64_tr_b16 v[94:95], v13 offset:33792
    v_mfma_f32_32x32x16_bf16 v[224:239], v[104:107], v[76:79], v[224:239]
    s_lshl_b32 s12, s66, 6
    s_add_u32 s12, s12, s8
    s_mul_i32 s13, s66, 114688
    s_add_u32 s13, s13, s9
    s_add_u32 s66, s66, 1
    s_and_b32 s66, s66, 15
    s_add_u32 m0, s10, 0
    s_add_u32 s14, s12, 0
    buffer_load_dwordx4 v8, s[40:43], s14 offen lds
    v_mfma_f32_32x32x16_bf16 v[176:191], v[108:111], v[72:75], v[176:191]
    s_add_u32 m0, s10, 1024
    s_add_u32 s14, s12, 16384
    buffer_load_dwordx4 v8, s[40:43], s14 offen lds
    v_mfma_f32_32x32x16_bf16 v[240:255], v[108:111], v[76:79], v[240:255]
    s_add_u32 m0, s10, 8192
    s_add_u32 s14, s13, 0
    buffer_load_dwordx4 v9, s[44:47], s14 offen lds
    v_mfma_f32_32x32x16_bf16 v[20:35], v[96:99], v[52:55], v[20:35]
    v_mfma_f32_32x32x16_bf16 v[36:51], v[100:103], v[52:55], v[36:51]
    s_waitcnt lgkmcnt(0)
    v_mfma_f32_32x32x16_bf16 v[128:143], v[80:83], v[64:67], v[128:143]
    ds_read_b128 v[72:75], v11 offset:24576
    ds_read_b128 v[76:79], v11 offset:26624
    v_mfma_f32_32x32x16_bf16 v[192:207], v[80:83], v[68:71], v[192:207]
    ds_read_b64_tr_b16 v[96:97], v12 offset:28672
    ds_read_b64_tr_b16 v[98:99], v12 offset:29696
    v_mfma_f32_32x32x16_bf16 v[144:159], v[84:87], v[64:67], v[144:159]
    ds_read_b64_tr_b16 v[100:101], v12 offset:36864
    ds_read_b64_tr_b16 v[102:103], v12 offset:37888
    v_mfma_f32_32x32x16_bf16 v[208:223], v[84:87], v[68:71], v[208:223]
    ds_read_b64_tr_b16 v[104:105], v13 offset:28672
    ds_read_b64_tr_b16 v[106:107], v13 offset:29696
    v_mfma_f32_32x32x16_bf16 v[160:175], v[88:91], v[64:67], v[160:175]
    ds_read_b64_tr_b16 v[108:109], v13 offset:36864
    ds_read_b64_tr_b16 v[110:111], v13 offset:37888
    v_mfma_f32_32x32x16_bf16 v[224:239], v[88:91], v[68:71], v[224:239]
    s_add_u32 m0, s10, 9216
    s_add_u32 s14, s13, 14336
    buffer_load_dwordx4 v9, s[44:47], s14 offen lds
    v_mfma_f32_32x32x16_bf16 v[176:191], v[92:95], v[64:67], v[176:191]
    s_add_u32 m0, s10, 16384
    s_add_u32 s14, s13, 0
    buffer_load_dwordx4 v9, s[48:51], s14 offen lds
    v_mfma_f32_32x32x16_bf16 v[240:255], v[92:95], v[68:71], v[240:255]
    s_add_u32 m0, s10, 17408
    s_add_u32 s14, s13, 14336
    buffer_load_dwordx4 v9, s[48:51], s14 offen lds
    v_mfma_f32_32x32x16_bf16 v[20:35], v[80:83], v[52:55], v[20:35]
    v_mfma_f32_32x32x16_bf16 v[36:51], v[84:87], v[52:55], v[36:51]
    s_waitcnt vmcnt(6) lgkmcnt(0)
    s_barrier
    v_mfma_f32_32x32x16_bf16 v[128:143], v[96:99], v[72:75], v[128:143]
    ds_read_b128 v[64:67], v14 offset:0
    ds_read_b128 v[68:71], v14 offset:2048
    v_mfma_f32_32x32x16_bf16 v[192:207], v[96:99], v[76:79], v[192:207]
    ds_read_b64_tr_b16 v[80:81], v16 offset:0
    ds_read_b64_tr_b16 v[82:83], v16 offset:1024
    v_mfma_f32_32x32x16_bf16 v[144:159], v[100:103], v[72:75], v[144:159]
    ds_read_b64_tr_b16 v[84:85], v16 offset:8192
    ds_read_b64_tr_b16 v[86:87], v16 offset:9216
    v_mfma_f32_32x32x16_bf16 v[208:223], v[100:103], v[76:79], v[208:223]
    ds_read_b64_tr_b16 v[88:89], v17 offset:0
    ds_read_b64_tr_b16 v[90:91], v17 offset:1024
    v_mfma_f32_32x32x16_bf16 v[160:175], v[104:107], v[72:75], v[160:175]
    ds_read_b64_tr_b16 v[92:93], v17 offset:8192
    ds_read_b64_tr_b16 v[94:95], v17 offset:9216
    v_mfma_f32_32x32x16_bf16 v[224:239], v[104:107], v[76:79], v[224:239]
    s_lshl_b32 s12, s66, 6
    s_add_u32 s12, s12, s8
    s_mul_i32 s13, s66, 114688
    s_add_u32 s13, s13, s9
    s_add_u32 s66, s66, 1
    s_and_b32 s66, s66, 15
    s_add_u32 m0, s10, 24576
    s_add_u32 s14, s12, 0
    buffer_load_dwordx4 v8, s[40:43], s14 offen lds
    v_mfma_f32_32x32x16_bf16 v[176:191], v[108:111], v[72:75], v[176:191]
    s_add_u32 m0, s10, 25600
    s_add_u32 s14, s12, 16384
    buffer_load_dwordx4 v8, s[40:43], s14 offen lds
    v_mfma_f32_32x32x16_bf16 v[240:255], v[108:111], v[76:79], v[240:255]
    s_add_u32 m0, s10, 32768
    s_add_u32 s14, s13, 0
    buffer_load_dwordx4 v9, s[44:47], s14 offen lds
    v_mfma_f32_32x32x16_bf16 v[20:35], v[96:99], v[52:55], v[20:35]
    v_mfma_f32_32x32x16_bf16 v[36:51], v[100:103], v[52:55], v[36:51]
    s_waitcnt lgkmcnt(0)
    v_mfma_f32_32x32x16_bf16 v[128:143], v[80:83], v[64:67], v[128:143]
    ds_read_b128 v[72:75], v15 offset:0
    ds_read_b128 v[76:79], v15 offset:2048
    v_mfma_f32_32x32x16_bf16 v[192:207], v[80:83], v[68:71], v[192:207]
    ds_read_b64_tr_b16 v[96:97], v16 offset:4096
    ds_read_b64_tr_b16 v[98:99], v16 offset:5120
    v_mfma_f32_32x32x16_bf16 v[144:159], v[84:87], v[64:67], v[144:159]
    ds_read_b64_tr_b16 v[100:101], v16 offset:12288
    ds_read_b64_tr_b16 v[102:103], v16 offset:13312
    v_mfma_f32_32x32x16_bf16 v[208:223], v[84:87], v[68:71], v[208:223]
    ds_read_b64_tr_b16 v[104:105], v17 offset:4096
    ds_read_b64_tr_b16 v[106:107], v17 offset:5120
    v_mfma_f32_32x32x16_bf16 v[160:175], v[88:91], v[64:67], v[160:175]
    ds_read_b64_tr_b16 v[108:109], v17 offset:12288
    ds_read_b64_tr_b16 v[110:111], v17 offset:13312
    v_mfma_f32_32x32x16_bf16 v[224:239], v[88:91], v[68:71], v[224:239]
    s_add_u32 m0, s10, 33792
    s_add_u32 s14, s13, 14336
    buffer_load_dwordx4 v9, s[44:47], s14 offen lds
    v_mfma_f32_32x32x16_bf16 v[176:191], v[92:95], v[64:67], v[176:191]
    s_add_u32 m0, s10, 40960
    s_add_u32 s14, s13, 0
    buffer_load_dwordx4 v9, s[48:51], s14 offen lds
    v_mfma_f32_32x32x16_bf16 v[240:255], v[92:95], v[68:71], v[240:255]
    s_add_u32 m0, s10, 41984
    s_add_u32 s14, s13, 14336
    buffer_load_dwordx4 v9, s[48:51], s14 offen lds
    v_mfma_f32_32x32x16_bf16 v[20:35], v[80:83], v[52:55], v[20:35]
    v_mfma_f32_32x32x16_bf16 v[36:51], v[84:87], v[52:55], v[36:51]
    s_waitcnt vmcnt(6) lgkmcnt(0)
    s_barrier
    v_mfma_f32_32x32x16_bf16 v[128:143], v[96:99], v[72:75], v[128:143]
    ds_read_b128 v[64:67], v10 offset:0
    ds_read_b128 v[68:71], v10 offset:2048
    v_mfma_f32_32x32x16_bf16 v[192:207], v[96:99], v[76:79], v[192:207]
    ds_read_b64_tr_b16 v[80:81], v12 offset:0
    ds_read_b64_tr_b16 v[82:83], v12 offset:1024
    v_mfma_f32_32x32x16_bf16 v[144:159], v[100:103], v[72:75], v[144:159]
    ds_read_b64_tr_b16 v[84:85], v12 offset:8192
    ds_read_b64_tr_b16 v[86:87], v12 offset:9216
    v_mfma_f32_32x32x16_bf16 v[208:223], v[100:103], v[76:79], v[208:223]
    ds_read_b64_tr_b16 v[88:89], v13 offset:0
    ds_read_b64_tr_b16 v[90:91], v13 offset:1024
    v_mfma_f32_32x32x16_bf16 v[160:175], v[104:107], v[72:75], v[160:175]
    ds_read_b64_tr_b16 v[92:93], v13 offset:8192
    ds_read_b64_tr_b16 v[94:95], v13 offset:9216
    v_mfma_f32_32x32x16_bf16 v[224:239], v[104:107], v[76:79], v[224:239]
    s_lshl_b32 s12, s66, 6
    s_add_u32 s12, s12, s8
    s_mul_i32 s13, s66, 114688
    s_add_u32 s13, s13, s9
    s_add_u32 s66, s66, 1
    s_and_b32 s66, s66, 15
    s_add_u32 m0, s10, 49152
    s_add_u32 s14, s12, 0
    buffer_load_dwordx4 v8, s[40:43], s14 offen lds
    v_mfma_f32_32x32x16_bf16 v[176:191], v[108:111], v[72:75], v[176:191]
    s_add_u32 m0, s10, 50176
    s_add_u32 s14, s12, 16384
    buffer_load_dwordx4 v8, s[40:43], s14 offen lds
    v_mfma_f32_32x32x16_bf16 v[240:255], v[108:111], v[76:79], v[240:255]
    s_add_u32 m0, s10, 57344
    s_add_u32 s14, s13, 0
    buffer_load_dwordx4 v9, s[44:47], s14 offen lds
    v_mfma_f32_32x32x16_bf16 v[20:35], v[96:99], v[52:55], v[20:35]
    v_mfma_f32_32x32x16_bf16 v[36:51], v[100:103], v[52:55], v[36:51]
    s_waitcnt lgkmcnt(0)
    v_mfma_f32_32x32x16_bf16 v[128:143], v[80:83], v[64:67], v[128:143]
    ds_read_b128 v[72:75], v11 offset:0
    ds_read_b128 v[76:79], v11 offset:2048
    v_mfma_f32_32x32x16_bf16 v[192:207], v[80:83], v[68:71], v[192:207]
    ds_read_b64_tr_b16 v[96:97], v12 offset:4096
    ds_read_b64_tr_b16 v[98:99], v12 offset:5120
    v_mfma_f32_32x32x16_bf16 v[144:159], v[84:87], v[64:67], v[144:159]
    ds_read_b64_tr_b16 v[100:101], v12 offset:12288
    ds_read_b64_tr_b16 v[102:103], v12 offset:13312
    v_mfma_f32_32x32x16_bf16 v[208:223], v[84:87], v[68:71], v[208:223]
    ds_read_b64_tr_b16 v[104:105], v13 offset:4096
    ds_read_b64_tr_b16 v[106:107], v13 offset:5120
    v_mfma_f32_32x32x16_bf16 v[160:175], v[88:91], v[64:67], v[160:175]
    ds_read_b64_tr_b16 v[108:109], v13 offset:12288
    ds_read_b64_tr_b16 v[110:111], v13 offset:13312
    v_mfma_f32_32x32x16_bf16 v[224:239], v[88:91], v[68:71], v[224:239]
    s_add_u32 m0, s10, 58368
    s_add_u32 s14, s13, 14336
    buffer_load_dwordx4 v9, s[44:47], s14 offen lds
    v_mfma_f32_32x32x16_bf16 v[176:191], v[92:95], v[64:67], v[176:191]
    s_add_u32 m0, s10, 65536
    s_add_u32 s14, s13, 0
    buffer_load_dwordx4 v9, s[48:51], s14 offen lds
    v_mfma_f32_32x32x16_bf16 v[240:255], v[92:95], v[68:71], v[240:255]
    s_add_u32 m0, s10, 66560
    s_add_u32 s14, s13, 14336
    buffer_load_dwordx4 v9, s[48:51], s14 offen lds
    v_mfma_f32_32x32x16_bf16 v[20:35], v[80:83], v[52:55], v[20:35]
    v_mfma_f32_32x32x16_bf16 v[36:51], v[84:87], v[52:55], v[36:51]
    s_waitcnt vmcnt(6) lgkmcnt(0)
    s_barrier
    v_mfma_f32_32x32x16_bf16 v[128:143], v[96:99], v[72:75], v[128:143]
    ds_read_b128 v[64:67], v10 offset:24576
    ds_read_b128 v[68:71], v10 offset:26624
    v_mfma_f32_32x32x16_bf16 v[192:207], v[96:99], v[76:79], v[192:207]
    ds_read_b64_tr_b16 v[80:81], v12 offset:24576
    ds_read_b64_tr_b16 v[82:83], v12 offset:25600
    v_mfma_f32_32x32x16_bf16 v[144:159], v[100:103], v[72:75], v[144:159]
    ds_read_b64_tr_b16 v[84:85], v12 offset:32768
    ds_read_b64_tr_b16 v[86:87], v12 offset:33792
    v_mfma_f32_32x32x16_bf16 v[208:223], v[100:103], v[76:79], v[208:223]
    ds_read_b64_tr_b16 v[88:89], v13 offset:24576
    ds_read_b64_tr_b16 v[90:91], v13 offset:25600
    v_mfma_f32_32x32x16_bf16 v[160:175], v[104:107], v[72:75], v[160:175]
    ds_read_b64_tr_b16 v[92:93], v13 offset:32768
    ds_read_b64_tr_b16 v[94:95], v13 offset:33792
    v_mfma_f32_32x32x16_bf16 v[224:239], v[104:107], v[76:79], v[224:239]
    s_lshl_b32 s12, s66, 6
    s_add_u32 s12, s12, s8
    s_mul_i32 s13, s66, 114688
    s_add_u32 s13, s13, s9
    s_add_u32 s66, s66, 1
    s_and_b32 s66, s66, 15
    s_add_u32 m0, s10, 0
    s_add_u32 s14, s12, 0
    buffer_load_dwordx4 v8, s[40:43], s14 offen lds
    v_mfma_f32_32x32x16_bf16 v[176:191], v[108:111], v[72:75], v[176:191]
    s_add_u32 m0, s10, 1024
    s_add_u32 s14, s12, 16384
    buffer_load_dwordx4 v8, s[40:43], s14 offen lds
    v_mfma_f32_32x32x16_bf16 v[240:255], v[108:111], v[76:79], v[240:255]
    s_add_u32 m0, s10, 8192
    s_add_u32 s14, s13, 0
    buffer_load_dwordx4 v9, s[44:47], s14 offen lds
    v_mfma_f32_32x32x16_bf16 v[20:35], v[96:99], v[52:55], v[20:35]
    v_mfma_f32_32x32x16_bf16 v[36:51], v[100:103], v[52:55], v[36:51]
    s_branch GU_j_24
GU_wm1_23:
    s_waitcnt lgkmcnt(0)
    v_mfma_f32_32x32x16_bf16 v[128:143], v[80:83], v[64:67], v[128:143]
    ds_read_b128 v[72:75], v11 offset:0
    ds_read_b128 v[76:79], v11 offset:2048
    v_mfma_f32_32x32x16_bf16 v[192:207], v[80:83], v[68:71], v[192:207]
    ds_read_b64_tr_b16 v[96:97], v12 offset:4096
    ds_read_b64_tr_b16 v[98:99], v12 offset:5120
    v_mfma_f32_32x32x16_bf16 v[144:159], v[84:87], v[64:67], v[144:159]
    ds_read_b64_tr_b16 v[100:101], v12 offset:12288
    ds_read_b64_tr_b16 v[102:103], v12 offset:13312
    v_mfma_f32_32x32x16_bf16 v[208:223], v[84:87], v[68:71], v[208:223]
    ds_read_b64_tr_b16 v[104:105], v13 offset:4096
    ds_read_b64_tr_b16 v[106:107], v13 offset:5120
    v_mfma_f32_32x32x16_bf16 v[160:175], v[88:91], v[64:67], v[160:175]
    ds_read_b64_tr_b16 v[108:109], v13 offset:12288
    ds_read_b64_tr_b16 v[110:111], v13 offset:13312
    v_mfma_f32_32x32x16_bf16 v[224:239], v[88:91], v[68:71], v[224:239]
    v_mfma_f32_32x32x16_bf16 v[176:191], v[92:95], v[64:67], v[176:191]
    v_mfma_f32_32x32x16_bf16 v[240:255], v[92:95], v[68:71], v[240:255]
    v_mfma_f32_32x32x16_bf16 v[20:35], v[88:91], v[52:55], v[20:35]
    v_mfma_f32_32x32x16_bf16 v[36:51], v[92:95], v[52:55], v[36:51]
    s_waitcnt vmcnt(9) lgkmcnt(0)
    s_barrier
    v_mfma_f32_32x32x16_bf16 v[128:143], v[96:99], v[72:75], v[128:143]
    ds_read_b128 v[64:67], v10 offset:24576
    ds_read_b128 v[68:71], v10 offset:26624
    v_mfma_f32_32x32x16_bf16 v[192:207], v[96:99], v[76:79], v[192:207]
    ds_read_b64_tr_b16 v[80:81], v12 offset:24576
    ds_read_b64_tr_b16 v[82:83], v12 offset:25600
    v_mfma_f32_32x32x16_bf16 v[144:159], v[100:103], v[72:75], v[144:159]
    ds_read_b64_tr_b16 v[84:85], v12 offset:32768
    ds_read_b64_tr_b16 v[86:87], v12 offset:33792
    v_mfma_f32_32x32x16_bf16 v[208:223], v[100:103], v[76:79], v[208:223]
    ds_read_b64_tr_b16 v[88:89], v13 offset:24576
    ds_read_b64_tr_b16 v[90:91], v13 offset:25600
    v_mfma_f32_32x32x16_bf16 v[160:175], v[104:107], v[72:75], v[160:175]
    ds_read_b64_tr_b16 v[92:93], v13 offset:32768
    ds_read_b64_tr_b16 v[94:95], v13 offset:33792
    v_mfma_f32_32x32x16_bf16 v[224:239], v[104:107], v[76:79], v[224:239]
    s_lshl_b32 s12, s66, 6
    s_add_u32 s12, s12, s8
    s_mul_i32 s13, s66, 114688
    s_add_u32 s13, s13, s9
    s_add_u32 s66, s66, 1
    s_and_b32 s66, s66, 15
    s_add_u32 m0, s10, 0
    s_add_u32 s14, s12, 0
    buffer_load_dwordx4 v8, s[40:43], s14 offen lds
    v_mfma_f32_32x32x16_bf16 v[176:191], v[108:111], v[72:75], v[176:191]
    s_add_u32 m0, s10, 1024
    s_add_u32 s14, s12, 16384
    buffer_load_dwordx4 v8, s[40:43], s14 offen lds
    v_mfma_f32_32x32x16_bf16 v[240:255], v[108:111], v[76:79], v[240:255]
    s_add_u32 m0, s10, 8192
    s_add_u32 s14, s13, 0
    buffer_load_dwordx4 v9, s[44:47], s14 offen lds
    v_mfma_f32_32x32x16_bf16 v[20:35], v[104:107], v[52:55], v[20:35]
    v_mfma_f32_32x32x16_bf16 v[36:51], v[108:111], v[52:55], v[36:51]
    s_waitcnt lgkmcnt(0)
    v_mfma_f32_32x32x16_bf16 v[128:143], v[80:83], v[64:67], v[128:143]
    ds_read_b128 v[72:75], v11 offset:24576
    ds_read_b128 v[76:79], v11 offset:26624
    v_mfma_f32_32x32x16_bf16 v[192:207], v[80:83], v[68:71], v[192:207]
    ds_read_b64_tr_b16 v[96:97], v12 offset:28672
    ds_read_b64_tr_b16 v[98:99], v12 offset:29696
    v_mfma_f32_32x32x16_bf16 v[144:159], v[84:87], v[64:67], v[144:159]
    ds_read_b64_tr_b16 v[100:101], v12 offset:36864
    ds_read_b64_tr_b16 v[102:103], v12 offset:37888
    v_mfma_f32_32x32x16_bf16 v[208:223], v[84:87], v[68:71], v[208:223]
    ds_read_b64_tr_b16 v[104:105], v13 offset:28672
    ds_read_b64_tr_b16 v[106:107], v13 offset:29696
    v_mfma_f32_32x32x16_bf16 v[160:175], v[88:91], v[64:67], v[160:175]
    ds_read_b64_tr_b16 v[108:109], v13 offset:36864
    ds_read_b64_tr_b16 v[110:111], v13 offset:37888
    v_mfma_f32_32x32x16_bf16 v[224:239], v[88:91], v[68:71], v[224:239]
    s_add_u32 m0, s10, 9216
    s_add_u32 s14, s13, 14336
    buffer_load_dwordx4 v9, s[44:47], s14 offen lds
    v_mfma_f32_32x32x16_bf16 v[176:191], v[92:95], v[64:67], v[176:191]
    s_add_u32 m0, s10, 16384
    s_add_u32 s14, s13, 0
    buffer_load_dwordx4 v9, s[48:51], s14 offen lds
    v_mfma_f32_32x32x16_bf16 v[240:255], v[92:95], v[68:71], v[240:255]
    s_add_u32 m0, s10, 17408
    s_add_u32 s14, s13, 14336
    buffer_load_dwordx4 v9, s[48:51], s14 offen lds
    v_mfma_f32_32x32x16_bf16 v[20:35], v[88:91], v[52:55], v[20:35]
    v_mfma_f32_32x32x16_bf16 v[36:51], v[92:95], v[52:55], v[36:51]
    s_waitcnt vmcnt(6) lgkmcnt(0)
    s_barrier
    v_mfma_f32_32x32x16_bf16 v[128:143], v[96:99], v[72:75], v[128:143]
    ds_read_b128 v[64:67], v14 offset:0
    ds_read_b128 v[68:71], v14 offset:2048
    v_mfma_f32_32x32x16_bf16 v[192:207], v[96:99], v[76:79], v[192:207]
    ds_read_b64_tr_b16 v[80:81], v16 offset:0
    ds_read_b64_tr_b16 v[82:83], v16 offset:1024
    v_mfma_f32_32x32x16_bf16 v[144:159], v[100:103], v[72:75], v[144:159]
    ds_read_b64_tr_b16 v[84:85], v16 offset:8192
    ds_read_b64_tr_b16 v[86:87], v16 offset:9216
    v_mfma_f32_32x32x16_bf16 v[208:223], v[100:103], v[76:79], v[208:223]
    ds_read_b64_tr_b16 v[88:89], v17 offset:0
    ds_read_b64_tr_b16 v[90:91], v17 offset:1024
    v_mfma_f32_32x32x16_bf16 v[160:175], v[104:107], v[72:75], v[160:175]
    ds_read_b64_tr_b16 v[92:93], v17 offset:8192
    ds_read_b64_tr_b16 v[94:95], v17 offset:9216
    v_mfma_f32_32x32x16_bf16 v[224:239], v[104:107], v[76:79], v[224:239]
    s_lshl_b32 s12, s66, 6
    s_add_u32 s12, s12, s8
    s_mul_i32 s13, s66, 114688
    s_add_u32 s13, s13, s9
    s_add_u32 s66, s66, 1
    s_and_b32 s66, s66, 15
    s_add_u32 m0, s10, 24576
    s_add_u32 s14, s12, 0
    buffer_load_dwordx4 v8, s[40:43], s14 offen lds
    v_mfma_f32_32x32x16_bf16 v[176:191], v[108:111], v[72:75], v[176:191]
    s_add_u32 m0, s10, 25600
    s_add_u32 s14, s12, 16384
    buffer_load_dwordx4 v8, s[40:43], s14 offen lds
    v_mfma_f32_32x32x16_bf16 v[240:255], v[108:111], v[76:79], v[240:255]
    s_add_u32 m0, s10, 32768
    s_add_u32 s14, s13, 0
    buffer_load_dwordx4 v9, s[44:47], s14 offen lds
    v_mfma_f32_32x32x16_bf16 v[20:35], v[104:107], v[52:55], v[20:35]
    v_mfma_f32_32x32x16_bf16 v[36:51], v[108:111], v[52:55], v[36:51]
    s_waitcnt lgkmcnt(0)
    v_mfma_f32_32x32x16_bf16 v[128:143], v[80:83], v[64:67], v[128:143]
    ds_read_b128 v[72:75], v15 offset:0
    ds_read_b128 v[76:79], v15 offset:2048
    v_mfma_f32_32x32x16_bf16 v[192:207], v[80:83], v[68:71], v[192:207]
    ds_read_b64_tr_b16 v[96:97], v16 offset:4096
    ds_read_b64_tr_b16 v[98:99], v16 offset:5120
    v_mfma_f32_32x32x16_bf16 v[144:159], v[84:87], v[64:67], v[144:159]
    ds_read_b64_tr_b16 v[100:101], v16 offset:12288
    ds_read_b64_tr_b16 v[102:103], v16 offset:13312
    v_mfma_f32_32x32x16_bf16 v[208:223], v[84:87], v[68:71], v[208:223]
    ds_read_b64_tr_b16 v[104:105], v17 offset:4096
    ds_read_b64_tr_b16 v[106:107], v17 offset:5120
    v_mfma_f32_32x32x16_bf16 v[160:175], v[88:91], v[64:67], v[160:175]
    ds_read_b64_tr_b16 v[108:109], v17 offset:12288
    ds_read_b64_tr_b16 v[110:111], v17 offset:13312
    v_mfma_f32_32x32x16_bf16 v[224:239], v[88:91], v[68:71], v[224:239]
    s_add_u32 m0, s10, 33792
    s_add_u32 s14, s13, 14336
    buffer_load_dwordx4 v9, s[44:47], s14 offen lds
    v_mfma_f32_32x32x16_bf16 v[176:191], v[92:95], v[64:67], v[176:191]
    s_add_u32 m0, s10, 40960
    s_add_u32 s14, s13, 0
    buffer_load_dwordx4 v9, s[48:51], s14 offen lds
    v_mfma_f32_32x32x16_bf16 v[240:255], v[92:95], v[68:71], v[240:255]
    s_add_u32 m0, s10, 41984
    s_add_u32 s14, s13, 14336
    buffer_load_dwordx4 v9, s[48:51], s14 offen lds
    v_mfma_f32_32x32x16_bf16 v[20:35], v[88:91], v[52:55], v[20:35]
    v_mfma_f32_32x32x16_bf16 v[36:51], v[92:95], v[52:55], v[36:51]
    s_waitcnt vmcnt(6) lgkmcnt(0)
    s_barrier
    v_mfma_f32_32x32x16_bf16 v[128:143], v[96:99], v[72:75], v[128:143]
    ds_read_b128 v[64:67], v10 offset:0
    ds_read_b128 v[68:71], v10 offset:2048
    v_mfma_f32_32x32x16_bf16 v[192:207], v[96:99], v[76:79], v[192:207]
    ds_read_b64_tr_b16 v[80:81], v12 offset:0
    ds_read_b64_tr_b16 v[82:83], v12 offset:1024
    v_mfma_f32_32x32x16_bf16 v[144:159], v[100:103], v[72:75], v[144:159]
    ds_read_b64_tr_b16 v[84:85], v12 offset:8192
    ds_read_b64_tr_b16 v[86:87], v12 offset:9216
    v_mfma_f32_32x32x16_bf16 v[208:223], v[100:103], v[76:79], v[208:223]
    ds_read_b64_tr_b16 v[88:89], v13 offset:0
    ds_read_b64_tr_b16 v[90:91], v13 offset:1024
    v_mfma_f32_32x32x16_bf16 v[160:175], v[104:107], v[72:75], v[160:175]
    ds_read_b64_tr_b16 v[92:93], v13 offset:8192
    ds_read_b64_tr_b16 v[94:95], v13 offset:9216
    v_mfma_f32_32x32x16_bf16 v[224:239], v[104:107], v[76:79], v[224:239]
    s_lshl_b32 s12, s66, 6
    s_add_u32 s12, s12, s8
    s_mul_i32 s13, s66, 114688
    s_add_u32 s13, s13, s9
    s_add_u32 s66, s66, 1
    s_and_b32 s66, s66, 15
    s_add_u32 m0, s10, 49152
    s_add_u32 s14, s12, 0
    buffer_load_dwordx4 v8, s[40:43], s14 offen lds
    v_mfma_f32_32x32x16_bf16 v[176:191], v[108:111], v[72:75], v[176:191]
    s_add_u32 m0, s10, 50176
    s_add_u32 s14, s12, 16384
    buffer_load_dwordx4 v8, s[40:43], s14 offen lds
    v_mfma_f32_32x32x16_bf16 v[240:255], v[108:111], v[76:79], v[240:255]
    s_add_u32 m0, s10, 57344
    s_add_u32 s14, s13, 0
    buffer_load_dwordx4 v9, s[44:47], s14 offen lds
    v_mfma_f32_32x32x16_bf16 v[20:35], v[104:107], v[52:55], v[20:35]
    v_mfma_f32_32x32x16_bf16 v[36:51], v[108:111], v[52:55], v[36:51]
    s_waitcnt lgkmcnt(0)
    v_mfma_f32_32x32x16_bf16 v[128:143], v[80:83], v[64:67], v[128:143]
    ds_read_b128 v[72:75], v11 offset:0
    ds_read_b128 v[76:79], v11 offset:2048
    v_mfma_f32_32x32x16_bf16 v[192:207], v[80:83], v[68:71], v[192:207]
    ds_read_b64_tr_b16 v[96:97], v12 offset:4096
    ds_read_b64_tr_b16 v[98:99], v12 offset:5120
    v_mfma_f32_32x32x16_bf16 v[144:159], v[84:87], v[64:67], v[144:159]
    ds_read_b64_tr_b16 v[100:101], v12 offset:12288
    ds_read_b64_tr_b16 v[102:103], v12 offset:13312
    v_mfma_f32_32x32x16_bf16 v[208:223], v[84:87], v[68:71], v[208:223]
    ds_read_b64_tr_b16 v[104:105], v13 offset:4096
    ds_read_b64_tr_b16 v[106:107], v13 offset:5120
    v_mfma_f32_32x32x16_bf16 v[160:175], v[88:91], v[64:67], v[160:175]
    ds_read_b64_tr_b16 v[108:109], v13 offset:12288
    ds_read_b64_tr_b16 v[110:111], v13 offset:13312
    v_mfma_f32_32x32x16_bf16 v[224:239], v[88:91], v[68:71], v[224:239]
    s_add_u32 m0, s10, 58368
    s_add_u32 s14, s13, 14336
    buffer_load_dwordx4 v9, s[44:47], s14 offen lds
    v_mfma_f32_32x32x16_bf16 v[176:191], v[92:95], v[64:67], v[176:191]
    s_add_u32 m0, s10, 65536
    s_add_u32 s14, s13, 0
    buffer_load_dwordx4 v9, s[48:51], s14 offen lds
    v_mfma_f32_32x32x16_bf16 v[240:255], v[92:95], v[68:71], v[240:255]
    s_add_u32 m0, s10, 66560
    s_add_u32 s14, s13, 14336
    buffer_load_dwordx4 v9, s[48:51], s14 offen lds
    v_mfma_f32_32x32x16_bf16 v[20:35], v[88:91], v[52:55], v[20:35]
    v_mfma_f32_32x32x16_bf16 v[36:51], v[92:95], v[52:55], v[36:51]
    s_waitcnt vmcnt(6) lgkmcnt(0)
    s_barrier
    v_mfma_f32_32x32x16_bf16 v[128:143], v[96:99], v[72:75], v[128:143]
    ds_read_b128 v[64:67], v10 offset:24576
    ds_read_b128 v[68:71], v10 offset:26624
    v_mfma_f32_32x32x16_bf16 v[192:207], v[96:99], v[76:79], v[192:207]
    ds_read_b64_tr_b16 v[80:81], v12 offset:24576
    ds_read_b64_tr_b16 v[82:83], v12 offset:25600
    v_mfma_f32_32x32x16_bf16 v[144:159], v[100:103], v[72:75], v[144:159]
    ds_read_b64_tr_b16 v[84:85], v12 offset:32768
    ds_read_b64_tr_b16 v[86:87], v12 offset:33792
    v_mfma_f32_32x32x16_bf16 v[208:223], v[100:103], v[76:79], v[208:223]
    ds_read_b64_tr_b16 v[88:89], v13 offset:24576
    ds_read_b64_tr_b16 v[90:91], v13 offset:25600
    v_mfma_f32_32x32x16_bf16 v[160:175], v[104:107], v[72:75], v[160:175]
    ds_read_b64_tr_b16 v[92:93], v13 offset:32768
    ds_read_b64_tr_b16 v[94:95], v13 offset:33792
    v_mfma_f32_32x32x16_bf16 v[224:239], v[104:107], v[76:79], v[224:239]
    s_lshl_b32 s12, s66, 6
    s_add_u32 s12, s12, s8
    s_mul_i32 s13, s66, 114688
    s_add_u32 s13, s13, s9
    s_add_u32 s66, s66, 1
    s_and_b32 s66, s66, 15
    s_add_u32 m0, s10, 0
    s_add_u32 s14, s12, 0
    buffer_load_dwordx4 v8, s[40:43], s14 offen lds
    v_mfma_f32_32x32x16_bf16 v[176:191], v[108:111], v[72:75], v[176:191]
    s_add_u32 m0, s10, 1024
    s_add_u32 s14, s12, 16384
    buffer_load_dwordx4 v8, s[40:43], s14 offen lds
    v_mfma_f32_32x32x16_bf16 v[240:255], v[108:111], v[76:79], v[240:255]
    s_add_u32 m0, s10, 8192
    s_add_u32 s14, s13, 0
    buffer_load_dwordx4 v9, s[44:47], s14 offen lds
    v_mfma_f32_32x32x16_bf16 v[20:35], v[104:107], v[52:55], v[20:35]
    v_mfma_f32_32x32x16_bf16 v[36:51], v[108:111], v[52:55], v[36:51]
GU_j_24:
    v_mov_b32 v57, 0
    global_load_dword v56, v57, s[36:37]
    v_lshrrev_b32 v58, 5, v1
    v_lshlrev_b32 v58, 4, v58
    s_mul_i32 s67, s4, 14336
    s_lshl_b32 s68, s5, 9
    s_add_u32 s67, s67, s68
    s_lshl_b32 s68, s7, 8
    s_add_u32 s67, s67, s68
    s_lshl_b32 s68, s6, 7
    s_add_u32 s67, s67, s68
    s_add_u32 s67, s67, 262144
    s_add_u32 s68, s67, 7168
    s_mov_b32 exec_lo, 0x1
    s_mov_b32 exec_hi, 0x1
    buffer_store_dwordx4 v[20:23], v58, s[52:55], s67 offen offset:0 sc1
    buffer_store_dwordx4 v[24:27], v58, s[52:55], s67 offen offset:32 sc1
    buffer_store_dwordx4 v[28:31], v58, s[52:55], s67 offen offset:64 sc1
    buffer_store_dwordx4 v[32:35], v58, s[52:55], s67 offen offset:96 sc1
    buffer_store_dwordx4 v[36:39], v58, s[52:55], s68 offen offset:0 sc1
    buffer_store_dwordx4 v[40:43], v58, s[52:55], s68 offen offset:32 sc1
    buffer_store_dwordx4 v[44:47], v58, s[52:55], s68 offen offset:64 sc1
    buffer_store_dwordx4 v[48:51], v58, s[52:55], s68 offen offset:96 sc1
    s_mov_b64 exec, -1
    s_waitcnt lgkmcnt(0)
    v_mfma_f32_32x32x16_bf16 v[128:143], v[80:83], v[64:67], v[128:143]
    ds_read_b128 v[72:75], v11 offset:24576
    ds_read_b128 v[76:79], v11 offset:26624
    v_mfma_f32_32x32x16_bf16 v[192:207], v[80:83], v[68:71], v[192:207]
    ds_read_b64_tr_b16 v[96:97], v12 offset:28672
    ds_read_b64_tr_b16 v[98:99], v12 offset:29696
    v_mfma_f32_32x32x16_bf16 v[144:159], v[84:87], v[64:67], v[144:159]
    ds_read_b64_tr_b16 v[100:101], v12 offset:36864
    ds_read_b64_tr_b16 v[102:103], v12 offset:37888
    v_mfma_f32_32x32x16_bf16 v[208:223], v[84:87], v[68:71], v[208:223]
    ds_read_b64_tr_b16 v[104:105], v13 offset:28672
    ds_read_b64_tr_b16 v[106:107], v13 offset:29696
    v_mfma_f32_32x32x16_bf16 v[160:175], v[88:91], v[64:67], v[160:175]
    ds_read_b64_tr_b16 v[108:109], v13 offset:36864
    ds_read_b64_tr_b16 v[110:111], v13 offset:37888
    v_mfma_f32_32x32x16_bf16 v[224:239], v[88:91], v[68:71], v[224:239]
    s_add_u32 m0, s10, 9216
    s_add_u32 s14, s13, 14336
    buffer_load_dwordx4 v9, s[44:47], s14 offen lds
    v_mfma_f32_32x32x16_bf16 v[176:191], v[92:95], v[64:67], v[176:191]
    s_add_u32 m0, s10, 16384
    s_add_u32 s14, s13, 0
    buffer_load_dwordx4 v9, s[48:51], s14 offen lds
    v_mfma_f32_32x32x16_bf16 v[240:255], v[92:95], v[68:71], v[240:255]
    s_add_u32 m0, s10, 17408
    s_add_u32 s14, s13, 14336
    buffer_load_dwordx4 v9, s[48:51], s14 offen lds
    s_waitcnt vmcnt(6) lgkmcnt(0)
    s_barrier
    v_mfma_f32_32x32x16_bf16 v[128:143], v[96:99], v[72:75], v[128:143]
    ds_read_b128 v[64:67], v14 offset:0
    ds_read_b128 v[68:71], v14 offset:2048
    v_mfma_f32_32x32x16_bf16 v[192:207], v[96:99], v[76:79], v[192:207]
    ds_read_b64_tr_b16 v[80:81], v16 offset:0
    ds_read_b64_tr_b16 v[82:83], v16 offset:1024
    v_mfma_f32_32x32x16_bf16 v[144:159], v[100:103], v[72:75], v[144:159]
    ds_read_b64_tr_b16 v[84:85], v16 offset:8192
    ds_read_b64_tr_b16 v[86:87], v16 offset:9216
    v_mfma_f32_32x32x16_bf16 v[208:223], v[100:103], v[76:79], v[208:223]
    ds_read_b64_tr_b16 v[88:89], v17 offset:0
    ds_read_b64_tr_b16 v[90:91], v17 offset:1024
    v_mfma_f32_32x32x16_bf16 v[160:175], v[104:107], v[72:75], v[160:175]
    ds_read_b64_tr_b16 v[92:93], v17 offset:8192
    ds_read_b64_tr_b16 v[94:95], v17 offset:9216
    v_mfma_f32_32x32x16_bf16 v[224:239], v[104:107], v[76:79], v[224:239]
    s_lshl_b32 s12, s66, 6
    s_add_u32 s12, s12, s8
    s_mul_i32 s13, s66, 114688
    s_add_u32 s13, s13, s9
    s_add_u32 s66, s66, 1
    s_and_b32 s66, s66, 15
    s_add_u32 m0, s10, 24576
    s_add_u32 s14, s12, 0
    buffer_load_dwordx4 v8, s[40:43], s14 offen lds
    v_mfma_f32_32x32x16_bf16 v[176:191], v[108:111], v[72:75], v[176:191]
    s_add_u32 m0, s10, 25600
    s_add_u32 s14, s12, 16384
    buffer_load_dwordx4 v8, s[40:43], s14 offen lds
    v_mfma_f32_32x32x16_bf16 v[240:255], v[108:111], v[76:79], v[240:255]
    s_add_u32 m0, s10, 32768
    s_add_u32 s14, s13, 0
    buffer_load_dwordx4 v9, s[44:47], s14 offen lds
    s_waitcnt lgkmcnt(0)
    v_mfma_f32_32x32x16_bf16 v[128:143], v[80:83], v[64:67], v[128:143]
    ds_read_b128 v[72:75], v15 offset:0
    ds_read_b128 v[76:79], v15 offset:2048
    v_mfma_f32_32x32x16_bf16 v[192:207], v[80:83], v[68:71], v[192:207]
    ds_read_b64_tr_b16 v[96:97], v16 offset:4096
    ds_read_b64_tr_b16 v[98:99], v16 offset:5120
    v_mfma_f32_32x32x16_bf16 v[144:159], v[84:87], v[64:67], v[144:159]
    ds_read_b64_tr_b16 v[100:101], v16 offset:12288
    ds_read_b64_tr_b16 v[102:103], v16 offset:13312
    v_mfma_f32_32x32x16_bf16 v[208:223], v[84:87], v[68:71], v[208:223]
    ds_read_b64_tr_b16 v[104:105], v17 offset:4096
    ds_read_b64_tr_b16 v[106:107], v17 offset:5120
    v_mfma_f32_32x32x16_bf16 v[160:175], v[88:91], v[64:67], v[160:175]
    ds_read_b64_tr_b16 v[108:109], v17 offset:12288
    ds_read_b64_tr_b16 v[110:111], v17 offset:13312
    v_mfma_f32_32x32x16_bf16 v[224:239], v[88:91], v[68:71], v[224:239]
    s_add_u32 m0, s10, 33792
    s_add_u32 s14, s13, 14336
    buffer_load_dwordx4 v9, s[44:47], s14 offen lds
    v_mfma_f32_32x32x16_bf16 v[176:191], v[92:95], v[64:67], v[176:191]
    s_add_u32 m0, s10, 40960
    s_add_u32 s14, s13, 0
    buffer_load_dwordx4 v9, s[48:51], s14 offen lds
    v_mfma_f32_32x32x16_bf16 v[240:255], v[92:95], v[68:71], v[240:255]
    s_add_u32 m0, s10, 41984
    s_add_u32 s14, s13, 14336
    buffer_load_dwordx4 v9, s[48:51], s14 offen lds
    s_waitcnt vmcnt(6) lgkmcnt(0)
    s_barrier
    v_mfma_f32_32x32x16_bf16 v[128:143], v[96:99], v[72:75], v[128:143]
    ds_read_b128 v[64:67], v10 offset:0
    ds_read_b128 v[68:71], v10 offset:2048
    v_mfma_f32_32x32x16_bf16 v[192:207], v[96:99], v[76:79], v[192:207]
    ds_read_b64_tr_b16 v[80:81], v12 offset:0
    ds_read_b64_tr_b16 v[82:83], v12 offset:1024
    v_mfma_f32_32x32x16_bf16 v[144:159], v[100:103], v[72:75], v[144:159]
    ds_read_b64_tr_b16 v[84:85], v12 offset:8192
    ds_read_b64_tr_b16 v[86:87], v12 offset:9216
    v_mfma_f32_32x32x16_bf16 v[208:223], v[100:103], v[76:79], v[208:223]
    ds_read_b64_tr_b16 v[88:89], v13 offset:0
    ds_read_b64_tr_b16 v[90:91], v13 offset:1024
    v_mfma_f32_32x32x16_bf16 v[160:175], v[104:107], v[72:75], v[160:175]
    ds_read_b64_tr_b16 v[92:93], v13 offset:8192
    ds_read_b64_tr_b16 v[94:95], v13 offset:9216
    v_mfma_f32_32x32x16_bf16 v[224:239], v[104:107], v[76:79], v[224:239]
    s_lshl_b32 s12, s66, 6
    s_add_u32 s12, s12, s8
    s_mul_i32 s13, s66, 114688
    s_add_u32 s13, s13, s9
    s_add_u32 s66, s66, 1
    s_and_b32 s66, s66, 15
    s_add_u32 m0, s10, 49152
    s_add_u32 s14, s12, 0
    buffer_load_dwordx4 v8, s[40:43], s14 offen lds
    v_mfma_f32_32x32x16_bf16 v[176:191], v[108:111], v[72:75], v[176:191]
    s_add_u32 m0, s10, 50176
    s_add_u32 s14, s12, 16384
    buffer_load_dwordx4 v8, s[40:43], s14 offen lds
    v_mfma_f32_32x32x16_bf16 v[240:255], v[108:111], v[76:79], v[240:255]
    s_add_u32 m0, s10, 57344
    s_add_u32 s14, s13, 0
    buffer_load_dwordx4 v9, s[44:47], s14 offen lds
    s_waitcnt lgkmcnt(0)
    v_mfma_f32_32x32x16_bf16 v[128:143], v[80:83], v[64:67], v[128:143]
    ds_read_b128 v[72:75], v11 offset:0
    ds_read_b128 v[76:79], v11 offset:2048
    v_mfma_f32_32x32x16_bf16 v[192:207], v[80:83], v[68:71], v[192:207]
    ds_read_b64_tr_b16 v[96:97], v12 offset:4096
    ds_read_b64_tr_b16 v[98:99], v12 offset:5120
    v_mfma_f32_32x32x16_bf16 v[144:159], v[84:87], v[64:67], v[144:159]
    ds_read_b64_tr_b16 v[100:101], v12 offset:12288
    ds_read_b64_tr_b16 v[102:103], v12 offset:13312
    v_mfma_f32_32x32x16_bf16 v[208:223], v[84:87], v[68:71], v[208:223]
    ds_read_b64_tr_b16 v[104:105], v13 offset:4096
    ds_read_b64_tr_b16 v[106:107], v13 offset:5120
    v_mfma_f32_32x32x16_bf16 v[160:175], v[88:91], v[64:67], v[160:175]
    ds_read_b64_tr_b16 v[108:109], v13 offset:12288
    ds_read_b64_tr_b16 v[110:111], v13 offset:13312
    v_mfma_f32_32x32x16_bf16 v[224:239], v[88:91], v[68:71], v[224:239]
    s_add_u32 m0, s10, 58368
    s_add_u32 s14, s13, 14336
    buffer_load_dwordx4 v9, s[44:47], s14 offen lds
    v_mfma_f32_32x32x16_bf16 v[176:191], v[92:95], v[64:67], v[176:191]
    s_add_u32 m0, s10, 65536
    s_add_u32 s14, s13, 0
    buffer_load_dwordx4 v9, s[48:51], s14 offen lds
    v_mfma_f32_32x32x16_bf16 v[240:255], v[92:95], v[68:71], v[240:255]
    s_add_u32 m0, s10, 66560
    s_add_u32 s14, s13, 14336
    buffer_load_dwordx4 v9, s[48:51], s14 offen lds
    s_waitcnt vmcnt(6) lgkmcnt(0)
    s_barrier
    v_mfma_f32_32x32x16_bf16 v[128:143], v[96:99], v[72:75], v[128:143]
    ds_read_b128 v[64:67], v10 offset:24576
    ds_read_b128 v[68:71], v10 offset:26624
    v_mfma_f32_32x32x16_bf16 v[192:207], v[96:99], v[76:79], v[192:207]
    ds_read_b64_tr_b16 v[80:81], v12 offset:24576
    ds_read_b64_tr_b16 v[82:83], v12 offset:25600
    v_mfma_f32_32x32x16_bf16 v[144:159], v[100:103], v[72:75], v[144:159]
    ds_read_b64_tr_b16 v[84:85], v12 offset:32768
    ds_read_b64_tr_b16 v[86:87], v12 offset:33792
    v_mfma_f32_32x32x16_bf16 v[208:223], v[100:103], v[76:79], v[208:223]
    ds_read_b64_tr_b16 v[88:89], v13 offset:24576
    ds_read_b64_tr_b16 v[90:91], v13 offset:25600
    v_mfma_f32_32x32x16_bf16 v[160:175], v[104:107], v[72:75], v[160:175]
    ds_read_b64_tr_b16 v[92:93], v13 offset:32768
    ds_read_b64_tr_b16 v[94:95], v13 offset:33792
    v_mfma_f32_32x32x16_bf16 v[224:239], v[104:107], v[76:79], v[224:239]
    s_lshl_b32 s12, s66, 6
    s_add_u32 s12, s12, s8
    s_mul_i32 s13, s66, 114688
    s_add_u32 s13, s13, s9
    s_add_u32 s66, s66, 1
    s_and_b32 s66, s66, 15
    s_add_u32 m0, s10, 0
    s_add_u32 s14, s12, 0
    buffer_load_dwordx4 v8, s[40:43], s14 offen lds
    v_mfma_f32_32x32x16_bf16 v[176:191], v[108:111], v[72:75], v[176:191]
    s_add_u32 m0, s10, 1024
    s_add_u32 s14, s12, 16384
    buffer_load_dwordx4 v8, s[40:43], s14 offen lds
    v_mfma_f32_32x32x16_bf16 v[240:255], v[108:111], v[76:79], v[240:255]
    s_add_u32 m0, s10, 8192
    s_add_u32 s14, s13, 0
    buffer_load_dwordx4 v9, s[44:47], s14 offen lds
    s_cmp_lg_u32 s3, 0
    s_cbranch_scc1 GU_cf_25
    v_readfirstlane_b32 s74, v56
    s_cmp_lg_u32 s74, 0
    s_cbranch_scc1 TAGF_27
    s_mov_b32 s75, 0
TAGR_26:
    s_sleep 4
    global_load_dword v56, v57, s[36:37] sc0 sc1
    s_waitcnt vmcnt(0)
    v_readfirstlane_b32 s74, v56
    s_cmp_lg_u32 s74, 0
    s_cbranch_scc1 TAGF_27
    s_add_u32 s75, s75, 1
    s_cmp_lt_u32 s75, 200000
    s_cbranch_scc1 TAGR_26
TAGF_27:
    s_lshr_b32 s67, s4, 2
    s_mul_i32 s67, s67, 14
    s_add_u32 s67, s67, s5
    s_lshl_b32 s67, s67, 6
    s_and_b32 s68, s4, 3
    s_lshl_b32 s68, s68, 2
    s_add_u32 s67, s67, s68
    s_add_u32 s67, s67, 200704
    v_mov_b32 v58, 0
    v_mov_b32 v59, s74
    s_mov_b32 exec_lo, 0x1
    s_mov_b32 exec_hi, 0x0
    buffer_store_dword v59, v58, s[52:55], s67 offen sc0 sc1
    s_mov_b64 exec, -1
GU_cf_25:
    s_waitcnt lgkmcnt(0)
    v_mfma_f32_32x32x16_bf16 v[128:143], v[80:83], v[64:67], v[128:143]
    ds_read_b128 v[72:75], v11 offset:24576
    ds_read_b128 v[76:79], v11 offset:26624
    v_mfma_f32_32x32x16_bf16 v[192:207], v[80:83], v[68:71], v[192:207]
    ds_read_b64_tr_b16 v[96:97], v12 offset:28672
    ds_read_b64_tr_b16 v[98:99], v12 offset:29696
    v_mfma_f32_32x32x16_bf16 v[144:159], v[84:87], v[64:67], v[144:159]
    ds_read_b64_tr_b16 v[100:101], v12 offset:36864
    ds_read_b64_tr_b16 v[102:103], v12 offset:37888
    v_mfma_f32_32x32x16_bf16 v[208:223], v[84:87], v[68:71], v[208:223]
    ds_read_b64_tr_b16 v[104:105], v13 offset:28672
    ds_read_b64_tr_b16 v[106:107], v13 offset:29696
    v_mfma_f32_32x32x16_bf16 v[160:175], v[88:91], v[64:67], v[160:175]
    ds_read_b64_tr_b16 v[108:109], v13 offset:36864
    ds_read_b64_tr_b16 v[110:111], v13 offset:37888
    v_mfma_f32_32x32x16_bf16 v[224:239], v[88:91], v[68:71], v[224:239]
    s_add_u32 m0, s10, 9216
    s_add_u32 s14, s13, 14336
    buffer_load_dwordx4 v9, s[44:47], s14 offen lds
    v_mfma_f32_32x32x16_bf16 v[176:191], v[92:95], v[64:67], v[176:191]
    s_add_u32 m0, s10, 16384
    s_add_u32 s14, s13, 0
    buffer_load_dwordx4 v9, s[48:51], s14 offen lds
    v_mfma_f32_32x32x16_bf16 v[240:255], v[92:95], v[68:71], v[240:255]
    s_add_u32 m0, s10, 17408
    s_add_u32 s14, s13, 14336
    buffer_load_dwordx4 v9, s[48:51], s14 offen lds
    s_waitcnt vmcnt(6) lgkmcnt(0)
    s_barrier
    v_mfma_f32_32x32x16_bf16 v[128:143], v[96:99], v[72:75], v[128:143]
    ds_read_b128 v[64:67], v14 offset:0
    ds_read_b128 v[68:71], v14 offset:2048
    v_mfma_f32_32x32x16_bf16 v[192:207], v[96:99], v[76:79], v[192:207]
    ds_read_b64_tr_b16 v[80:81], v16 offset:0
    ds_read_b64_tr_b16 v[82:83], v16 offset:1024
    v_mfma_f32_32x32x16_bf16 v[144:159], v[100:103], v[72:75], v[144:159]
    ds_read_b64_tr_b16 v[84:85], v16 offset:8192
    ds_read_b64_tr_b16 v[86:87], v16 offset:9216
    v_mfma_f32_32x32x16_bf16 v[208:223], v[100:103], v[76:79], v[208:223]
    ds_read_b64_tr_b16 v[88:89], v17 offset:0
    ds_read_b64_tr_b16 v[90:91], v17 offset:1024
    v_mfma_f32_32x32x16_bf16 v[160:175], v[104:107], v[72:75], v[160:175]
    ds_read_b64_tr_b16 v[92:93], v17 offset:8192
    ds_read_b64_tr_b16 v[94:95], v17 offset:9216
    v_mfma_f32_32x32x16_bf16 v[224:239], v[104:107], v[76:79], v[224:239]
    s_lshl_b32 s12, s66, 6
    s_add_u32 s12, s12, s8
    s_mul_i32 s13, s66, 114688
    s_add_u32 s13, s13, s9
    s_add_u32 s66, s66, 1
    s_and_b32 s66, s66, 15
    s_add_u32 m0, s10, 24576
    s_add_u32 s14, s12, 0
    buffer_load_dwordx4 v8, s[40:43], s14 offen lds
    v_mfma_f32_32x32x16_bf16 v[176:191], v[108:111], v[72:75], v[176:191]
    s_add_u32 m0, s10, 25600
    s_add_u32 s14, s12, 16384
    buffer_load_dwordx4 v8, s[40:43], s14 offen lds
    v_mfma_f32_32x32x16_bf16 v[240:255], v[108:111], v[76:79], v[240:255]
    s_add_u32 m0, s10, 32768
    s_add_u32 s14, s13, 0
    buffer_load_dwordx4 v9, s[44:47], s14 offen lds
    s_waitcnt lgkmcnt(0)
    v_mfma_f32_32x32x16_bf16 v[128:143], v[80:83], v[64:67], v[128:143]
    ds_read_b128 v[72:75], v15 offset:0
    ds_read_b128 v[76:79], v15 offset:2048
    v_mfma_f32_32x32x16_bf16 v[192:207], v[80:83], v[68:71], v[192:207]
    ds_read_b64_tr_b16 v[96:97], v16 offset:4096
    ds_read_b64_tr_b16 v[98:99], v16 offset:5120
    v_mfma_f32_32x32x16_bf16 v[144:159], v[84:87], v[64:67], v[144:159]
    ds_read_b64_tr_b16 v[100:101], v16 offset:12288
    ds_read_b64_tr_b16 v[102:103], v16 offset:13312
    v_mfma_f32_32x32x16_bf16 v[208:223], v[84:87], v[68:71], v[208:223]
    ds_read_b64_tr_b16 v[104:105], v17 offset:4096
    ds_read_b64_tr_b16 v[106:107], v17 offset:5120
    v_mfma_f32_32x32x16_bf16 v[160:175], v[88:91], v[64:67], v[160:175]
    ds_read_b64_tr_b16 v[108:109], v17 offset:12288
    ds_read_b64_tr_b16 v[110:111], v17 offset:13312
    v_mfma_f32_32x32x16_bf16 v[224:239], v[88:91], v[68:71], v[224:239]
    s_add_u32 m0, s10, 33792
    s_add_u32 s14, s13, 14336
    buffer_load_dwordx4 v9, s[44:47], s14 offen lds
    v_mfma_f32_32x32x16_bf16 v[176:191], v[92:95], v[64:67], v[176:191]
    s_add_u32 m0, s10, 40960
    s_add_u32 s14, s13, 0
    buffer_load_dwordx4 v9, s[48:51], s14 offen lds
    v_mfma_f32_32x32x16_bf16 v[240:255], v[92:95], v[68:71], v[240:255]
    s_add_u32 m0, s10, 41984
    s_add_u32 s14, s13, 14336
    buffer_load_dwordx4 v9, s[48:51], s14 offen lds
    s_waitcnt vmcnt(6) lgkmcnt(0)
    s_barrier
    v_mfma_f32_32x32x16_bf16 v[128:143], v[96:99], v[72:75], v[128:143]
    ds_read_b128 v[64:67], v10 offset:0
    ds_read_b128 v[68:71], v10 offset:2048
    v_mfma_f32_32x32x16_bf16 v[192:207], v[96:99], v[76:79], v[192:207]
    ds_read_b64_tr_b16 v[80:81], v12 offset:0
    ds_read_b64_tr_b16 v[82:83], v12 offset:1024
    v_mfma_f32_32x32x16_bf16 v[144:159], v[100:103], v[72:75], v[144:159]
    ds_read_b64_tr_b16 v[84:85], v12 offset:8192
    ds_read_b64_tr_b16 v[86:87], v12 offset:9216
    v_mfma_f32_32x32x16_bf16 v[208:223], v[100:103], v[76:79], v[208:223]
    ds_read_b64_tr_b16 v[88:89], v13 offset:0
    ds_read_b64_tr_b16 v[90:91], v13 offset:1024
    v_mfma_f32_32x32x16_bf16 v[160:175], v[104:107], v[72:75], v[160:175]
    ds_read_b64_tr_b16 v[92:93], v13 offset:8192
    ds_read_b64_tr_b16 v[94:95], v13 offset:9216
    v_mfma_f32_32x32x16_bf16 v[224:239], v[104:107], v[76:79], v[224:239]
    s_lshl_b32 s12, s66, 6
    s_add_u32 s12, s12, s8
    s_mul_i32 s13, s66, 114688
    s_add_u32 s13, s13, s9
    s_add_u32 s66, s66, 1
    s_and_b32 s66, s66, 15
    s_add_u32 m0, s10, 49152
    s_add_u32 s14, s12, 0
    buffer_load_dwordx4 v8, s[40:43], s14 offen lds
    v_mfma_f32_32x32x16_bf16 v[176:191], v[108:111], v[72:75], v[176:191]
    s_add_u32 m0, s10, 50176
    s_add_u32 s14, s12, 16384
    buffer_load_dwordx4 v8, s[40:43], s14 offen lds
    v_mfma_f32_32x32x16_bf16 v[240:255], v[108:111], v[76:79], v[240:255]
    s_add_u32 m0, s10, 57344
    s_add_u32 s14, s13, 0
    buffer_load_dwordx4 v9, s[44:47], s14 offen lds
    s_waitcnt lgkmcnt(0)
    v_mfma_f32_32x32x16_bf16 v[128:143], v[80:83], v[64:67], v[128:143]
    ds_read_b128 v[72:75], v11 offset:0
    ds_read_b128 v[76:79], v11 offset:2048
    v_mfma_f32_32x32x16_bf16 v[192:207], v[80:83], v[68:71], v[192:207]
    ds_read_b64_tr_b16 v[96:97], v12 offset:4096
    ds_read_b64_tr_b16 v[98:99], v12 offset:5120
    v_mfma_f32_32x32x16_bf16 v[144:159], v[84:87], v[64:67], v[144:159]
    ds_read_b64_tr_b16 v[100:101], v12 offset:12288
    ds_read_b64_tr_b16 v[102:103], v12 offset:13312
    v_mfma_f32_32x32x16_bf16 v[208:223], v[84:87], v[68:71], v[208:223]
    ds_read_b64_tr_b16 v[104:105], v13 offset:4096
    ds_read_b64_tr_b16 v[106:107], v13 offset:5120
    v_mfma_f32_32x32x16_bf16 v[160:175], v[88:91], v[64:67], v[160:175]
    ds_read_b64_tr_b16 v[108:109], v13 offset:12288
    ds_read_b64_tr_b16 v[110:111], v13 offset:13312
    v_mfma_f32_32x32x16_bf16 v[224:239], v[88:91], v[68:71], v[224:239]
    s_add_u32 m0, s10, 58368
    s_add_u32 s14, s13, 14336
    buffer_load_dwordx4 v9, s[44:47], s14 offen lds
    v_mfma_f32_32x32x16_bf16 v[176:191], v[92:95], v[64:67], v[176:191]
    s_add_u32 m0, s10, 65536
    s_add_u32 s14, s13, 0
    buffer_load_dwordx4 v9, s[48:51], s14 offen lds
    v_mfma_f32_32x32x16_bf16 v[240:255], v[92:95], v[68:71], v[240:255]
    s_add_u32 m0, s10, 66560
    s_add_u32 s14, s13, 14336
    buffer_load_dwordx4 v9, s[48:51], s14 offen lds
    s_waitcnt vmcnt(6) lgkmcnt(0)
    s_barrier
    v_mfma_f32_32x32x16_bf16 v[128:143], v[96:99], v[72:75], v[128:143]
    ds_read_b128 v[64:67], v10 offset:24576
    ds_read_b128 v[68:71], v10 offset:26624
    v_mfma_f32_32x32x16_bf16 v[192:207], v[96:99], v[76:79], v[192:207]
    ds_read_b64_tr_b16 v[80:81], v12 offset:24576
    ds_read_b64_tr_b16 v[82:83], v12 offset:25600
    v_mfma_f32_32x32x16_bf16 v[144:159], v[100:103], v[72:75], v[144:159]
    ds_read_b64_tr_b16 v[84:85], v12 offset:32768
    ds_read_b64_tr_b16 v[86:87], v12 offset:33792
    v_mfma_f32_32x32x16_bf16 v[208:223], v[100:103], v[76:79], v[208:223]
    ds_read_b64_tr_b16 v[88:89], v13 offset:24576
    ds_read_b64_tr_b16 v[90:91], v13 offset:25600
    v_mfma_f32_32x32x16_bf16 v[160:175], v[104:107], v[72:75], v[160:175]
    ds_read_b64_tr_b16 v[92:93], v13 offset:32768
    ds_read_b64_tr_b16 v[94:95], v13 offset:33792
    v_mfma_f32_32x32x16_bf16 v[224:239], v[104:107], v[76:79], v[224:239]
    s_lshl_b32 s12, s66, 6
    s_add_u32 s12, s12, s8
    s_mul_i32 s13, s66, 114688
    s_add_u32 s13, s13, s9
    s_add_u32 s66, s66, 1
    s_and_b32 s66, s66, 15
    s_add_u32 m0, s10, 0
    s_add_u32 s14, s12, 0
    buffer_load_dwordx4 v8, s[40:43], s14 offen lds
    v_mfma_f32_32x32x16_bf16 v[176:191], v[108:111], v[72:75], v[176:191]
    s_add_u32 m0, s10, 1024
    s_add_u32 s14, s12, 16384
    buffer_load_dwordx4 v8, s[40:43], s14 offen lds
    v_mfma_f32_32x32x16_bf16 v[240:255], v[108:111], v[76:79], v[240:255]
    s_add_u32 m0, s10, 8192
    s_add_u32 s14, s13, 0
    buffer_load_dwordx4 v9, s[44:47], s14 offen lds
    s_waitcnt lgkmcnt(0)
    v_mfma_f32_32x32x16_bf16 v[128:143], v[80:83], v[64:67], v[128:143]
    ds_read_b128 v[72:75], v11 offset:24576
    ds_read_b128 v[76:79], v11 offset:26624
    v_mfma_f32_32x32x16_bf16 v[192:207], v[80:83], v[68:71], v[192:207]
    ds_read_b64_tr_b16 v[96:97], v12 offset:28672
    ds_read_b64_tr_b16 v[98:99], v12 offset:29696
    v_mfma_f32_32x32x16_bf16 v[144:159], v[84:87], v[64:67], v[144:159]
    ds_read_b64_tr_b16 v[100:101], v12 offset:36864
    ds_read_b64_tr_b16 v[102:103], v12 offset:37888
    v_mfma_f32_32x32x16_bf16 v[208:223], v[84:87], v[68:71], v[208:223]
    ds_read_b64_tr_b16 v[104:105], v13 offset:28672
    ds_read_b64_tr_b16 v[106:107], v13 offset:29696
    v_mfma_f32_32x32x16_bf16 v[160:175], v[88:91], v[64:67], v[160:175]
    ds_read_b64_tr_b16 v[108:109], v13 offset:36864
    ds_read_b64_tr_b16 v[110:111], v13 offset:37888
    v_mfma_f32_32x32x16_bf16 v[224:239], v[88:91], v[68:71], v[224:239]
    s_add_u32 m0, s10, 9216
    s_add_u32 s14, s13, 14336
    buffer_load_dwordx4 v9, s[44:47], s14 offen lds
    v_mfma_f32_32x32x16_bf16 v[176:191], v[92:95], v[64:67], v[176:191]
    s_add_u32 m0, s10, 16384
    s_add_u32 s14, s13, 0
    buffer_load_dwordx4 v9, s[48:51], s14 offen lds
    v_mfma_f32_32x32x16_bf16 v[240:255], v[92:95], v[68:71], v[240:255]
    s_add_u32 m0, s10, 17408
    s_add_u32 s14, s13, 14336
    buffer_load_dwordx4 v9, s[48:51], s14 offen lds
    s_waitcnt vmcnt(6) lgkmcnt(0)
    s_barrier
    v_mfma_f32_32x32x16_bf16 v[128:143], v[96:99], v[72:75], v[128:143]
    ds_read_b128 v[64:67], v14 offset:0
    ds_read_b128 v[68:71], v14 offset:2048
    v_mfma_f32_32x32x16_bf16 v[192:207], v[96:99], v[76:79], v[192:207]
    ds_read_b64_tr_b16 v[80:81], v16 offset:0
    ds_read_b64_tr_b16 v[82:83], v16 offset:1024
    v_mfma_f32_32x32x16_bf16 v[144:159], v[100:103], v[72:75], v[144:159]
    ds_read_b64_tr_b16 v[84:85], v16 offset:8192
    ds_read_b64_tr_b16 v[86:87], v16 offset:9216
    v_mfma_f32_32x32x16_bf16 v[208:223], v[100:103], v[76:79], v[208:223]
    ds_read_b64_tr_b16 v[88:89], v17 offset:0
    ds_read_b64_tr_b16 v[90:91], v17 offset:1024
    v_mfma_f32_32x32x16_bf16 v[160:175], v[104:107], v[72:75], v[160:175]
    ds_read_b64_tr_b16 v[92:93], v17 offset:8192
    ds_read_b64_tr_b16 v[94:95], v17 offset:9216
    v_mfma_f32_32x32x16_bf16 v[224:239], v[104:107], v[76:79], v[224:239]
    s_lshl_b32 s12, s66, 6
    s_add_u32 s12, s12, s8
    s_mul_i32 s13, s66, 114688
    s_add_u32 s13, s13, s9
    s_add_u32 s66, s66, 1
    s_and_b32 s66, s66, 15
    s_add_u32 m0, s10, 24576
    s_add_u32 s14, s12, 0
    buffer_load_dwordx4 v8, s[40:43], s14 offen lds
    v_mfma_f32_32x32x16_bf16 v[176:191], v[108:111], v[72:75], v[176:191]
    s_add_u32 m0, s10, 25600
    s_add_u32 s14, s12, 16384
    buffer_load_dwordx4 v8, s[40:43], s14 offen lds
    v_mfma_f32_32x32x16_bf16 v[240:255], v[108:111], v[76:79], v[240:255]
    s_add_u32 m0, s10, 32768
    s_add_u32 s14, s13, 0
    buffer_load_dwordx4 v9, s[44:47], s14 offen lds
    s_waitcnt lgkmcnt(0)
    v_mfma_f32_32x32x16_bf16 v[128:143], v[80:83], v[64:67], v[128:143]
    ds_read_b128 v[72:75], v15 offset:0
    ds_read_b128 v[76:79], v15 offset:2048
    v_mfma_f32_32x32x16_bf16 v[192:207], v[80:83], v[68:71], v[192:207]
    ds_read_b64_tr_b16 v[96:97], v16 offset:4096
    ds_read_b64_tr_b16 v[98:99], v16 offset:5120
    v_mfma_f32_32x32x16_bf16 v[144:159], v[84:87], v[64:67], v[144:159]
    ds_read_b64_tr_b16 v[100:101], v16 offset:12288
    ds_read_b64_tr_b16 v[102:103], v16 offset:13312
    v_mfma_f32_32x32x16_bf16 v[208:223], v[84:87], v[68:71], v[208:223]
    ds_read_b64_tr_b16 v[104:105], v17 offset:4096
    ds_read_b64_tr_b16 v[106:107], v17 offset:5120
    v_mfma_f32_32x32x16_bf16 v[160:175], v[88:91], v[64:67], v[160:175]
    ds_read_b64_tr_b16 v[108:109], v17 offset:12288
    ds_read_b64_tr_b16 v[110:111], v17 offset:13312
    v_mfma_f32_32x32x16_bf16 v[224:239], v[88:91], v[68:71], v[224:239]
    s_add_u32 m0, s10, 33792
    s_add_u32 s14, s13, 14336
    buffer_load_dwordx4 v9, s[44:47], s14 offen lds
    v_mfma_f32_32x32x16_bf16 v[176:191], v[92:95], v[64:67], v[176:191]
    s_add_u32 m0, s10, 40960
    s_add_u32 s14, s13, 0
    buffer_load_dwordx4 v9, s[48:51], s14 offen lds
    v_mfma_f32_32x32x16_bf16 v[240:255], v[92:95], v[68:71], v[240:255]
    s_add_u32 m0, s10, 41984
    s_add_u32 s14, s13, 14336
    buffer_load_dwordx4 v9, s[48:51], s14 offen lds
    s_waitcnt vmcnt(6) lgkmcnt(0)
    s_barrier
    v_mfma_f32_32x32x16_bf16 v[128:143], v[96:99], v[72:75], v[128:143]
    ds_read_b128 v[64:67], v10 offset:0
    ds_read_b128 v[68:71], v10 offset:2048
    v_mfma_f32_32x32x16_bf16 v[192:207], v[96:99], v[76:79], v[192:207]
    ds_read_b64_tr_b16 v[80:81], v12 offset:0
    ds_read_b64_tr_b16 v[82:83], v12 offset:1024
    v_mfma_f32_32x32x16_bf16 v[144:159], v[100:103], v[72:75], v[144:159]
    ds_read_b64_tr_b16 v[84:85], v12 offset:8192
    ds_read_b64_tr_b16 v[86:87], v12 offset:9216
    v_mfma_f32_32x32x16_bf16 v[208:223], v[100:103], v[76:79], v[208:223]
    ds_read_b64_tr_b16 v[88:89], v13 offset:0
    ds_read_b64_tr_b16 v[90:91], v13 offset:1024
    v_mfma_f32_32x32x16_bf16 v[160:175], v[104:107], v[72:75], v[160:175]
    ds_read_b64_tr_b16 v[92:93], v13 offset:8192
    ds_read_b64_tr_b16 v[94:95], v13 offset:9216
    v_mfma_f32_32x32x16_bf16 v[224:239], v[104:107], v[76:79], v[224:239]
    s_lshl_b32 s12, s66, 6
    s_add_u32 s12, s12, s8
    s_mul_i32 s13, s66, 114688
    s_add_u32 s13, s13, s9
    s_add_u32 s66, s66, 1
    s_and_b32 s66, s66, 15
    s_add_u32 m0, s10, 49152
    s_add_u32 s14, s12, 0
    buffer_load_dwordx4 v8, s[40:43], s14 offen lds
    v_mfma_f32_32x32x16_bf16 v[176:191], v[108:111], v[72:75], v[176:191]
    s_add_u32 m0, s10, 50176
    s_add_u32 s14, s12, 16384
    buffer_load_dwordx4 v8, s[40:43], s14 offen lds
    v_mfma_f32_32x32x16_bf16 v[240:255], v[108:111], v[76:79], v[240:255]
    s_add_u32 m0, s10, 57344
    s_add_u32 s14, s13, 0
    buffer_load_dwordx4 v9, s[44:47], s14 offen lds
    s_waitcnt lgkmcnt(0)
    v_mfma_f32_32x32x16_bf16 v[128:143], v[80:83], v[64:67], v[128:143]
    ds_read_b128 v[72:75], v11 offset:0
    ds_read_b128 v[76:79], v11 offset:2048
    v_mfma_f32_32x32x16_bf16 v[192:207], v[80:83], v[68:71], v[192:207]
    ds_read_b64_tr_b16 v[96:97], v12 offset:4096
    ds_read_b64_tr_b16 v[98:99], v12 offset:5120
    v_mfma_f32_32x32x16_bf16 v[144:159], v[84:87], v[64:67], v[144:159]
    ds_read_b64_tr_b16 v[100:101], v12 offset:12288
    ds_read_b64_tr_b16 v[102:103], v12 offset:13312
    v_mfma_f32_32x32x16_bf16 v[208:223], v[84:87], v[68:71], v[208:223]
    ds_read_b64_tr_b16 v[104:105], v13 offset:4096
    ds_read_b64_tr_b16 v[106:107], v13 offset:5120
    v_mfma_f32_32x32x16_bf16 v[160:175], v[88:91], v[64:67], v[160:175]
    ds_read_b64_tr_b16 v[108:109], v13 offset:12288
    ds_read_b64_tr_b16 v[110:111], v13 offset:13312
    v_mfma_f32_32x32x16_bf16 v[224:239], v[88:91], v[68:71], v[224:239]
    s_add_u32 m0, s10, 58368
    s_add_u32 s14, s13, 14336
    buffer_load_dwordx4 v9, s[44:47], s14 offen lds
    v_mfma_f32_32x32x16_bf16 v[176:191], v[92:95], v[64:67], v[176:191]
    s_add_u32 m0, s10, 65536
    s_add_u32 s14, s13, 0
    buffer_load_dwordx4 v9, s[48:51], s14 offen lds
    v_mfma_f32_32x32x16_bf16 v[240:255], v[92:95], v[68:71], v[240:255]
    s_add_u32 m0, s10, 66560
    s_add_u32 s14, s13, 14336
    buffer_load_dwordx4 v9, s[48:51], s14 offen lds
    s_waitcnt vmcnt(6) lgkmcnt(0)
    s_barrier
    v_mfma_f32_32x32x16_bf16 v[128:143], v[96:99], v[72:75], v[128:143]
    ds_read_b128 v[64:67], v10 offset:24576
    ds_read_b128 v[68:71], v10 offset:26624
    v_mfma_f32_32x32x16_bf16 v[192:207], v[96:99], v[76:79], v[192:207]
    ds_read_b64_tr_b16 v[80:81], v12 offset:24576
    ds_read_b64_tr_b16 v[82:83], v12 offset:25600
    v_mfma_f32_32x32x16_bf16 v[144:159], v[100:103], v[72:75], v[144:159]
    ds_read_b64_tr_b16 v[84:85], v12 offset:32768
    ds_read_b64_tr_b16 v[86:87], v12 offset:33792
    v_mfma_f32_32x32x16_bf16 v[208:223], v[100:103], v[76:79], v[208:223]
    ds_read_b64_tr_b16 v[88:89], v13 offset:24576
    ds_read_b64_tr_b16 v[90:91], v13 offset:25600
    v_mfma_f32_32x32x16_bf16 v[160:175], v[104:107], v[72:75], v[160:175]
    ds_read_b64_tr_b16 v[92:93], v13 offset:32768
    ds_read_b64_tr_b16 v[94:95], v13 offset:33792
    v_mfma_f32_32x32x16_bf16 v[224:239], v[104:107], v[76:79], v[224:239]
    s_lshl_b32 s12, s66, 6
    s_add_u32 s12, s12, s8
    s_mul_i32 s13, s66, 114688
    s_add_u32 s13, s13, s9
    s_add_u32 s66, s66, 1
    s_and_b32 s66, s66, 15
    s_add_u32 m0, s10, 0
    s_add_u32 s14, s12, 0
    buffer_load_dwordx4 v8, s[40:43], s14 offen lds
    v_mfma_f32_32x32x16_bf16 v[176:191], v[108:111], v[72:75], v[176:191]
    s_add_u32 m0, s10, 1024
    s_add_u32 s14, s12, 16384
    buffer_load_dwordx4 v8, s[40:43], s14 offen lds
    v_mfma_f32_32x32x16_bf16 v[240:255], v[108:111], v[76:79], v[240:255]
    s_add_u32 m0, s10, 8192
    s_add_u32 s14, s13, 0
    buffer_load_dwordx4 v9, s[44:47], s14 offen lds
    s_waitcnt lgkmcnt(0)
    v_mfma_f32_32x32x16_bf16 v[128:143], v[80:83], v[64:67], v[128:143]
    ds_read_b128 v[72:75], v11 offset:24576
    ds_read_b128 v[76:79], v11 offset:26624
    v_mfma_f32_32x32x16_bf16 v[192:207], v[80:83], v[68:71], v[192:207]
    ds_read_b64_tr_b16 v[96:97], v12 offset:28672
    ds_read_b64_tr_b16 v[98:99], v12 offset:29696
    v_mfma_f32_32x32x16_bf16 v[144:159], v[84:87], v[64:67], v[144:159]
    ds_read_b64_tr_b16 v[100:101], v12 offset:36864
    ds_read_b64_tr_b16 v[102:103], v12 offset:37888
    v_mfma_f32_32x32x16_bf16 v[208:223], v[84:87], v[68:71], v[208:223]
    ds_read_b64_tr_b16 v[104:105], v13 offset:28672
    ds_read_b64_tr_b16 v[106:107], v13 offset:29696
    v_mfma_f32_32x32x16_bf16 v[160:175], v[88:91], v[64:67], v[160:175]
    ds_read_b64_tr_b16 v[108:109], v13 offset:36864
    ds_read_b64_tr_b16 v[110:111], v13 offset:37888
    v_mfma_f32_32x32x16_bf16 v[224:239], v[88:91], v[68:71], v[224:239]
    s_add_u32 m0, s10, 9216
    s_add_u32 s14, s13, 14336
    buffer_load_dwordx4 v9, s[44:47], s14 offen lds
    v_mfma_f32_32x32x16_bf16 v[176:191], v[92:95], v[64:67], v[176:191]
    s_add_u32 m0, s10, 16384
    s_add_u32 s14, s13, 0
    buffer_load_dwordx4 v9, s[48:51], s14 offen lds
    v_mfma_f32_32x32x16_bf16 v[240:255], v[92:95], v[68:71], v[240:255]
    s_add_u32 m0, s10, 17408
    s_add_u32 s14, s13, 14336
    buffer_load_dwordx4 v9, s[48:51], s14 offen lds
    s_waitcnt vmcnt(6) lgkmcnt(0)
    s_barrier
    v_mfma_f32_32x32x16_bf16 v[128:143], v[96:99], v[72:75], v[128:143]
    ds_read_b128 v[64:67], v14 offset:0
    ds_read_b128 v[68:71], v14 offset:2048
    v_mfma_f32_32x32x16_bf16 v[192:207], v[96:99], v[76:79], v[192:207]
    ds_read_b64_tr_b16 v[80:81], v16 offset:0
    ds_read_b64_tr_b16 v[82:83], v16 offset:1024
    v_mfma_f32_32x32x16_bf16 v[144:159], v[100:103], v[72:75], v[144:159]
    ds_read_b64_tr_b16 v[84:85], v16 offset:8192
    ds_read_b64_tr_b16 v[86:87], v16 offset:9216
    v_mfma_f32_32x32x16_bf16 v[208:223], v[100:103], v[76:79], v[208:223]
    ds_read_b64_tr_b16 v[88:89], v17 offset:0
    ds_read_b64_tr_b16 v[90:91], v17 offset:1024
    v_mfma_f32_32x32x16_bf16 v[160:175], v[104:107], v[72:75], v[160:175]
    ds_read_b64_tr_b16 v[92:93], v17 offset:8192
    ds_read_b64_tr_b16 v[94:95], v17 offset:9216
    v_mfma_f32_32x32x16_bf16 v[224:239], v[104:107], v[76:79], v[224:239]
    v_mfma_f32_32x32x16_bf16 v[176:191], v[108:111], v[72:75], v[176:191]
    v_mfma_f32_32x32x16_bf16 v[240:255], v[108:111], v[76:79], v[240:255]
    s_waitcnt lgkmcnt(0)
    v_mfma_f32_32x32x16_bf16 v[128:143], v[80:83], v[64:67], v[128:143]
    ds_read_b128 v[72:75], v15 offset:0
    ds_read_b128 v[76:79], v15 offset:2048
    v_mfma_f32_32x32x16_bf16 v[192:207], v[80:83], v[68:71], v[192:207]
    ds_read_b64_tr_b16 v[96:97], v16 offset:4096
    ds_read_b64_tr_b16 v[98:99], v16 offset:5120
    v_mfma_f32_32x32x16_bf16 v[144:159], v[84:87], v[64:67], v[144:159]
    ds_read_b64_tr_b16 v[100:101], v16 offset:12288
    ds_read_b64_tr_b16 v[102:103], v16 offset:13312
    v_mfma_f32_32x32x16_bf16 v[208:223], v[84:87], v[68:71], v[208:223]
    ds_read_b64_tr_b16 v[104:105], v17 offset:4096
    ds_read_b64_tr_b16 v[106:107], v17 offset:5120
    v_mfma_f32_32x32x16_bf16 v[160:175], v[88:91], v[64:67], v[160:175]
    ds_read_b64_tr_b16 v[108:109], v17 offset:12288
    ds_read_b64_tr_b16 v[110:111], v17 offset:13312
    v_mfma_f32_32x32x16_bf16 v[224:239], v[88:91], v[68:71], v[224:239]
    v_mfma_f32_32x32x16_bf16 v[176:191], v[92:95], v[64:67], v[176:191]
    v_mfma_f32_32x32x16_bf16 v[240:255], v[92:95], v[68:71], v[240:255]
    s_waitcnt vmcnt(0) lgkmcnt(0)
    s_barrier
    v_mfma_f32_32x32x16_bf16 v[128:143], v[96:99], v[72:75], v[128:143]
    ds_read_b128 v[64:67], v10 offset:0
    ds_read_b128 v[68:71], v10 offset:2048
    v_mfma_f32_32x32x16_bf16 v[192:207], v[96:99], v[76:79], v[192:207]
    ds_read_b64_tr_b16 v[80:81], v12 offset:0
    ds_read_b64_tr_b16 v[82:83], v12 offset:1024
    v_mfma_f32_32x32x16_bf16 v[144:159], v[100:103], v[72:75], v[144:159]
    ds_read_b64_tr_b16 v[84:85], v12 offset:8192
    ds_read_b64_tr_b16 v[86:87], v12 offset:9216
    v_mfma_f32_32x32x16_bf16 v[208:223], v[100:103], v[76:79], v[208:223]
    ds_read_b64_tr_b16 v[88:89], v13 offset:0
    ds_read_b64_tr_b16 v[90:91], v13 offset:1024
    v_mfma_f32_32x32x16_bf16 v[160:175], v[104:107], v[72:75], v[160:175]
    ds_read_b64_tr_b16 v[92:93], v13 offset:8192
    ds_read_b64_tr_b16 v[94:95], v13 offset:9216
    v_mfma_f32_32x32x16_bf16 v[224:239], v[104:107], v[76:79], v[224:239]
    v_mfma_f32_32x32x16_bf16 v[176:191], v[108:111], v[72:75], v[176:191]
    v_mfma_f32_32x32x16_bf16 v[240:255], v[108:111], v[76:79], v[240:255]
    s_waitcnt lgkmcnt(0)
    v_mfma_f32_32x32x16_bf16 v[128:143], v[80:83], v[64:67], v[128:143]
    ds_read_b128 v[72:75], v11 offset:0
    ds_read_b128 v[76:79], v11 offset:2048
    v_mfma_f32_32x32x16_bf16 v[192:207], v[80:83], v[68:71], v[192:207]
    ds_read_b64_tr_b16 v[96:97], v12 offset:4096
    ds_read_b64_tr_b16 v[98:99], v12 offset:5120
    v_mfma_f32_32x32x16_bf16 v[144:159], v[84:87], v[64:67], v[144:159]
    ds_read_b64_tr_b16 v[100:101], v12 offset:12288
    ds_read_b64_tr_b16 v[102:103], v12 offset:13312
    v_mfma_f32_32x32x16_bf16 v[208:223], v[84:87], v[68:71], v[208:223]
    ds_read_b64_tr_b16 v[104:105], v13 offset:4096
    ds_read_b64_tr_b16 v[106:107], v13 offset:5120
    v_mfma_f32_32x32x16_bf16 v[160:175], v[88:91], v[64:67], v[160:175]
    ds_read_b64_tr_b16 v[108:109], v13 offset:12288
    ds_read_b64_tr_b16 v[110:111], v13 offset:13312
    v_mfma_f32_32x32x16_bf16 v[224:239], v[88:91], v[68:71], v[224:239]
    v_mfma_f32_32x32x16_bf16 v[176:191], v[92:95], v[64:67], v[176:191]
    v_mfma_f32_32x32x16_bf16 v[240:255], v[92:95], v[68:71], v[240:255]
    s_waitcnt lgkmcnt(0)
    v_mfma_f32_32x32x16_bf16 v[128:143], v[96:99], v[72:75], v[128:143]
    v_mfma_f32_32x32x16_bf16 v[192:207], v[96:99], v[76:79], v[192:207]
    v_mfma_f32_32x32x16_bf16 v[144:159], v[100:103], v[72:75], v[144:159]
    v_mfma_f32_32x32x16_bf16 v[208:223], v[100:103], v[76:79], v[208:223]
    v_mfma_f32_32x32x16_bf16 v[160:175], v[104:107], v[72:75], v[160:175]
    v_mfma_f32_32x32x16_bf16 v[224:239], v[104:107], v[76:79], v[224:239]
    v_mfma_f32_32x32x16_bf16 v[176:191], v[108:111], v[72:75], v[176:191]
    v_mfma_f32_32x32x16_bf16 v[240:255], v[108:111], v[76:79], v[240:255]
    s_setprio 3
    s_cmp_lg_u32 s3, 0
    s_cbranch_scc1 WGW_28
    s_lshr_b32 s13, s4, 2
    s_mul_i32 s13, s13, 14
    s_add_u32 s13, s13, s5
    s_lshl_b32 s13, s13, 6
    s_add_u32 s13, s13, 200704
    s_and_b32 s12, s2, 15
    s_lshl_b32 s12, s12, 8
    s_add_u32 s12, s12, 196608
    v_lshlrev_b32 v2, 2, v1
    s_mov_b32 s75, 0
    s_mov_b32 exec_lo, 0xffffffff
    s_mov_b32 exec_hi, 0x0
POLL_29:
    buffer_load_dword v3, v2, s[52:55], s12 offen sc0 sc1
    s_waitcnt vmcnt(0)
    v_cmp_ne_u32 vcc, s74, v3
    s_cbranch_vccz POLLD_30
    s_sleep 2
    s_add_u32 s75, s75, 1
    s_cmp_lt_u32 s75, 200000
    s_cbranch_scc1 POLL_29
POLLD_30:
    s_mov_b64 exec, -1
    v_lshlrev_b32 v2, 2, v1
    s_mov_b32 s75, 0
    s_mov_b32 exec_lo, 0xf
    s_mov_b32 exec_hi, 0x0
POLL_31:
    buffer_load_dword v3, v2, s[52:55], s13 offen sc0 sc1
    s_waitcnt vmcnt(0)
    v_cmp_ne_u32 vcc, s74, v3
    s_cbranch_vccz POLLD_32
    s_sleep 2
    s_add_u32 s75, s75, 1
    s_cmp_lt_u32 s75, 200000
    s_cbranch_scc1 POLL_31
POLLD_32:
    s_mov_b64 exec, -1
WGW_28:
    s_barrier
    s_lshl_b32 s8, s4, 7
    s_lshl_b32 s9, s6, 6
    s_add_u32 s8, s8, s9
    v_add_u32 v2, s8, v6
    v_lshlrev_b32 v2, 2, v2
    s_mov_b32 s9, 131072
    s_mov_b32 s10, 139264
    buffer_load_dword v8, v2, s[52:55], s9 offen offset:0 sc1
    buffer_load_dword v10, v2, s[52:55], s10 offen offset:0 sc1
    buffer_load_dword v9, v2, s[52:55], s9 offen offset:128 sc1
    buffer_load_dword v11, v2, s[52:55], s10 offen offset:128 sc1
    s_and_b32 s8, s4, 12
    s_mul_i32 s8, s8, 14336
    s_lshl_b32 s9, s5, 9
    s_add_u32 s8, s8, s9
    s_lshl_b32 s9, s7, 8
    s_add_u32 s8, s8, s9
    s_add_u32 s8, s8, 262144
    v_mul_u32_u24 v2, 7168, v7
    v_lshl_add_u32 v2, v6, 3, v2
    s_add_u32 s9, s8, 0
    buffer_load_dwordx2 v[16:17], v2, s[52:55], s9 offen sc1
    s_add_u32 s9, s8, 14336
    buffer_load_dwordx2 v[18:19], v2, s[52:55], s9 offen sc1
    s_add_u32 s9, s8, 28672
    buffer_load_dwordx2 v[20:21], v2, s[52:55], s9 offen sc1
    s_add_u32 s9, s8, 43008
    buffer_load_dwordx2 v[22:23], v2, s[52:55], s9 offen sc1
    s_lshl_b32 s9, s3, 9
    v_lshl_add_u32 v3, v1, 3, s9
    v_lshl_add_u32 v4, v7, 4, s9
    s_waitcnt vmcnt(0)
    v_add_f32 v16, v16, v18
    v_add_f32 v17, v17, v19
    v_add_f32 v20, v20, v22
    v_add_f32 v21, v21, v23
    v_add_f32 v16, v16, v20
    v_add_f32 v17, v17, v21
    ds_write_b64 v3, v[16:17]
    s_waitcnt lgkmcnt(0)
    ds_read_b128 v[64:67], v4 offset:0
    ds_read_b128 v[68:71], v4 offset:32
    ds_read_b128 v[72:75], v4 offset:64
    ds_read_b128 v[76:79], v4 offset:96
    ds_read_b128 v[80:83], v4 offset:256
    ds_read_b128 v[84:87], v4 offset:288
    ds_read_b128 v[88:91], v4 offset:320
    ds_read_b128 v[92:95], v4 offset:352
    ds_read_b128 v[96:99], v4 offset:128
    ds_read_b128 v[100:103], v4 offset:160
    ds_read_b128 v[104:107], v4 offset:192
    ds_read_b128 v[108:111], v4 offset:224
    ds_read_b128 v[112:115], v4 offset:384
    ds_read_b128 v[116:119], v4 offset:416
    ds_read_b128 v[120:123], v4 offset:448
    ds_read_b128 v[124:127], v4 offset:480
    v_lshlrev_b32 v3, 4, v1
    s_lshl_b32 s8, s4, 2
    s_lshl_b32 s9, s6, 1
    s_add_u32 s8, s8, s9
    s_mul_i32 s8, s8, 112
    s_lshl_b32 s9, s5, 3
    s_add_u32 s8, s8, s9
    s_lshl_b32 s9, s7, 2
    s_add_u32 s8, s8, s9
    s_lshl_b32 s8, s8, 10
    v_mov_b32 v12, -2.302208198144325
    v_mov_b32 v13, -0.1029432395800235
    s_waitcnt vmcnt(0) lgkmcnt(0)
    v_mov_b32 v40, v8
    v_mov_b32 v41, v8
    v_mov_b32 v42, v10
    v_mov_b32 v43, v10
    v_mov_b32 v44, v9
    v_mov_b32 v45, v9
    v_mov_b32 v46, v11
    v_mov_b32 v47, v11
    v_mov_b32 v48, v12
    v_mov_b32 v49, v12
    v_mov_b32 v50, v13
    v_mov_b32 v51, v13
    v_mov_b32 v52, 1.0
    v_mov_b32 v53, 1.0
    v_pk_mul_f32 v[16:17], v[42:43], v[64:65]
    v_pk_mul_f32 v[18:19], v[42:43], v[66:67]
    v_pk_mul_f32 v[20:21], v[42:43], v[68:69]
    v_pk_mul_f32 v[22:23], v[42:43], v[70:71]
    v_pk_mul_f32 v[24:25], v[42:43], v[72:73]
    v_pk_mul_f32 v[26:27], v[42:43], v[74:75]
    v_pk_mul_f32 v[28:29], v[42:43], v[76:77]
    v_pk_mul_f32 v[30:31], v[42:43], v[78:79]
    v_pk_fma_f32 v[128:129], v[128:129], v[40:41], v[16:17]
    v_pk_fma_f32 v[130:131], v[130:131], v[40:41], v[18:19]
    v_pk_fma_f32 v[132:133], v[132:133], v[40:41], v[20:21]
    v_pk_fma_f32 v[134:135], v[134:135], v[40:41], v[22:23]
    v_pk_fma_f32 v[136:137], v[136:137], v[40:41], v[24:25]
    v_pk_fma_f32 v[138:139], v[138:139], v[40:41], v[26:27]
    v_pk_fma_f32 v[140:141], v[140:141], v[40:41], v[28:29]
    v_pk_fma_f32 v[142:143], v[142:143], v[40:41], v[30:31]
    v_pk_mul_f32 v[16:17], v[42:43], v[80:81]
    v_pk_mul_f32 v[18:19], v[42:43], v[82:83]
    v_pk_mul_f32 v[20:21], v[42:43], v[84:85]
    v_pk_mul_f32 v[22:23], v[42:43], v[86:87]
    v_pk_mul_f32 v[24:25], v[42:43], v[88:89]
    v_pk_mul_f32 v[26:27], v[42:43], v[90:91]
    v_pk_mul_f32 v[28:29], v[42:43], v[92:93]
    v_pk_mul_f32 v[30:31], v[42:43], v[94:95]
    v_pk_fma_f32 v[144:145], v[144:145], v[40:41], v[16:17]
    v_pk_fma_f32 v[146:147], v[146:147], v[40:41], v[18:19]
    v_pk_fma_f32 v[148:149], v[148:149], v[40:41], v[20:21]
    v_pk_fma_f32 v[150:151], v[150:151], v[40:41], v[22:23]
    v_pk_fma_f32 v[152:153], v[152:153], v[40:41], v[24:25]
    v_pk_fma_f32 v[154:155], v[154:155], v[40:41], v[26:27]
    v_pk_fma_f32 v[156:157], v[156:157], v[40:41], v[28:29]
    v_pk_fma_f32 v[158:159], v[158:159], v[40:41], v[30:31]
    v_pk_mul_f32 v[16:17], v[128:129], v[128:129]
    v_pk_mul_f32 v[18:19], v[130:131], v[130:131]
    v_pk_mul_f32 v[20:21], v[132:133], v[132:133]
    v_pk_mul_f32 v[22:23], v[134:135], v[134:135]
    v_pk_mul_f32 v[24:25], v[136:137], v[136:137]
    v_pk_mul_f32 v[26:27], v[138:139], v[138:139]
    v_pk_mul_f32 v[28:29], v[140:141], v[140:141]
    v_pk_mul_f32 v[30:31], v[142:143], v[142:143]
    v_pk_fma_f32 v[16:17], v[16:17], v[50:51], v[48:49]
    v_pk_fma_f32 v[18:19], v[18:19], v[50:51], v[48:49]
    v_pk_fma_f32 v[20:21], v[20:21], v[50:51], v[48:49]
    v_pk_fma_f32 v[22:23], v[22:23], v[50:51], v[48:49]
    v_pk_fma_f32 v[24:25], v[24:25], v[50:51], v[48:49]
    v_pk_fma_f32 v[26:27], v[26:27], v[50:51], v[48:49]
    v_pk_fma_f32 v[28:29], v[28:29], v[50:51], v[48:49]
    v_pk_fma_f32 v[30:31], v[30:31], v[50:51], v[48:49]
    v_pk_mul_f32 v[16:17], v[16:17], v[128:129]
    v_pk_mul_f32 v[18:19], v[18:19], v[130:131]
    v_pk_mul_f32 v[20:21], v[20:21], v[132:133]
    v_pk_mul_f32 v[22:23], v[22:23], v[134:135]
    v_pk_mul_f32 v[24:25], v[24:25], v[136:137]
    v_pk_mul_f32 v[26:27], v[26:27], v[138:139]
    v_pk_mul_f32 v[28:29], v[28:29], v[140:141]
    v_pk_mul_f32 v[30:31], v[30:31], v[142:143]
    v_exp_f32 v16, v16
    v_exp_f32 v17, v17
    v_exp_f32 v18, v18
    v_exp_f32 v19, v19
    v_exp_f32 v20, v20
    v_exp_f32 v21, v21
    v_exp_f32 v22, v22
    v_exp_f32 v23, v23
    v_exp_f32 v24, v24
    v_exp_f32 v25, v25
    v_exp_f32 v26, v26
    v_exp_f32 v27, v27
    v_exp_f32 v28, v28
    v_exp_f32 v29, v29
    v_exp_f32 v30, v30
    v_exp_f32 v31, v31
    v_pk_mul_f32 v[144:145], v[144:145], v[128:129]
    v_pk_mul_f32 v[146:147], v[146:147], v[130:131]
    v_pk_mul_f32 v[148:149], v[148:149], v[132:133]
    v_pk_mul_f32 v[150:151], v[150:151], v[134:135]
    v_pk_mul_f32 v[152:153], v[152:153], v[136:137]
    v_pk_mul_f32 v[154:155], v[154:155], v[138:139]
    v_pk_mul_f32 v[156:157], v[156:157], v[140:141]
    v_pk_mul_f32 v[158:159], v[158:159], v[142:143]
    v_pk_add_f32 v[16:17], v[16:17], v[52:53]
    v_pk_add_f32 v[18:19], v[18:19], v[52:53]
    v_pk_add_f32 v[20:21], v[20:21], v[52:53]
    v_pk_add_f32 v[22:23], v[22:23], v[52:53]
    v_pk_add_f32 v[24:25], v[24:25], v[52:53]
    v_pk_add_f32 v[26:27], v[26:27], v[52:53]
    v_pk_add_f32 v[28:29], v[28:29], v[52:53]
    v_pk_add_f32 v[30:31], v[30:31], v[52:53]
    v_rcp_f32 v16, v16
    v_rcp_f32 v17, v17
    v_rcp_f32 v18, v18
    v_rcp_f32 v19, v19
    v_rcp_f32 v20, v20
    v_rcp_f32 v21, v21
    v_rcp_f32 v22, v22
    v_rcp_f32 v23, v23
    v_rcp_f32 v24, v24
    v_rcp_f32 v25, v25
    v_rcp_f32 v26, v26
    v_rcp_f32 v27, v27
    v_rcp_f32 v28, v28
    v_rcp_f32 v29, v29
    v_rcp_f32 v30, v30
    v_rcp_f32 v31, v31
    s_nop 0
    v_pk_mul_f32 v[144:145], v[144:145], v[16:17]
    v_pk_mul_f32 v[146:147], v[146:147], v[18:19]
    v_pk_mul_f32 v[148:149], v[148:149], v[20:21]
    v_pk_mul_f32 v[150:151], v[150:151], v[22:23]
    v_pk_mul_f32 v[152:153], v[152:153], v[24:25]
    v_pk_mul_f32 v[154:155], v[154:155], v[26:27]
    v_pk_mul_f32 v[156:157], v[156:157], v[28:29]
    v_pk_mul_f32 v[158:159], v[158:159], v[30:31]
    v_cvt_pk_bf16_f32 v128, v144, v145
    v_cvt_pk_bf16_f32 v129, v146, v147
    v_cvt_pk_bf16_f32 v130, v148, v149
    v_cvt_pk_bf16_f32 v131, v150, v151
    v_cvt_pk_bf16_f32 v132, v152, v153
    v_cvt_pk_bf16_f32 v133, v154, v155
    v_cvt_pk_bf16_f32 v134, v156, v157
    v_cvt_pk_bf16_f32 v135, v158, v159
    s_add_u32 s9, s8, 0
    buffer_store_dwordx4 v[128:131], v3, s[56:59], s9 offen sc1
    buffer_store_dwordx4 v[132:135], v3, s[56:59], s9 offen offset:1024 sc1
    v_pk_mul_f32 v[16:17], v[42:43], v[96:97]
    v_pk_mul_f32 v[18:19], v[42:43], v[98:99]
    v_pk_mul_f32 v[20:21], v[42:43], v[100:101]
    v_pk_mul_f32 v[22:23], v[42:43], v[102:103]
    v_pk_mul_f32 v[24:25], v[42:43], v[104:105]
    v_pk_mul_f32 v[26:27], v[42:43], v[106:107]
    v_pk_mul_f32 v[28:29], v[42:43], v[108:109]
    v_pk_mul_f32 v[30:31], v[42:43], v[110:111]
    v_pk_fma_f32 v[160:161], v[160:161], v[40:41], v[16:17]
    v_pk_fma_f32 v[162:163], v[162:163], v[40:41], v[18:19]
    v_pk_fma_f32 v[164:165], v[164:165], v[40:41], v[20:21]
    v_pk_fma_f32 v[166:167], v[166:167], v[40:41], v[22:23]
    v_pk_fma_f32 v[168:169], v[168:169], v[40:41], v[24:25]
    v_pk_fma_f32 v[170:171], v[170:171], v[40:41], v[26:27]
    v_pk_fma_f32 v[172:173], v[172:173], v[40:41], v[28:29]
    v_pk_fma_f32 v[174:175], v[174:175], v[40:41], v[30:31]
    v_pk_mul_f32 v[16:17], v[42:43], v[112:113]
    v_pk_mul_f32 v[18:19], v[42:43], v[114:115]
    v_pk_mul_f32 v[20:21], v[42:43], v[116:117]
    v_pk_mul_f32 v[22:23], v[42:43], v[118:119]
    v_pk_mul_f32 v[24:25], v[42:43], v[120:121]
    v_pk_mul_f32 v[26:27], v[42:43], v[122:123]
    v_pk_mul_f32 v[28:29], v[42:43], v[124:125]
    v_pk_mul_f32 v[30:31], v[42:43], v[126:127]
    v_pk_fma_f32 v[176:177], v[176:177], v[40:41], v[16:17]
    v_pk_fma_f32 v[178:179], v[178:179], v[40:41], v[18:19]
    v_pk_fma_f32 v[180:181], v[180:181], v[40:41], v[20:21]
    v_pk_fma_f32 v[182:183], v[182:183], v[40:41], v[22:23]
    v_pk_fma_f32 v[184:185], v[184:185], v[40:41], v[24:25]
    v_pk_fma_f32 v[186:187], v[186:187], v[40:41], v[26:27]
    v_pk_fma_f32 v[188:189], v[188:189], v[40:41], v[28:29]
    v_pk_fma_f32 v[190:191], v[190:191], v[40:41], v[30:31]
    v_pk_mul_f32 v[16:17], v[160:161], v[160:161]
    v_pk_mul_f32 v[18:19], v[162:163], v[162:163]
    v_pk_mul_f32 v[20:21], v[164:165], v[164:165]
    v_pk_mul_f32 v[22:23], v[166:167], v[166:167]
    v_pk_mul_f32 v[24:25], v[168:169], v[168:169]
    v_pk_mul_f32 v[26:27], v[170:171], v[170:171]
    v_pk_mul_f32 v[28:29], v[172:173], v[172:173]
    v_pk_mul_f32 v[30:31], v[174:175], v[174:175]
    v_pk_fma_f32 v[16:17], v[16:17], v[50:51], v[48:49]
    v_pk_fma_f32 v[18:19], v[18:19], v[50:51], v[48:49]
    v_pk_fma_f32 v[20:21], v[20:21], v[50:51], v[48:49]
    v_pk_fma_f32 v[22:23], v[22:23], v[50:51], v[48:49]
    v_pk_fma_f32 v[24:25], v[24:25], v[50:51], v[48:49]
    v_pk_fma_f32 v[26:27], v[26:27], v[50:51], v[48:49]
    v_pk_fma_f32 v[28:29], v[28:29], v[50:51], v[48:49]
    v_pk_fma_f32 v[30:31], v[30:31], v[50:51], v[48:49]
    v_pk_mul_f32 v[16:17], v[16:17], v[160:161]
    v_pk_mul_f32 v[18:19], v[18:19], v[162:163]
    v_pk_mul_f32 v[20:21], v[20:21], v[164:165]
    v_pk_mul_f32 v[22:23], v[22:23], v[166:167]
    v_pk_mul_f32 v[24:25], v[24:25], v[168:169]
    v_pk_mul_f32 v[26:27], v[26:27], v[170:171]
    v_pk_mul_f32 v[28:29], v[28:29], v[172:173]
    v_pk_mul_f32 v[30:31], v[30:31], v[174:175]
    v_exp_f32 v16, v16
    v_exp_f32 v17, v17
    v_exp_f32 v18, v18
    v_exp_f32 v19, v19
    v_exp_f32 v20, v20
    v_exp_f32 v21, v21
    v_exp_f32 v22, v22
    v_exp_f32 v23, v23
    v_exp_f32 v24, v24
    v_exp_f32 v25, v25
    v_exp_f32 v26, v26
    v_exp_f32 v27, v27
    v_exp_f32 v28, v28
    v_exp_f32 v29, v29
    v_exp_f32 v30, v30
    v_exp_f32 v31, v31
    v_pk_mul_f32 v[176:177], v[176:177], v[160:161]
    v_pk_mul_f32 v[178:179], v[178:179], v[162:163]
    v_pk_mul_f32 v[180:181], v[180:181], v[164:165]
    v_pk_mul_f32 v[182:183], v[182:183], v[166:167]
    v_pk_mul_f32 v[184:185], v[184:185], v[168:169]
    v_pk_mul_f32 v[186:187], v[186:187], v[170:171]
    v_pk_mul_f32 v[188:189], v[188:189], v[172:173]
    v_pk_mul_f32 v[190:191], v[190:191], v[174:175]
    v_pk_add_f32 v[16:17], v[16:17], v[52:53]
    v_pk_add_f32 v[18:19], v[18:19], v[52:53]
    v_pk_add_f32 v[20:21], v[20:21], v[52:53]
    v_pk_add_f32 v[22:23], v[22:23], v[52:53]
    v_pk_add_f32 v[24:25], v[24:25], v[52:53]
    v_pk_add_f32 v[26:27], v[26:27], v[52:53]
    v_pk_add_f32 v[28:29], v[28:29], v[52:53]
    v_pk_add_f32 v[30:31], v[30:31], v[52:53]
    v_rcp_f32 v16, v16
    v_rcp_f32 v17, v17
    v_rcp_f32 v18, v18
    v_rcp_f32 v19, v19
    v_rcp_f32 v20, v20
    v_rcp_f32 v21, v21
    v_rcp_f32 v22, v22
    v_rcp_f32 v23, v23
    v_rcp_f32 v24, v24
    v_rcp_f32 v25, v25
    v_rcp_f32 v26, v26
    v_rcp_f32 v27, v27
    v_rcp_f32 v28, v28
    v_rcp_f32 v29, v29
    v_rcp_f32 v30, v30
    v_rcp_f32 v31, v31
    s_nop 0
    v_pk_mul_f32 v[176:177], v[176:177], v[16:17]
    v_pk_mul_f32 v[178:179], v[178:179], v[18:19]
    v_pk_mul_f32 v[180:181], v[180:181], v[20:21]
    v_pk_mul_f32 v[182:183], v[182:183], v[22:23]
    v_pk_mul_f32 v[184:185], v[184:185], v[24:25]
    v_pk_mul_f32 v[186:187], v[186:187], v[26:27]
    v_pk_mul_f32 v[188:189], v[188:189], v[28:29]
    v_pk_mul_f32 v[190:191], v[190:191], v[30:31]
    v_cvt_pk_bf16_f32 v160, v176, v177
    v_cvt_pk_bf16_f32 v161, v178, v179
    v_cvt_pk_bf16_f32 v162, v180, v181
    v_cvt_pk_bf16_f32 v163, v182, v183
    v_cvt_pk_bf16_f32 v164, v184, v185
    v_cvt_pk_bf16_f32 v165, v186, v187
    v_cvt_pk_bf16_f32 v166, v188, v189
    v_cvt_pk_bf16_f32 v167, v190, v191
    s_add_u32 s9, s8, 2048
    buffer_store_dwordx4 v[160:163], v3, s[56:59], s9 offen sc1
    buffer_store_dwordx4 v[164:167], v3, s[56:59], s9 offen offset:1024 sc1
    v_pk_mul_f32 v[16:17], v[46:47], v[64:65]
    v_pk_mul_f32 v[18:19], v[46:47], v[66:67]
    v_pk_mul_f32 v[20:21], v[46:47], v[68:69]
    v_pk_mul_f32 v[22:23], v[46:47], v[70:71]
    v_pk_mul_f32 v[24:25], v[46:47], v[72:73]
    v_pk_mul_f32 v[26:27], v[46:47], v[74:75]
    v_pk_mul_f32 v[28:29], v[46:47], v[76:77]
    v_pk_mul_f32 v[30:31], v[46:47], v[78:79]
    v_pk_fma_f32 v[192:193], v[192:193], v[44:45], v[16:17]
    v_pk_fma_f32 v[194:195], v[194:195], v[44:45], v[18:19]
    v_pk_fma_f32 v[196:197], v[196:197], v[44:45], v[20:21]
    v_pk_fma_f32 v[198:199], v[198:199], v[44:45], v[22:23]
    v_pk_fma_f32 v[200:201], v[200:201], v[44:45], v[24:25]
    v_pk_fma_f32 v[202:203], v[202:203], v[44:45], v[26:27]
    v_pk_fma_f32 v[204:205], v[204:205], v[44:45], v[28:29]
    v_pk_fma_f32 v[206:207], v[206:207], v[44:45], v[30:31]
    v_pk_mul_f32 v[16:17], v[46:47], v[80:81]
    v_pk_mul_f32 v[18:19], v[46:47], v[82:83]
    v_pk_mul_f32 v[20:21], v[46:47], v[84:85]
    v_pk_mul_f32 v[22:23], v[46:47], v[86:87]
    v_pk_mul_f32 v[24:25], v[46:47], v[88:89]
    v_pk_mul_f32 v[26:27], v[46:47], v[90:91]
    v_pk_mul_f32 v[28:29], v[46:47], v[92:93]
    v_pk_mul_f32 v[30:31], v[46:47], v[94:95]
    v_pk_fma_f32 v[208:209], v[208:209], v[44:45], v[16:17]
    v_pk_fma_f32 v[210:211], v[210:211], v[44:45], v[18:19]
    v_pk_fma_f32 v[212:213], v[212:213], v[44:45], v[20:21]
    v_pk_fma_f32 v[214:215], v[214:215], v[44:45], v[22:23]
    v_pk_fma_f32 v[216:217], v[216:217], v[44:45], v[24:25]
    v_pk_fma_f32 v[218:219], v[218:219], v[44:45], v[26:27]
    v_pk_fma_f32 v[220:221], v[220:221], v[44:45], v[28:29]
    v_pk_fma_f32 v[222:223], v[222:223], v[44:45], v[30:31]
    v_pk_mul_f32 v[16:17], v[192:193], v[192:193]
    v_pk_mul_f32 v[18:19], v[194:195], v[194:195]
    v_pk_mul_f32 v[20:21], v[196:197], v[196:197]
    v_pk_mul_f32 v[22:23], v[198:199], v[198:199]
    v_pk_mul_f32 v[24:25], v[200:201], v[200:201]
    v_pk_mul_f32 v[26:27], v[202:203], v[202:203]
    v_pk_mul_f32 v[28:29], v[204:205], v[204:205]
    v_pk_mul_f32 v[30:31], v[206:207], v[206:207]
    v_pk_fma_f32 v[16:17], v[16:17], v[50:51], v[48:49]
    v_pk_fma_f32 v[18:19], v[18:19], v[50:51], v[48:49]
    v_pk_fma_f32 v[20:21], v[20:21], v[50:51], v[48:49]
    v_pk_fma_f32 v[22:23], v[22:23], v[50:51], v[48:49]
    v_pk_fma_f32 v[24:25], v[24:25], v[50:51], v[48:49]
    v_pk_fma_f32 v[26:27], v[26:27], v[50:51], v[48:49]
    v_pk_fma_f32 v[28:29], v[28:29], v[50:51], v[48:49]
    v_pk_fma_f32 v[30:31], v[30:31], v[50:51], v[48:49]
    v_pk_mul_f32 v[16:17], v[16:17], v[192:193]
    v_pk_mul_f32 v[18:19], v[18:19], v[194:195]
    v_pk_mul_f32 v[20:21], v[20:21], v[196:197]
    v_pk_mul_f32 v[22:23], v[22:23], v[198:199]
    v_pk_mul_f32 v[24:25], v[24:25], v[200:201]
    v_pk_mul_f32 v[26:27], v[26:27], v[202:203]
    v_pk_mul_f32 v[28:29], v[28:29], v[204:205]
    v_pk_mul_f32 v[30:31], v[30:31], v[206:207]
    v_exp_f32 v16, v16
    v_exp_f32 v17, v17
    v_exp_f32 v18, v18
    v_exp_f32 v19, v19
    v_exp_f32 v20, v20
    v_exp_f32 v21, v21
    v_exp_f32 v22, v22
    v_exp_f32 v23, v23
    v_exp_f32 v24, v24
    v_exp_f32 v25, v25
    v_exp_f32 v26, v26
    v_exp_f32 v27, v27
    v_exp_f32 v28, v28
    v_exp_f32 v29, v29
    v_exp_f32 v30, v30
    v_exp_f32 v31, v31
    v_pk_mul_f32 v[208:209], v[208:209], v[192:193]
    v_pk_mul_f32 v[210:211], v[210:211], v[194:195]
    v_pk_mul_f32 v[212:213], v[212:213], v[196:197]
    v_pk_mul_f32 v[214:215], v[214:215], v[198:199]
    v_pk_mul_f32 v[216:217], v[216:217], v[200:201]
    v_pk_mul_f32 v[218:219], v[218:219], v[202:203]
    v_pk_mul_f32 v[220:221], v[220:221], v[204:205]
    v_pk_mul_f32 v[222:223], v[222:223], v[206:207]
    v_pk_add_f32 v[16:17], v[16:17], v[52:53]
    v_pk_add_f32 v[18:19], v[18:19], v[52:53]
    v_pk_add_f32 v[20:21], v[20:21], v[52:53]
    v_pk_add_f32 v[22:23], v[22:23], v[52:53]
    v_pk_add_f32 v[24:25], v[24:25], v[52:53]
    v_pk_add_f32 v[26:27], v[26:27], v[52:53]
    v_pk_add_f32 v[28:29], v[28:29], v[52:53]
    v_pk_add_f32 v[30:31], v[30:31], v[52:53]
    v_rcp_f32 v16, v16
    v_rcp_f32 v17, v17
    v_rcp_f32 v18, v18
    v_rcp_f32 v19, v19
    v_rcp_f32 v20, v20
    v_rcp_f32 v21, v21
    v_rcp_f32 v22, v22
    v_rcp_f32 v23, v23
    v_rcp_f32 v24, v24
    v_rcp_f32 v25, v25
    v_rcp_f32 v26, v26
    v_rcp_f32 v27, v27
    v_rcp_f32 v28, v28
    v_rcp_f32 v29, v29
    v_rcp_f32 v30, v30
    v_rcp_f32 v31, v31
    s_nop 0
    v_pk_mul_f32 v[208:209], v[208:209], v[16:17]
    v_pk_mul_f32 v[210:211], v[210:211], v[18:19]
    v_pk_mul_f32 v[212:213], v[212:213], v[20:21]
    v_pk_mul_f32 v[214:215], v[214:215], v[22:23]
    v_pk_mul_f32 v[216:217], v[216:217], v[24:25]
    v_pk_mul_f32 v[218:219], v[218:219], v[26:27]
    v_pk_mul_f32 v[220:221], v[220:221], v[28:29]
    v_pk_mul_f32 v[222:223], v[222:223], v[30:31]
    v_cvt_pk_bf16_f32 v192, v208, v209
    v_cvt_pk_bf16_f32 v193, v210, v211
    v_cvt_pk_bf16_f32 v194, v212, v213
    v_cvt_pk_bf16_f32 v195, v214, v215
    v_cvt_pk_bf16_f32 v196, v216, v217
    v_cvt_pk_bf16_f32 v197, v218, v219
    v_cvt_pk_bf16_f32 v198, v220, v221
    v_cvt_pk_bf16_f32 v199, v222, v223
    s_add_u32 s9, s8, 114688
    buffer_store_dwordx4 v[192:195], v3, s[56:59], s9 offen sc1
    buffer_store_dwordx4 v[196:199], v3, s[56:59], s9 offen offset:1024 sc1
    v_pk_mul_f32 v[16:17], v[46:47], v[96:97]
    v_pk_mul_f32 v[18:19], v[46:47], v[98:99]
    v_pk_mul_f32 v[20:21], v[46:47], v[100:101]
    v_pk_mul_f32 v[22:23], v[46:47], v[102:103]
    v_pk_mul_f32 v[24:25], v[46:47], v[104:105]
    v_pk_mul_f32 v[26:27], v[46:47], v[106:107]
    v_pk_mul_f32 v[28:29], v[46:47], v[108:109]
    v_pk_mul_f32 v[30:31], v[46:47], v[110:111]
    v_pk_fma_f32 v[224:225], v[224:225], v[44:45], v[16:17]
    v_pk_fma_f32 v[226:227], v[226:227], v[44:45], v[18:19]
    v_pk_fma_f32 v[228:229], v[228:229], v[44:45], v[20:21]
    v_pk_fma_f32 v[230:231], v[230:231], v[44:45], v[22:23]
    v_pk_fma_f32 v[232:233], v[232:233], v[44:45], v[24:25]
    v_pk_fma_f32 v[234:235], v[234:235], v[44:45], v[26:27]
    v_pk_fma_f32 v[236:237], v[236:237], v[44:45], v[28:29]
    v_pk_fma_f32 v[238:239], v[238:239], v[44:45], v[30:31]
    v_pk_mul_f32 v[16:17], v[46:47], v[112:113]
    v_pk_mul_f32 v[18:19], v[46:47], v[114:115]
    v_pk_mul_f32 v[20:21], v[46:47], v[116:117]
    v_pk_mul_f32 v[22:23], v[46:47], v[118:119]
    v_pk_mul_f32 v[24:25], v[46:47], v[120:121]
    v_pk_mul_f32 v[26:27], v[46:47], v[122:123]
    v_pk_mul_f32 v[28:29], v[46:47], v[124:125]
    v_pk_mul_f32 v[30:31], v[46:47], v[126:127]
    v_pk_fma_f32 v[240:241], v[240:241], v[44:45], v[16:17]
    v_pk_fma_f32 v[242:243], v[242:243], v[44:45], v[18:19]
    v_pk_fma_f32 v[244:245], v[244:245], v[44:45], v[20:21]
    v_pk_fma_f32 v[246:247], v[246:247], v[44:45], v[22:23]
    v_pk_fma_f32 v[248:249], v[248:249], v[44:45], v[24:25]
    v_pk_fma_f32 v[250:251], v[250:251], v[44:45], v[26:27]
    v_pk_fma_f32 v[252:253], v[252:253], v[44:45], v[28:29]
    v_pk_fma_f32 v[254:255], v[254:255], v[44:45], v[30:31]
    v_pk_mul_f32 v[16:17], v[224:225], v[224:225]
    v_pk_mul_f32 v[18:19], v[226:227], v[226:227]
    v_pk_mul_f32 v[20:21], v[228:229], v[228:229]
    v_pk_mul_f32 v[22:23], v[230:231], v[230:231]
    v_pk_mul_f32 v[24:25], v[232:233], v[232:233]
    v_pk_mul_f32 v[26:27], v[234:235], v[234:235]
    v_pk_mul_f32 v[28:29], v[236:237], v[236:237]
    v_pk_mul_f32 v[30:31], v[238:239], v[238:239]
    v_pk_fma_f32 v[16:17], v[16:17], v[50:51], v[48:49]
    v_pk_fma_f32 v[18:19], v[18:19], v[50:51], v[48:49]
    v_pk_fma_f32 v[20:21], v[20:21], v[50:51], v[48:49]
    v_pk_fma_f32 v[22:23], v[22:23], v[50:51], v[48:49]
    v_pk_fma_f32 v[24:25], v[24:25], v[50:51], v[48:49]
    v_pk_fma_f32 v[26:27], v[26:27], v[50:51], v[48:49]
    v_pk_fma_f32 v[28:29], v[28:29], v[50:51], v[48:49]
    v_pk_fma_f32 v[30:31], v[30:31], v[50:51], v[48:49]
    v_pk_mul_f32 v[16:17], v[16:17], v[224:225]
    v_pk_mul_f32 v[18:19], v[18:19], v[226:227]
    v_pk_mul_f32 v[20:21], v[20:21], v[228:229]
    v_pk_mul_f32 v[22:23], v[22:23], v[230:231]
    v_pk_mul_f32 v[24:25], v[24:25], v[232:233]
    v_pk_mul_f32 v[26:27], v[26:27], v[234:235]
    v_pk_mul_f32 v[28:29], v[28:29], v[236:237]
    v_pk_mul_f32 v[30:31], v[30:31], v[238:239]
    v_exp_f32 v16, v16
    v_exp_f32 v17, v17
    v_exp_f32 v18, v18
    v_exp_f32 v19, v19
    v_exp_f32 v20, v20
    v_exp_f32 v21, v21
    v_exp_f32 v22, v22
    v_exp_f32 v23, v23
    v_exp_f32 v24, v24
    v_exp_f32 v25, v25
    v_exp_f32 v26, v26
    v_exp_f32 v27, v27
    v_exp_f32 v28, v28
    v_exp_f32 v29, v29
    v_exp_f32 v30, v30
    v_exp_f32 v31, v31
    v_pk_mul_f32 v[240:241], v[240:241], v[224:225]
    v_pk_mul_f32 v[242:243], v[242:243], v[226:227]
    v_pk_mul_f32 v[244:245], v[244:245], v[228:229]
    v_pk_mul_f32 v[246:247], v[246:247], v[230:231]
    v_pk_mul_f32 v[248:249], v[248:249], v[232:233]
    v_pk_mul_f32 v[250:251], v[250:251], v[234:235]
    v_pk_mul_f32 v[252:253], v[252:253], v[236:237]
    v_pk_mul_f32 v[254:255], v[254:255], v[238:239]
    v_pk_add_f32 v[16:17], v[16:17], v[52:53]
    v_pk_add_f32 v[18:19], v[18:19], v[52:53]
    v_pk_add_f32 v[20:21], v[20:21], v[52:53]
    v_pk_add_f32 v[22:23], v[22:23], v[52:53]
    v_pk_add_f32 v[24:25], v[24:25], v[52:53]
    v_pk_add_f32 v[26:27], v[26:27], v[52:53]
    v_pk_add_f32 v[28:29], v[28:29], v[52:53]
    v_pk_add_f32 v[30:31], v[30:31], v[52:53]
    v_rcp_f32 v16, v16
    v_rcp_f32 v17, v17
    v_rcp_f32 v18, v18
    v_rcp_f32 v19, v19
    v_rcp_f32 v20, v20
    v_rcp_f32 v21, v21
    v_rcp_f32 v22, v22
    v_rcp_f32 v23, v23
    v_rcp_f32 v24, v24
    v_rcp_f32 v25, v25
    v_rcp_f32 v26, v26
    v_rcp_f32 v27, v27
    v_rcp_f32 v28, v28
    v_rcp_f32 v29, v29
    v_rcp_f32 v30, v30
    v_rcp_f32 v31, v31
    s_nop 0
    v_pk_mul_f32 v[240:241], v[240:241], v[16:17]
    v_pk_mul_f32 v[242:243], v[242:243], v[18:19]
    v_pk_mul_f32 v[244:245], v[244:245], v[20:21]
    v_pk_mul_f32 v[246:247], v[246:247], v[22:23]
    v_pk_mul_f32 v[248:249], v[248:249], v[24:25]
    v_pk_mul_f32 v[250:251], v[250:251], v[26:27]
    v_pk_mul_f32 v[252:253], v[252:253], v[28:29]
    v_pk_mul_f32 v[254:255], v[254:255], v[30:31]
    v_cvt_pk_bf16_f32 v224, v240, v241
    v_cvt_pk_bf16_f32 v225, v242, v243
    v_cvt_pk_bf16_f32 v226, v244, v245
    v_cvt_pk_bf16_f32 v227, v246, v247
    v_cvt_pk_bf16_f32 v228, v248, v249
    v_cvt_pk_bf16_f32 v229, v250, v251
    v_cvt_pk_bf16_f32 v230, v252, v253
    v_cvt_pk_bf16_f32 v231, v254, v255
    s_add_u32 s9, s8, 116736
    buffer_store_dwordx4 v[224:227], v3, s[56:59], s9 offen sc1
    buffer_store_dwordx4 v[228:231], v3, s[56:59], s9 offen offset:1024 sc1
    s_lshl_b32 s12, s4, 7
    s_lshl_b32 s13, s5, 2
    s_add_u32 s12, s12, s13
    s_add_u32 s12, s12, 204800
    s_waitcnt vmcnt(0)
    s_barrier
    s_cmp_lg_u32 s3, 0
    s_cbranch_scc1 SIG_33
    v_mul_u32_u24 v2, 0, v1
    v_mov_b32 v3, s74
    s_mov_b32 exec_lo, 0x1
    s_mov_b32 exec_hi, 0x0
    buffer_store_dword v3, v2, s[52:55], s12 offen sc0 sc1
    s_mov_b64 exec, -1
SIG_33:
    s_branch K_flush
K_fin:
    s_sub_u32 s9, s2, 512
K_fin2:
    s_setprio 1
    s_and_b32 s4, s9, 7
    s_lshl_b32 s4, s4, 2
    s_lshr_b32 s5, s9, 3
    s_and_b32 s6, s5, 3
    s_add_u32 s4, s4, s6
    s_lshr_b32 s5, s5, 2
    s_mov_b32 s40, s32
    s_and_b32 s41, s33, 0xffff
    s_mov_b32 s42, 1835008
    s_mov_b32 s43, 0x00020000
    s_mov_b32 s44, s24
    s_and_b32 s45, s25, 0xffff
    s_mov_b32 s46, 524288
    s_mov_b32 s47, 0x00020000
    s_mov_b32 s48, s16
    s_and_b32 s49, s17, 0xffff
    s_mov_b32 s50, 2097152
    s_mov_b32 s51, 0x00020000
    s_mov_b32 s52, s38
    s_and_b32 s53, s39, 0xffff
    s_mov_b32 s54, 524288
    s_mov_b32 s55, 0x00020000
    s_add_u32 s56, s38, 1048576
    s_addc_u32 s57, s39, 0
    s_and_b32 s57, s57, 0xffff
    s_mov_b32 s58, 7340032
    s_mov_b32 s59, 0x00020000
    s_add_u32 s60, s38, 8388608
    s_addc_u32 s61, s39, 0
    s_and_b32 s61, s61, 0xffff
    s_mov_b32 s62, 2097152
    s_mov_b32 s63, 0x00020000
    s_mov_b32 s64, s34
    s_and_b32 s65, s35, 0xffff
    s_mov_b32 s66, 2097152
    s_mov_b32 s67, 0x00020000
    v_lshrrev_b32 v3, 3, v1
    v_lshlrev_b32 v3, 10, v3
    v_bfe_u32 v4, v1, 2, 1
    v_bfe_u32 v5, v1, 4, 1
    v_xor_b32 v4, v4, v5
    v_lshl_add_u32 v8, v4, 6, v3
    v_and_b32 v4, 3, v1
    v_lshl_add_u32 v8, v4, 4, v8
    v_lshlrev_b32 v9, 4, v1
    s_lshl_b32 s6, s3, 14
    v_lshrrev_b32 v7, 5, v1
    v_and_b32 v6, 31, v1
    v_bfe_u32 v2, v1, 2, 2
    v_lshl_add_u32 v10, v7, 2, v2
    v_lshlrev_b32 v10, 7, v10
    v_lshrrev_b32 v2, 1, v2
    v_lshl_add_u32 v10, v2, 6, v10
    v_and_b32 v2, 1, v1
    v_lshl_add_u32 v10, v2, 5, v10
    v_bfe_u32 v2, v1, 4, 1
    v_lshl_add_u32 v10, v2, 4, v10
    v_bfe_u32 v2, v1, 1, 1
    v_lshl_add_u32 v10, v2, 3, v10
    v_add_u32 v10, s6, v10
    v_xor_b32 v11, 64, v10
    v_mov_b32 v192, 0
    v_mov_b32 v193, 0
    v_mov_b32 v194, 0
    v_mov_b32 v195, 0
    v_mov_b32 v196, 0
    v_mov_b32 v197, 0
    v_mov_b32 v198, 0
    v_mov_b32 v199, 0
    v_mov_b32 v200, 0
    v_mov_b32 v201, 0
    v_mov_b32 v202, 0
    v_mov_b32 v203, 0
    v_mov_b32 v204, 0
    v_mov_b32 v205, 0
    v_mov_b32 v206, 0
    v_mov_b32 v207, 0
    v_mov_b32 v208, 0
    v_mov_b32 v209, 0
    v_mov_b32 v210, 0
    v_mov_b32 v211, 0
    v_mov_b32 v212, 0
    v_mov_b32 v213, 0
    v_mov_b32 v214, 0
    v_mov_b32 v215, 0
    v_mov_b32 v216, 0
    v_mov_b32 v217, 0
    v_mov_b32 v218, 0
    v_mov_b32 v219, 0
    v_mov_b32 v220, 0
    v_mov_b32 v221, 0
    v_mov_b32 v222, 0
    v_mov_b32 v223, 0
    v_mov_b32 v224, 0
    v_mov_b32 v225, 0
    v_mov_b32 v226, 0
    v_mov_b32 v227, 0
    v_mov_b32 v228, 0
    v_mov_b32 v229, 0
    v_mov_b32 v230, 0
    v_mov_b32 v231, 0
    v_mov_b32 v232, 0
    v_mov_b32 v233, 0
    v_mov_b32 v234, 0
    v_mov_b32 v235, 0
    v_mov_b32 v236, 0
    v_mov_b32 v237, 0
    v_mov_b32 v238, 0
    v_mov_b32 v239, 0
    v_mov_b32 v240, 0
    v_mov_b32 v241, 0
    v_mov_b32 v242, 0
    v_mov_b32 v243, 0
    v_mov_b32 v244, 0
    v_mov_b32 v245, 0
    v_mov_b32 v246, 0
    v_mov_b32 v247, 0
    v_mov_b32 v248, 0
    v_mov_b32 v249, 0
    v_mov_b32 v250, 0
    v_mov_b32 v251, 0
    v_mov_b32 v252, 0
    v_mov_b32 v253, 0
    v_mov_b32 v254, 0
    v_mov_b32 v255, 0
    s_and_b32 s7, s3, 1
    s_lshr_b32 s8, s3, 1
    s_lshl_b32 s9, s4, 6
    s_lshl_b32 s10, s7, 5
    s_add_u32 s9, s9, s10
    v_add_u32 v12, s9, v6
    v_lshlrev_b32 v12, 10, v12
    v_lshl_add_u32 v12, v7, 5, v12
    s_lshl_b32 s9, s5, 7
    s_lshl_b32 s10, s8, 6
    s_add_u32 s9, s9, s10
    v_add_u32 v12, s9, v12
    buffer_load_dwordx4 v[16:19], v12, s[48:51], 0 offen
    buffer_load_dwordx4 v[20:23], v12, s[48:51], 0 offen offset:16
    s_and_b32 s70, s4, 3
    s_mul_i32 s70, s70, 7
    s_mul_i32 s71, s5, 7
    s_lshr_b32 s71, s71, 1
    s_add_u32 s70, s70, s71
    s_cmp_ge_u32 s70, 28
    s_cselect_b32 s71, 28, 0
    s_sub_u32 s70, s70, s71
    s_mov_b32 s72, s70
    s_lshl_b32 s11, s4, 1
    s_mul_i32 s11, s11, 112
    s_mul_i32 s12, s3, 28
    s_add_u32 s11, s11, s12
    s_lshl_b32 s11, s11, 10
    s_lshl_b32 s12, s12, 14
    s_lshl_b32 s13, s5, 7
    s_add_u32 s12, s12, s13
    s_lshl_b32 s15, s70, 14
    s_add_u32 s15, s15, s12
    s_add_u32 s70, s70, 1
    s_cmp_eq_u32 s70, 28
    s_cselect_b32 s70, 0, s70
    s_add_u32 m0, s6, 0
    s_add_u32 s14, s15, 0
    buffer_load_dwordx4 v8, s[40:43], s14 offen lds
    s_add_u32 m0, s6, 1024
    s_add_u32 s14, s15, 8192
    buffer_load_dwordx4 v8, s[40:43], s14 offen lds
    s_lshl_b32 s15, s70, 14
    s_add_u32 s15, s15, s12
    s_add_u32 s70, s70, 1
    s_cmp_eq_u32 s70, 28
    s_cselect_b32 s70, 0, s70
    s_add_u32 m0, s6, 2048
    s_add_u32 s14, s15, 0
    buffer_load_dwordx4 v8, s[40:43], s14 offen lds
    s_add_u32 m0, s6, 3072
    s_add_u32 s14, s15, 8192
    buffer_load_dwordx4 v8, s[40:43], s14 offen lds
    s_lshl_b32 s15, s70, 14
    s_add_u32 s15, s15, s12
    s_add_u32 s70, s70, 1
    s_cmp_eq_u32 s70, 28
    s_cselect_b32 s70, 0, s70
    s_add_u32 m0, s6, 4096
    s_add_u32 s14, s15, 0
    buffer_load_dwordx4 v8, s[40:43], s14 offen lds
    s_add_u32 m0, s6, 5120
    s_add_u32 s14, s15, 8192
    buffer_load_dwordx4 v8, s[40:43], s14 offen lds
    s_lshl_b32 s15, s70, 14
    s_add_u32 s15, s15, s12
    s_add_u32 s70, s70, 1
    s_cmp_eq_u32 s70, 28
    s_cselect_b32 s70, 0, s70
    s_add_u32 m0, s6, 6144
    s_add_u32 s14, s15, 0
    buffer_load_dwordx4 v8, s[40:43], s14 offen lds
    s_add_u32 m0, s6, 7168
    s_add_u32 s14, s15, 8192
    buffer_load_dwordx4 v8, s[40:43], s14 offen lds
    s_lshl_b32 s15, s70, 14
    s_add_u32 s15, s15, s12
    s_add_u32 s70, s70, 1
    s_cmp_eq_u32 s70, 28
    s_cselect_b32 s70, 0, s70
    s_add_u32 m0, s6, 8192
    s_add_u32 s14, s15, 0
    buffer_load_dwordx4 v8, s[40:43], s14 offen lds
    s_add_u32 m0, s6, 9216
    s_add_u32 s14, s15, 8192
    buffer_load_dwordx4 v8, s[40:43], s14 offen lds
    s_lshl_b32 s15, s70, 14
    s_add_u32 s15, s15, s12
    s_add_u32 s70, s70, 1
    s_cmp_eq_u32 s70, 28
    s_cselect_b32 s70, 0, s70
    s_add_u32 m0, s6, 10240
    s_add_u32 s14, s15, 0
    buffer_load_dwordx4 v8, s[40:43], s14 offen lds
    s_add_u32 m0, s6, 11264
    s_add_u32 s14, s15, 8192
    buffer_load_dwordx4 v8, s[40:43], s14 offen lds
    s_cmp_lg_u32 s3, 0
    s_cbranch_scc1 WGW_34
    v_mov_b32 v2, 0
    global_load_dword v3, v2, s[36:37]
    s_waitcnt vmcnt(0)
    v_readfirstlane_b32 s74, v3
    s_cmp_lg_u32 s74, 0
    s_cbranch_scc1 TAGD_36
    s_mov_b32 s75, 0
TAG_35:
    s_sleep 4
    global_load_dword v3, v2, s[36:37] sc0 sc1
    s_waitcnt vmcnt(0)
    v_readfirstlane_b32 s74, v3
    s_cmp_lg_u32 s74, 0
    s_cbranch_scc1 TAGD_36
    s_add_u32 s75, s75, 1
    s_cmp_lt_u32 s75, 200000
    s_cbranch_scc1 TAG_35
TAGD_36:
    s_lshr_b32 s14, s4, 1
    s_lshl_b32 s14, s14, 7
    s_add_u32 s14, s14, 204800
    v_lshlrev_b32 v2, 2, v1
    s_mov_b32 s75, 0
    s_mov_b32 exec_lo, 0x3fff
    s_mov_b32 exec_hi, 0x0
POLL_37:
    buffer_load_dword v3, v2, s[52:55], s14 offen sc0 sc1
    s_waitcnt vmcnt(0)
    v_cmp_ne_u32 vcc, s74, v3
    s_cbranch_vccz POLLD_38
    s_sleep 2
    s_add_u32 s75, s75, 1
    s_cmp_lt_u32 s75, 200000
    s_cbranch_scc1 POLL_37
POLLD_38:
    s_mov_b64 exec, -1
WGW_34:
    s_barrier
    s_lshl_b32 s15, s72, 10
    s_add_u32 s15, s15, s11
    s_add_u32 s72, s72, 1
    s_cmp_eq_u32 s72, 28
    s_cselect_b32 s72, 0, s72
    s_add_u32 s14, s15, 0
    buffer_load_dwordx4 v[64:67], v9, s[56:59], s14 offen sc1
    s_add_u32 s14, s15, 114688
    buffer_load_dwordx4 v[68:71], v9, s[56:59], s14 offen sc1
    s_lshl_b32 s15, s72, 10
    s_add_u32 s15, s15, s11
    s_add_u32 s72, s72, 1
    s_cmp_eq_u32 s72, 28
    s_cselect_b32 s72, 0, s72
    s_add_u32 s14, s15, 0
    buffer_load_dwordx4 v[72:75], v9, s[56:59], s14 offen sc1
    s_add_u32 s14, s15, 114688
    buffer_load_dwordx4 v[76:79], v9, s[56:59], s14 offen sc1
    s_lshl_b32 s15, s72, 10
    s_add_u32 s15, s15, s11
    s_add_u32 s72, s72, 1
    s_cmp_eq_u32 s72, 28
    s_cselect_b32 s72, 0, s72
    s_add_u32 s14, s15, 0
    buffer_load_dwordx4 v[80:83], v9, s[56:59], s14 offen sc1
    s_add_u32 s14, s15, 114688
    buffer_load_dwordx4 v[84:87], v9, s[56:59], s14 offen sc1
    s_lshl_b32 s15, s72, 10
    s_add_u32 s15, s15, s11
    s_add_u32 s72, s72, 1
    s_cmp_eq_u32 s72, 28
    s_cselect_b32 s72, 0, s72
    s_add_u32 s14, s15, 0
    buffer_load_dwordx4 v[88:91], v9, s[56:59], s14 offen sc1
    s_add_u32 s14, s15, 114688
    buffer_load_dwordx4 v[92:95], v9, s[56:59], s14 offen sc1
    s_lshl_b32 s15, s72, 10
    s_add_u32 s15, s15, s11
    s_add_u32 s72, s72, 1
    s_cmp_eq_u32 s72, 28
    s_cselect_b32 s72, 0, s72
    s_add_u32 s14, s15, 0
    buffer_load_dwordx4 v[96:99], v9, s[56:59], s14 offen sc1
    s_add_u32 s14, s15, 114688
    buffer_load_dwordx4 v[100:103], v9, s[56:59], s14 offen sc1
    s_lshl_b32 s15, s72, 10
    s_add_u32 s15, s15, s11
    s_add_u32 s72, s72, 1
    s_cmp_eq_u32 s72, 28
    s_cselect_b32 s72, 0, s72
    s_add_u32 s14, s15, 0
    buffer_load_dwordx4 v[104:107], v9, s[56:59], s14 offen sc1
    s_add_u32 s14, s15, 114688
    buffer_load_dwordx4 v[108:111], v9, s[56:59], s14 offen sc1
    s_waitcnt vmcnt(12)
    ds_read_b64_tr_b16 v[128:129], v10 offset:0
    ds_read_b64_tr_b16 v[130:131], v10 offset:1024
    ds_read_b64_tr_b16 v[132:133], v11 offset:0
    ds_read_b64_tr_b16 v[134:135], v11 offset:1024
    ds_read_b64_tr_b16 v[136:137], v10 offset:2048
    ds_read_b64_tr_b16 v[138:139], v10 offset:3072
    ds_read_b64_tr_b16 v[140:141], v11 offset:2048
    ds_read_b64_tr_b16 v[142:143], v11 offset:3072
    s_waitcnt vmcnt(10) lgkmcnt(4)
    v_mfma_f32_32x32x16_bf16 v[192:207], v[128:131], v[64:67], v[192:207]
    ds_read_b64_tr_b16 v[144:145], v10 offset:4096
    ds_read_b64_tr_b16 v[146:147], v10 offset:5120
    ds_read_b64_tr_b16 v[148:149], v11 offset:4096
    ds_read_b64_tr_b16 v[150:151], v11 offset:5120
    s_lshl_b32 s15, s70, 14
    s_add_u32 s15, s15, s12
    s_add_u32 s70, s70, 1
    s_cmp_eq_u32 s70, 28
    s_cselect_b32 s70, 0, s70
    s_add_u32 m0, s6, 12288
    s_add_u32 s14, s15, 0
    buffer_load_dwordx4 v8, s[40:43], s14 offen lds
    v_mfma_f32_32x32x16_bf16 v[224:239], v[128:131], v[68:71], v[224:239]
    s_add_u32 m0, s6, 13312
    s_add_u32 s14, s15, 8192
    buffer_load_dwordx4 v8, s[40:43], s14 offen lds
    v_mfma_f32_32x32x16_bf16 v[208:223], v[132:135], v[64:67], v[208:223]
    s_lshl_b32 s69, s72, 10
    s_add_u32 s69, s69, s11
    s_add_u32 s72, s72, 1
    s_cmp_eq_u32 s72, 28
    s_cselect_b32 s72, 0, s72
    s_add_u32 s14, s69, 0
    buffer_load_dwordx4 v[112:115], v9, s[56:59], s14 offen sc1
    v_mfma_f32_32x32x16_bf16 v[240:255], v[132:135], v[68:71], v[240:255]
    s_add_u32 s14, s69, 114688
    buffer_load_dwordx4 v[116:119], v9, s[56:59], s14 offen sc1
    s_waitcnt vmcnt(12) lgkmcnt(4)
    v_mfma_f32_32x32x16_bf16 v[192:207], v[136:139], v[72:75], v[192:207]
    ds_read_b64_tr_b16 v[128:129], v10 offset:6144
    ds_read_b64_tr_b16 v[130:131], v10 offset:7168
    ds_read_b64_tr_b16 v[132:133], v11 offset:6144
    ds_read_b64_tr_b16 v[134:135], v11 offset:7168
    s_lshl_b32 s15, s70, 14
    s_add_u32 s15, s15, s12
    s_add_u32 s70, s70, 1
    s_cmp_eq_u32 s70, 28
    s_cselect_b32 s70, 0, s70
    s_add_u32 m0, s6, 0
    s_add_u32 s14, s15, 0
    buffer_load_dwordx4 v8, s[40:43], s14 offen lds
    v_mfma_f32_32x32x16_bf16 v[224:239], v[136:139], v[76:79], v[224:239]
    s_add_u32 m0, s6, 1024
    s_add_u32 s14, s15, 8192
    buffer_load_dwordx4 v8, s[40:43], s14 offen lds
    v_mfma_f32_32x32x16_bf16 v[208:223], v[140:143], v[72:75], v[208:223]
    s_lshl_b32 s69, s72, 10
    s_add_u32 s69, s69, s11
    s_add_u32 s72, s72, 1
    s_cmp_eq_u32 s72, 28
    s_cselect_b32 s72, 0, s72
    s_add_u32 s14, s69, 0
    buffer_load_dwordx4 v[64:67], v9, s[56:59], s14 offen sc1
    v_mfma_f32_32x32x16_bf16 v[240:255], v[140:143], v[76:79], v[240:255]
    s_add_u32 s14, s69, 114688
    buffer_load_dwordx4 v[68:71], v9, s[56:59], s14 offen sc1
    s_waitcnt vmcnt(14) lgkmcnt(4)
    v_mfma_f32_32x32x16_bf16 v[192:207], v[144:147], v[80:83], v[192:207]
    ds_read_b64_tr_b16 v[136:137], v10 offset:8192
    ds_read_b64_tr_b16 v[138:139], v10 offset:9216
    ds_read_b64_tr_b16 v[140:141], v11 offset:8192
    ds_read_b64_tr_b16 v[142:143], v11 offset:9216
    s_lshl_b32 s15, s70, 14
    s_add_u32 s15, s15, s12
    s_add_u32 s70, s70, 1
    s_cmp_eq_u32 s70, 28
    s_cselect_b32 s70, 0, s70
    s_add_u32 m0, s6, 2048
    s_add_u32 s14, s15, 0
    buffer_load_dwordx4 v8, s[40:43], s14 offen lds
    v_mfma_f32_32x32x16_bf16 v[224:239], v[144:147], v[84:87], v[224:239]
    s_add_u32 m0, s6, 3072
    s_add_u32 s14, s15, 8192
    buffer_load_dwordx4 v8, s[40:43], s14 offen lds
    v_mfma_f32_32x32x16_bf16 v[208:223], v[148:151], v[80:83], v[208:223]
    s_lshl_b32 s69, s72, 10
    s_add_u32 s69, s69, s11
    s_add_u32 s72, s72, 1
    s_cmp_eq_u32 s72, 28
    s_cselect_b32 s72, 0, s72
    s_add_u32 s14, s69, 0
    buffer_load_dwordx4 v[72:75], v9, s[56:59], s14 offen sc1
    v_mfma_f32_32x32x16_bf16 v[240:255], v[148:151], v[84:87], v[240:255]
    s_add_u32 s14, s69, 114688
    buffer_load_dwordx4 v[76:79], v9, s[56:59], s14 offen sc1
    s_waitcnt vmcnt(16) lgkmcnt(4)
    v_mfma_f32_32x32x16_bf16 v[192:207], v[128:131], v[88:91], v[192:207]
    ds_read_b64_tr_b16 v[144:145], v10 offset:10240
    ds_read_b64_tr_b16 v[146:147], v10 offset:11264
    ds_read_b64_tr_b16 v[148:149], v11 offset:10240
    ds_read_b64_tr_b16 v[150:151], v11 offset:11264
    s_lshl_b32 s15, s70, 14
    s_add_u32 s15, s15, s12
    s_add_u32 s70, s70, 1
    s_cmp_eq_u32 s70, 28
    s_cselect_b32 s70, 0, s70
    s_add_u32 m0, s6, 4096
    s_add_u32 s14, s15, 0
    buffer_load_dwordx4 v8, s[40:43], s14 offen lds
    v_mfma_f32_32x32x16_bf16 v[224:239], v[128:131], v[92:95], v[224:239]
    s_add_u32 m0, s6, 5120
    s_add_u32 s14, s15, 8192
    buffer_load_dwordx4 v8, s[40:43], s14 offen lds
    v_mfma_f32_32x32x16_bf16 v[208:223], v[132:135], v[88:91], v[208:223]
    s_lshl_b32 s69, s72, 10
    s_add_u32 s69, s69, s11
    s_add_u32 s72, s72, 1
    s_cmp_eq_u32 s72, 28
    s_cselect_b32 s72, 0, s72
    s_add_u32 s14, s69, 0
    buffer_load_dwordx4 v[80:83], v9, s[56:59], s14 offen sc1
    v_mfma_f32_32x32x16_bf16 v[240:255], v[132:135], v[92:95], v[240:255]
    s_add_u32 s14, s69, 114688
    buffer_load_dwordx4 v[84:87], v9, s[56:59], s14 offen sc1
    s_waitcnt vmcnt(14) lgkmcnt(4)
    v_mfma_f32_32x32x16_bf16 v[192:207], v[136:139], v[96:99], v[192:207]
    ds_read_b64_tr_b16 v[128:129], v10 offset:12288
    ds_read_b64_tr_b16 v[130:131], v10 offset:13312
    ds_read_b64_tr_b16 v[132:133], v11 offset:12288
    ds_read_b64_tr_b16 v[134:135], v11 offset:13312
    s_lshl_b32 s15, s70, 14
    s_add_u32 s15, s15, s12
    s_add_u32 s70, s70, 1
    s_cmp_eq_u32 s70, 28
    s_cselect_b32 s70, 0, s70
    s_add_u32 m0, s6, 6144
    s_add_u32 s14, s15, 0
    buffer_load_dwordx4 v8, s[40:43], s14 offen lds
    v_mfma_f32_32x32x16_bf16 v[224:239], v[136:139], v[100:103], v[224:239]
    s_add_u32 m0, s6, 7168
    s_add_u32 s14, s15, 8192
    buffer_load_dwordx4 v8, s[40:43], s14 offen lds
    v_mfma_f32_32x32x16_bf16 v[208:223], v[140:143], v[96:99], v[208:223]
    s_lshl_b32 s69, s72, 10
    s_add_u32 s69, s69, s11
    s_add_u32 s72, s72, 1
    s_cmp_eq_u32 s72, 28
    s_cselect_b32 s72, 0, s72
    s_add_u32 s14, s69, 0
    buffer_load_dwordx4 v[88:91], v9, s[56:59], s14 offen sc1
    v_mfma_f32_32x32x16_bf16 v[240:255], v[140:143], v[100:103], v[240:255]
    s_add_u32 s14, s69, 114688
    buffer_load_dwordx4 v[92:95], v9, s[56:59], s14 offen sc1
    s_waitcnt vmcnt(14) lgkmcnt(4)
    v_mfma_f32_32x32x16_bf16 v[192:207], v[144:147], v[104:107], v[192:207]
    ds_read_b64_tr_b16 v[136:137], v10 offset:0
    ds_read_b64_tr_b16 v[138:139], v10 offset:1024
    ds_read_b64_tr_b16 v[140:141], v11 offset:0
    ds_read_b64_tr_b16 v[142:143], v11 offset:1024
    s_lshl_b32 s15, s70, 14
    s_add_u32 s15, s15, s12
    s_add_u32 s70, s70, 1
    s_cmp_eq_u32 s70, 28
    s_cselect_b32 s70, 0, s70
    s_add_u32 m0, s6, 8192
    s_add_u32 s14, s15, 0
    buffer_load_dwordx4 v8, s[40:43], s14 offen lds
    v_mfma_f32_32x32x16_bf16 v[224:239], v[144:147], v[108:111], v[224:239]
    s_add_u32 m0, s6, 9216
    s_add_u32 s14, s15, 8192
    buffer_load_dwordx4 v8, s[40:43], s14 offen lds
    v_mfma_f32_32x32x16_bf16 v[208:223], v[148:151], v[104:107], v[208:223]
    s_lshl_b32 s69, s72, 10
    s_add_u32 s69, s69, s11
    s_add_u32 s72, s72, 1
    s_cmp_eq_u32 s72, 28
    s_cselect_b32 s72, 0, s72
    s_add_u32 s14, s69, 0
    buffer_load_dwordx4 v[96:99], v9, s[56:59], s14 offen sc1
    v_mfma_f32_32x32x16_bf16 v[240:255], v[148:151], v[108:111], v[240:255]
    s_add_u32 s14, s69, 114688
    buffer_load_dwordx4 v[100:103], v9, s[56:59], s14 offen sc1
    s_waitcnt vmcnt(14) lgkmcnt(4)
    v_mfma_f32_32x32x16_bf16 v[192:207], v[128:131], v[112:115], v[192:207]
    ds_read_b64_tr_b16 v[144:145], v10 offset:2048
    ds_read_b64_tr_b16 v[146:147], v10 offset:3072
    ds_read_b64_tr_b16 v[148:149], v11 offset:2048
    ds_read_b64_tr_b16 v[150:151], v11 offset:3072
    s_lshl_b32 s15, s70, 14
    s_add_u32 s15, s15, s12
    s_add_u32 s70, s70, 1
    s_cmp_eq_u32 s70, 28
    s_cselect_b32 s70, 0, s70
    s_add_u32 m0, s6, 10240
    s_add_u32 s14, s15, 0
    buffer_load_dwordx4 v8, s[40:43], s14 offen lds
    v_mfma_f32_32x32x16_bf16 v[224:239], v[128:131], v[116:119], v[224:239]
    s_add_u32 m0, s6, 11264
    s_add_u32 s14, s15, 8192
    buffer_load_dwordx4 v8, s[40:43], s14 offen lds
    v_mfma_f32_32x32x16_bf16 v[208:223], v[132:135], v[112:115], v[208:223]
    s_lshl_b32 s69, s72, 10
    s_add_u32 s69, s69, s11
    s_add_u32 s72, s72, 1
    s_cmp_eq_u32 s72, 28
    s_cselect_b32 s72, 0, s72
    s_add_u32 s14, s69, 0
    buffer_load_dwordx4 v[104:107], v9, s[56:59], s14 offen sc1
    v_mfma_f32_32x32x16_bf16 v[240:255], v[132:135], v[116:119], v[240:255]
    s_add_u32 s14, s69, 114688
    buffer_load_dwordx4 v[108:111], v9, s[56:59], s14 offen sc1
    s_waitcnt vmcnt(14) lgkmcnt(4)
    v_mfma_f32_32x32x16_bf16 v[192:207], v[136:139], v[64:67], v[192:207]
    ds_read_b64_tr_b16 v[128:129], v10 offset:4096
    ds_read_b64_tr_b16 v[130:131], v10 offset:5120
    ds_read_b64_tr_b16 v[132:133], v11 offset:4096
    ds_read_b64_tr_b16 v[134:135], v11 offset:5120
    s_lshl_b32 s15, s70, 14
    s_add_u32 s15, s15, s12
    s_add_u32 s70, s70, 1
    s_cmp_eq_u32 s70, 28
    s_cselect_b32 s70, 0, s70
    s_add_u32 m0, s6, 12288
    s_add_u32 s14, s15, 0
    buffer_load_dwordx4 v8, s[40:43], s14 offen lds
    v_mfma_f32_32x32x16_bf16 v[224:239], v[136:139], v[68:71], v[224:239]
    s_add_u32 m0, s6, 13312
    s_add_u32 s14, s15, 8192
    buffer_load_dwordx4 v8, s[40:43], s14 offen lds
    v_mfma_f32_32x32x16_bf16 v[208:223], v[140:143], v[64:67], v[208:223]
    s_lshl_b32 s69, s72, 10
    s_add_u32 s69, s69, s11
    s_add_u32 s72, s72, 1
    s_cmp_eq_u32 s72, 28
    s_cselect_b32 s72, 0, s72
    s_add_u32 s14, s69, 0
    buffer_load_dwordx4 v[112:115], v9, s[56:59], s14 offen sc1
    v_mfma_f32_32x32x16_bf16 v[240:255], v[140:143], v[68:71], v[240:255]
    s_add_u32 s14, s69, 114688
    buffer_load_dwordx4 v[116:119], v9, s[56:59], s14 offen sc1
    s_waitcnt vmcnt(14) lgkmcnt(4)
    v_mfma_f32_32x32x16_bf16 v[192:207], v[144:147], v[72:75], v[192:207]
    ds_read_b64_tr_b16 v[136:137], v10 offset:6144
    ds_read_b64_tr_b16 v[138:139], v10 offset:7168
    ds_read_b64_tr_b16 v[140:141], v11 offset:6144
    ds_read_b64_tr_b16 v[142:143], v11 offset:7168
    s_lshl_b32 s15, s70, 14
    s_add_u32 s15, s15, s12
    s_add_u32 s70, s70, 1
    s_cmp_eq_u32 s70, 28
    s_cselect_b32 s70, 0, s70
    s_add_u32 m0, s6, 0
    s_add_u32 s14, s15, 0
    buffer_load_dwordx4 v8, s[40:43], s14 offen lds
    v_mfma_f32_32x32x16_bf16 v[224:239], v[144:147], v[76:79], v[224:239]
    s_add_u32 m0, s6, 1024
    s_add_u32 s14, s15, 8192
    buffer_load_dwordx4 v8, s[40:43], s14 offen lds
    v_mfma_f32_32x32x16_bf16 v[208:223], v[148:151], v[72:75], v[208:223]
    s_lshl_b32 s69, s72, 10
    s_add_u32 s69, s69, s11
    s_add_u32 s72, s72, 1
    s_cmp_eq_u32 s72, 28
    s_cselect_b32 s72, 0, s72
    s_add_u32 s14, s69, 0
    buffer_load_dwordx4 v[64:67], v9, s[56:59], s14 offen sc1
    v_mfma_f32_32x32x16_bf16 v[240:255], v[148:151], v[76:79], v[240:255]
    s_add_u32 s14, s69, 114688
    buffer_load_dwordx4 v[68:71], v9, s[56:59], s14 offen sc1
    s_waitcnt vmcnt(14) lgkmcnt(4)
    v_mfma_f32_32x32x16_bf16 v[192:207], v[128:131], v[80:83], v[192:207]
    ds_read_b64_tr_b16 v[144:145], v10 offset:8192
    ds_read_b64_tr_b16 v[146:147], v10 offset:9216
    ds_read_b64_tr_b16 v[148:149], v11 offset:8192
    ds_read_b64_tr_b16 v[150:151], v11 offset:9216
    s_lshl_b32 s15, s70, 14
    s_add_u32 s15, s15, s12
    s_add_u32 s70, s70, 1
    s_cmp_eq_u32 s70, 28
    s_cselect_b32 s70, 0, s70
    s_add_u32 m0, s6, 2048
    s_add_u32 s14, s15, 0
    buffer_load_dwordx4 v8, s[40:43], s14 offen lds
    v_mfma_f32_32x32x16_bf16 v[224:239], v[128:131], v[84:87], v[224:239]
    s_add_u32 m0, s6, 3072
    s_add_u32 s14, s15, 8192
    buffer_load_dwordx4 v8, s[40:43], s14 offen lds
    v_mfma_f32_32x32x16_bf16 v[208:223], v[132:135], v[80:83], v[208:223]
    s_lshl_b32 s69, s72, 10
    s_add_u32 s69, s69, s11
    s_add_u32 s72, s72, 1
    s_cmp_eq_u32 s72, 28
    s_cselect_b32 s72, 0, s72
    s_add_u32 s14, s69, 0
    buffer_load_dwordx4 v[72:75], v9, s[56:59], s14 offen sc1
    v_mfma_f32_32x32x16_bf16 v[240:255], v[132:135], v[84:87], v[240:255]
    s_add_u32 s14, s69, 114688
    buffer_load_dwordx4 v[76:79], v9, s[56:59], s14 offen sc1
    s_waitcnt vmcnt(14) lgkmcnt(4)
    v_mfma_f32_32x32x16_bf16 v[192:207], v[136:139], v[88:91], v[192:207]
    ds_read_b64_tr_b16 v[128:129], v10 offset:10240
    ds_read_b64_tr_b16 v[130:131], v10 offset:11264
    ds_read_b64_tr_b16 v[132:133], v11 offset:10240
    ds_read_b64_tr_b16 v[134:135], v11 offset:11264
    s_lshl_b32 s15, s70, 14
    s_add_u32 s15, s15, s12
    s_add_u32 s70, s70, 1
    s_cmp_eq_u32 s70, 28
    s_cselect_b32 s70, 0, s70
    s_add_u32 m0, s6, 4096
    s_add_u32 s14, s15, 0
    buffer_load_dwordx4 v8, s[40:43], s14 offen lds
    v_mfma_f32_32x32x16_bf16 v[224:239], v[136:139], v[92:95], v[224:239]
    s_add_u32 m0, s6, 5120
    s_add_u32 s14, s15, 8192
    buffer_load_dwordx4 v8, s[40:43], s14 offen lds
    v_mfma_f32_32x32x16_bf16 v[208:223], v[140:143], v[88:91], v[208:223]
    s_lshl_b32 s69, s72, 10
    s_add_u32 s69, s69, s11
    s_add_u32 s72, s72, 1
    s_cmp_eq_u32 s72, 28
    s_cselect_b32 s72, 0, s72
    s_add_u32 s14, s69, 0
    buffer_load_dwordx4 v[80:83], v9, s[56:59], s14 offen sc1
    v_mfma_f32_32x32x16_bf16 v[240:255], v[140:143], v[92:95], v[240:255]
    s_add_u32 s14, s69, 114688
    buffer_load_dwordx4 v[84:87], v9, s[56:59], s14 offen sc1
    s_waitcnt vmcnt(14) lgkmcnt(4)
    v_mfma_f32_32x32x16_bf16 v[192:207], v[144:147], v[96:99], v[192:207]
    ds_read_b64_tr_b16 v[136:137], v10 offset:12288
    ds_read_b64_tr_b16 v[138:139], v10 offset:13312
    ds_read_b64_tr_b16 v[140:141], v11 offset:12288
    ds_read_b64_tr_b16 v[142:143], v11 offset:13312
    s_lshl_b32 s15, s70, 14
    s_add_u32 s15, s15, s12
    s_add_u32 s70, s70, 1
    s_cmp_eq_u32 s70, 28
    s_cselect_b32 s70, 0, s70
    s_add_u32 m0, s6, 6144
    s_add_u32 s14, s15, 0
    buffer_load_dwordx4 v8, s[40:43], s14 offen lds
    v_mfma_f32_32x32x16_bf16 v[224:239], v[144:147], v[100:103], v[224:239]
    s_add_u32 m0, s6, 7168
    s_add_u32 s14, s15, 8192
    buffer_load_dwordx4 v8, s[40:43], s14 offen lds
    v_mfma_f32_32x32x16_bf16 v[208:223], v[148:151], v[96:99], v[208:223]
    s_lshl_b32 s69, s72, 10
    s_add_u32 s69, s69, s11
    s_add_u32 s72, s72, 1
    s_cmp_eq_u32 s72, 28
    s_cselect_b32 s72, 0, s72
    s_add_u32 s14, s69, 0
    buffer_load_dwordx4 v[88:91], v9, s[56:59], s14 offen sc1
    v_mfma_f32_32x32x16_bf16 v[240:255], v[148:151], v[100:103], v[240:255]
    s_add_u32 s14, s69, 114688
    buffer_load_dwordx4 v[92:95], v9, s[56:59], s14 offen sc1
    s_waitcnt vmcnt(14) lgkmcnt(4)
    v_mfma_f32_32x32x16_bf16 v[192:207], v[128:131], v[104:107], v[192:207]
    ds_read_b64_tr_b16 v[144:145], v10 offset:0
    ds_read_b64_tr_b16 v[146:147], v10 offset:1024
    ds_read_b64_tr_b16 v[148:149], v11 offset:0
    ds_read_b64_tr_b16 v[150:151], v11 offset:1024
    s_lshl_b32 s15, s70, 14
    s_add_u32 s15, s15, s12
    s_add_u32 s70, s70, 1
    s_cmp_eq_u32 s70, 28
    s_cselect_b32 s70, 0, s70
    s_add_u32 m0, s6, 8192
    s_add_u32 s14, s15, 0
    buffer_load_dwordx4 v8, s[40:43], s14 offen lds
    v_mfma_f32_32x32x16_bf16 v[224:239], v[128:131], v[108:111], v[224:239]
    s_add_u32 m0, s6, 9216
    s_add_u32 s14, s15, 8192
    buffer_load_dwordx4 v8, s[40:43], s14 offen lds
    v_mfma_f32_32x32x16_bf16 v[208:223], v[132:135], v[104:107], v[208:223]
    s_lshl_b32 s69, s72, 10
    s_add_u32 s69, s69, s11
    s_add_u32 s72, s72, 1
    s_cmp_eq_u32 s72, 28
    s_cselect_b32 s72, 0, s72
    s_add_u32 s14, s69, 0
    buffer_load_dwordx4 v[96:99], v9, s[56:59], s14 offen sc1
    v_mfma_f32_32x32x16_bf16 v[240:255], v[132:135], v[108:111], v[240:255]
    s_add_u32 s14, s69, 114688
    buffer_load_dwordx4 v[100:103], v9, s[56:59], s14 offen sc1
    s_waitcnt vmcnt(14) lgkmcnt(4)
    v_mfma_f32_32x32x16_bf16 v[192:207], v[136:139], v[112:115], v[192:207]
    ds_read_b64_tr_b16 v[128:129], v10 offset:2048
    ds_read_b64_tr_b16 v[130:131], v10 offset:3072
    ds_read_b64_tr_b16 v[132:133], v11 offset:2048
    ds_read_b64_tr_b16 v[134:135], v11 offset:3072
    s_lshl_b32 s15, s70, 14
    s_add_u32 s15, s15, s12
    s_add_u32 s70, s70, 1
    s_cmp_eq_u32 s70, 28
    s_cselect_b32 s70, 0, s70
    s_add_u32 m0, s6, 10240
    s_add_u32 s14, s15, 0
    buffer_load_dwordx4 v8, s[40:43], s14 offen lds
    v_mfma_f32_32x32x16_bf16 v[224:239], v[136:139], v[116:119], v[224:239]
    s_add_u32 m0, s6, 11264
    s_add_u32 s14, s15, 8192
    buffer_load_dwordx4 v8, s[40:43], s14 offen lds
    v_mfma_f32_32x32x16_bf16 v[208:223], v[140:143], v[112:115], v[208:223]
    s_lshl_b32 s69, s72, 10
    s_add_u32 s69, s69, s11
    s_add_u32 s72, s72, 1
    s_cmp_eq_u32 s72, 28
    s_cselect_b32 s72, 0, s72
    s_add_u32 s14, s69, 0
    buffer_load_dwordx4 v[104:107], v9, s[56:59], s14 offen sc1
    v_mfma_f32_32x32x16_bf16 v[240:255], v[140:143], v[116:119], v[240:255]
    s_add_u32 s14, s69, 114688
    buffer_load_dwordx4 v[108:111], v9, s[56:59], s14 offen sc1
    s_waitcnt vmcnt(14) lgkmcnt(4)
    v_mfma_f32_32x32x16_bf16 v[192:207], v[144:147], v[64:67], v[192:207]
    ds_read_b64_tr_b16 v[136:137], v10 offset:4096
    ds_read_b64_tr_b16 v[138:139], v10 offset:5120
    ds_read_b64_tr_b16 v[140:141], v11 offset:4096
    ds_read_b64_tr_b16 v[142:143], v11 offset:5120
    s_lshl_b32 s15, s70, 14
    s_add_u32 s15, s15, s12
    s_add_u32 s70, s70, 1
    s_cmp_eq_u32 s70, 28
    s_cselect_b32 s70, 0, s70
    s_add_u32 m0, s6, 12288
    s_add_u32 s14, s15, 0
    buffer_load_dwordx4 v8, s[40:43], s14 offen lds
    v_mfma_f32_32x32x16_bf16 v[224:239], v[144:147], v[68:71], v[224:239]
    s_add_u32 m0, s6, 13312
    s_add_u32 s14, s15, 8192
    buffer_load_dwordx4 v8, s[40:43], s14 offen lds
    v_mfma_f32_32x32x16_bf16 v[208:223], v[148:151], v[64:67], v[208:223]
    s_lshl_b32 s69, s72, 10
    s_add_u32 s69, s69, s11
    s_add_u32 s72, s72, 1
    s_cmp_eq_u32 s72, 28
    s_cselect_b32 s72, 0, s72
    s_add_u32 s14, s69, 0
    buffer_load_dwordx4 v[112:115], v9, s[56:59], s14 offen sc1
    v_mfma_f32_32x32x16_bf16 v[240:255], v[148:151], v[68:71], v[240:255]
    s_add_u32 s14, s69, 114688
    buffer_load_dwordx4 v[116:119], v9, s[56:59], s14 offen sc1
    s_waitcnt vmcnt(14) lgkmcnt(4)
    v_mfma_f32_32x32x16_bf16 v[192:207], v[128:131], v[72:75], v[192:207]
    ds_read_b64_tr_b16 v[144:145], v10 offset:6144
    ds_read_b64_tr_b16 v[146:147], v10 offset:7168
    ds_read_b64_tr_b16 v[148:149], v11 offset:6144
    ds_read_b64_tr_b16 v[150:151], v11 offset:7168
    s_lshl_b32 s15, s70, 14
    s_add_u32 s15, s15, s12
    s_add_u32 s70, s70, 1
    s_cmp_eq_u32 s70, 28
    s_cselect_b32 s70, 0, s70
    s_add_u32 m0, s6, 0
    s_add_u32 s14, s15, 0
    buffer_load_dwordx4 v8, s[40:43], s14 offen lds
    v_mfma_f32_32x32x16_bf16 v[224:239], v[128:131], v[76:79], v[224:239]
    s_add_u32 m0, s6, 1024
    s_add_u32 s14, s15, 8192
    buffer_load_dwordx4 v8, s[40:43], s14 offen lds
    v_mfma_f32_32x32x16_bf16 v[208:223], v[132:135], v[72:75], v[208:223]
    s_lshl_b32 s69, s72, 10
    s_add_u32 s69, s69, s11
    s_add_u32 s72, s72, 1
    s_cmp_eq_u32 s72, 28
    s_cselect_b32 s72, 0, s72
    s_add_u32 s14, s69, 0
    buffer_load_dwordx4 v[64:67], v9, s[56:59], s14 offen sc1
    v_mfma_f32_32x32x16_bf16 v[240:255], v[132:135], v[76:79], v[240:255]
    s_add_u32 s14, s69, 114688
    buffer_load_dwordx4 v[68:71], v9, s[56:59], s14 offen sc1
    s_waitcnt vmcnt(14) lgkmcnt(4)
    v_mfma_f32_32x32x16_bf16 v[192:207], v[136:139], v[80:83], v[192:207]
    ds_read_b64_tr_b16 v[128:129], v10 offset:8192
    ds_read_b64_tr_b16 v[130:131], v10 offset:9216
    ds_read_b64_tr_b16 v[132:133], v11 offset:8192
    ds_read_b64_tr_b16 v[134:135], v11 offset:9216
    s_lshl_b32 s15, s70, 14
    s_add_u32 s15, s15, s12
    s_add_u32 s70, s70, 1
    s_cmp_eq_u32 s70, 28
    s_cselect_b32 s70, 0, s70
    s_add_u32 m0, s6, 2048
    s_add_u32 s14, s15, 0
    buffer_load_dwordx4 v8, s[40:43], s14 offen lds
    v_mfma_f32_32x32x16_bf16 v[224:239], v[136:139], v[84:87], v[224:239]
    s_add_u32 m0, s6, 3072
    s_add_u32 s14, s15, 8192
    buffer_load_dwordx4 v8, s[40:43], s14 offen lds
    v_mfma_f32_32x32x16_bf16 v[208:223], v[140:143], v[80:83], v[208:223]
    s_lshl_b32 s69, s72, 10
    s_add_u32 s69, s69, s11
    s_add_u32 s72, s72, 1
    s_cmp_eq_u32 s72, 28
    s_cselect_b32 s72, 0, s72
    s_add_u32 s14, s69, 0
    buffer_load_dwordx4 v[72:75], v9, s[56:59], s14 offen sc1
    v_mfma_f32_32x32x16_bf16 v[240:255], v[140:143], v[84:87], v[240:255]
    s_add_u32 s14, s69, 114688
    buffer_load_dwordx4 v[76:79], v9, s[56:59], s14 offen sc1
    s_waitcnt vmcnt(14) lgkmcnt(4)
    v_mfma_f32_32x32x16_bf16 v[192:207], v[144:147], v[88:91], v[192:207]
    ds_read_b64_tr_b16 v[136:137], v10 offset:10240
    ds_read_b64_tr_b16 v[138:139], v10 offset:11264
    ds_read_b64_tr_b16 v[140:141], v11 offset:10240
    ds_read_b64_tr_b16 v[142:143], v11 offset:11264
    s_lshl_b32 s15, s70, 14
    s_add_u32 s15, s15, s12
    s_add_u32 s70, s70, 1
    s_cmp_eq_u32 s70, 28
    s_cselect_b32 s70, 0, s70
    s_add_u32 m0, s6, 4096
    s_add_u32 s14, s15, 0
    buffer_load_dwordx4 v8, s[40:43], s14 offen lds
    v_mfma_f32_32x32x16_bf16 v[224:239], v[144:147], v[92:95], v[224:239]
    s_add_u32 m0, s6, 5120
    s_add_u32 s14, s15, 8192
    buffer_load_dwordx4 v8, s[40:43], s14 offen lds
    v_mfma_f32_32x32x16_bf16 v[208:223], v[148:151], v[88:91], v[208:223]
    s_lshl_b32 s69, s72, 10
    s_add_u32 s69, s69, s11
    s_add_u32 s72, s72, 1
    s_cmp_eq_u32 s72, 28
    s_cselect_b32 s72, 0, s72
    s_add_u32 s14, s69, 0
    buffer_load_dwordx4 v[80:83], v9, s[56:59], s14 offen sc1
    v_mfma_f32_32x32x16_bf16 v[240:255], v[148:151], v[92:95], v[240:255]
    s_add_u32 s14, s69, 114688
    buffer_load_dwordx4 v[84:87], v9, s[56:59], s14 offen sc1
    s_waitcnt vmcnt(14) lgkmcnt(4)
    v_mfma_f32_32x32x16_bf16 v[192:207], v[128:131], v[96:99], v[192:207]
    ds_read_b64_tr_b16 v[144:145], v10 offset:12288
    ds_read_b64_tr_b16 v[146:147], v10 offset:13312
    ds_read_b64_tr_b16 v[148:149], v11 offset:12288
    ds_read_b64_tr_b16 v[150:151], v11 offset:13312
    s_lshl_b32 s15, s70, 14
    s_add_u32 s15, s15, s12
    s_add_u32 s70, s70, 1
    s_cmp_eq_u32 s70, 28
    s_cselect_b32 s70, 0, s70
    s_add_u32 m0, s6, 6144
    s_add_u32 s14, s15, 0
    buffer_load_dwordx4 v8, s[40:43], s14 offen lds
    v_mfma_f32_32x32x16_bf16 v[224:239], v[128:131], v[100:103], v[224:239]
    s_add_u32 m0, s6, 7168
    s_add_u32 s14, s15, 8192
    buffer_load_dwordx4 v8, s[40:43], s14 offen lds
    v_mfma_f32_32x32x16_bf16 v[208:223], v[132:135], v[96:99], v[208:223]
    s_lshl_b32 s69, s72, 10
    s_add_u32 s69, s69, s11
    s_add_u32 s72, s72, 1
    s_cmp_eq_u32 s72, 28
    s_cselect_b32 s72, 0, s72
    s_add_u32 s14, s69, 0
    buffer_load_dwordx4 v[88:91], v9, s[56:59], s14 offen sc1
    v_mfma_f32_32x32x16_bf16 v[240:255], v[132:135], v[100:103], v[240:255]
    s_add_u32 s14, s69, 114688
    buffer_load_dwordx4 v[92:95], v9, s[56:59], s14 offen sc1
    s_waitcnt vmcnt(14) lgkmcnt(4)
    v_mfma_f32_32x32x16_bf16 v[192:207], v[136:139], v[104:107], v[192:207]
    ds_read_b64_tr_b16 v[128:129], v10 offset:0
    ds_read_b64_tr_b16 v[130:131], v10 offset:1024
    ds_read_b64_tr_b16 v[132:133], v11 offset:0
    ds_read_b64_tr_b16 v[134:135], v11 offset:1024
    s_lshl_b32 s15, s70, 14
    s_add_u32 s15, s15, s12
    s_add_u32 s70, s70, 1
    s_cmp_eq_u32 s70, 28
    s_cselect_b32 s70, 0, s70
    s_add_u32 m0, s6, 8192
    s_add_u32 s14, s15, 0
    buffer_load_dwordx4 v8, s[40:43], s14 offen lds
    v_mfma_f32_32x32x16_bf16 v[224:239], v[136:139], v[108:111], v[224:239]
    s_add_u32 m0, s6, 9216
    s_add_u32 s14, s15, 8192
    buffer_load_dwordx4 v8, s[40:43], s14 offen lds
    v_mfma_f32_32x32x16_bf16 v[208:223], v[140:143], v[104:107], v[208:223]
    s_lshl_b32 s69, s72, 10
    s_add_u32 s69, s69, s11
    s_add_u32 s72, s72, 1
    s_cmp_eq_u32 s72, 28
    s_cselect_b32 s72, 0, s72
    s_add_u32 s14, s69, 0
    buffer_load_dwordx4 v[96:99], v9, s[56:59], s14 offen sc1
    v_mfma_f32_32x32x16_bf16 v[240:255], v[140:143], v[108:111], v[240:255]
    s_add_u32 s14, s69, 114688
    buffer_load_dwordx4 v[100:103], v9, s[56:59], s14 offen sc1
    s_waitcnt vmcnt(14) lgkmcnt(4)
    v_mfma_f32_32x32x16_bf16 v[192:207], v[144:147], v[112:115], v[192:207]
    ds_read_b64_tr_b16 v[136:137], v10 offset:2048
    ds_read_b64_tr_b16 v[138:139], v10 offset:3072
    ds_read_b64_tr_b16 v[140:141], v11 offset:2048
    ds_read_b64_tr_b16 v[142:143], v11 offset:3072
    s_lshl_b32 s15, s70, 14
    s_add_u32 s15, s15, s12
    s_add_u32 s70, s70, 1
    s_cmp_eq_u32 s70, 28
    s_cselect_b32 s70, 0, s70
    s_add_u32 m0, s6, 10240
    s_add_u32 s14, s15, 0
    buffer_load_dwordx4 v8, s[40:43], s14 offen lds
    v_mfma_f32_32x32x16_bf16 v[224:239], v[144:147], v[116:119], v[224:239]
    s_add_u32 m0, s6, 11264
    s_add_u32 s14, s15, 8192
    buffer_load_dwordx4 v8, s[40:43], s14 offen lds
    v_mfma_f32_32x32x16_bf16 v[208:223], v[148:151], v[112:115], v[208:223]
    s_lshl_b32 s69, s72, 10
    s_add_u32 s69, s69, s11
    s_add_u32 s72, s72, 1
    s_cmp_eq_u32 s72, 28
    s_cselect_b32 s72, 0, s72
    s_add_u32 s14, s69, 0
    buffer_load_dwordx4 v[104:107], v9, s[56:59], s14 offen sc1
    v_mfma_f32_32x32x16_bf16 v[240:255], v[148:151], v[116:119], v[240:255]
    s_add_u32 s14, s69, 114688
    buffer_load_dwordx4 v[108:111], v9, s[56:59], s14 offen sc1
    s_waitcnt vmcnt(14) lgkmcnt(4)
    v_mfma_f32_32x32x16_bf16 v[192:207], v[128:131], v[64:67], v[192:207]
    ds_read_b64_tr_b16 v[144:145], v10 offset:4096
    ds_read_b64_tr_b16 v[146:147], v10 offset:5120
    ds_read_b64_tr_b16 v[148:149], v11 offset:4096
    ds_read_b64_tr_b16 v[150:151], v11 offset:5120
    s_lshl_b32 s15, s70, 14
    s_add_u32 s15, s15, s12
    s_add_u32 s70, s70, 1
    s_cmp_eq_u32 s70, 28
    s_cselect_b32 s70, 0, s70
    s_add_u32 m0, s6, 12288
    s_add_u32 s14, s15, 0
    buffer_load_dwordx4 v8, s[40:43], s14 offen lds
    v_mfma_f32_32x32x16_bf16 v[224:239], v[128:131], v[68:71], v[224:239]
    s_add_u32 m0, s6, 13312
    s_add_u32 s14, s15, 8192
    buffer_load_dwordx4 v8, s[40:43], s14 offen lds
    v_mfma_f32_32x32x16_bf16 v[208:223], v[132:135], v[64:67], v[208:223]
    s_lshl_b32 s69, s72, 10
    s_add_u32 s69, s69, s11
    s_add_u32 s72, s72, 1
    s_cmp_eq_u32 s72, 28
    s_cselect_b32 s72, 0, s72
    s_add_u32 s14, s69, 0
    buffer_load_dwordx4 v[112:115], v9, s[56:59], s14 offen sc1
    v_mfma_f32_32x32x16_bf16 v[240:255], v[132:135], v[68:71], v[240:255]
    s_add_u32 s14, s69, 114688
    buffer_load_dwordx4 v[116:119], v9, s[56:59], s14 offen sc1
    s_waitcnt vmcnt(14) lgkmcnt(4)
    v_mfma_f32_32x32x16_bf16 v[192:207], v[136:139], v[72:75], v[192:207]
    ds_read_b64_tr_b16 v[128:129], v10 offset:6144
    ds_read_b64_tr_b16 v[130:131], v10 offset:7168
    ds_read_b64_tr_b16 v[132:133], v11 offset:6144
    ds_read_b64_tr_b16 v[134:135], v11 offset:7168
    v_mfma_f32_32x32x16_bf16 v[224:239], v[136:139], v[76:79], v[224:239]
    v_mfma_f32_32x32x16_bf16 v[208:223], v[140:143], v[72:75], v[208:223]
    v_mfma_f32_32x32x16_bf16 v[240:255], v[140:143], v[76:79], v[240:255]
    s_waitcnt vmcnt(10) lgkmcnt(4)
    v_mfma_f32_32x32x16_bf16 v[192:207], v[144:147], v[80:83], v[192:207]
    ds_read_b64_tr_b16 v[136:137], v10 offset:8192
    ds_read_b64_tr_b16 v[138:139], v10 offset:9216
    ds_read_b64_tr_b16 v[140:141], v11 offset:8192
    ds_read_b64_tr_b16 v[142:143], v11 offset:9216
    v_mfma_f32_32x32x16_bf16 v[224:239], v[144:147], v[84:87], v[224:239]
    v_mfma_f32_32x32x16_bf16 v[208:223], v[148:151], v[80:83], v[208:223]
    v_mfma_f32_32x32x16_bf16 v[240:255], v[148:151], v[84:87], v[240:255]
    s_waitcnt vmcnt(6) lgkmcnt(4)
    v_mfma_f32_32x32x16_bf16 v[192:207], v[128:131], v[88:91], v[192:207]
    ds_read_b64_tr_b16 v[144:145], v10 offset:10240
    ds_read_b64_tr_b16 v[146:147], v10 offset:11264
    ds_read_b64_tr_b16 v[148:149], v11 offset:10240
    ds_read_b64_tr_b16 v[150:151], v11 offset:11264
    v_mfma_f32_32x32x16_bf16 v[224:239], v[128:131], v[92:95], v[224:239]
    v_mfma_f32_32x32x16_bf16 v[208:223], v[132:135], v[88:91], v[208:223]
    v_mfma_f32_32x32x16_bf16 v[240:255], v[132:135], v[92:95], v[240:255]
    s_waitcnt vmcnt(2) lgkmcnt(4)
    v_mfma_f32_32x32x16_bf16 v[192:207], v[136:139], v[96:99], v[192:207]
    ds_read_b64_tr_b16 v[128:129], v10 offset:12288
    ds_read_b64_tr_b16 v[130:131], v10 offset:13312
    ds_read_b64_tr_b16 v[132:133], v11 offset:12288
    ds_read_b64_tr_b16 v[134:135], v11 offset:13312
    v_mfma_f32_32x32x16_bf16 v[224:239], v[136:139], v[100:103], v[224:239]
    v_mfma_f32_32x32x16_bf16 v[208:223], v[140:143], v[96:99], v[208:223]
    v_mfma_f32_32x32x16_bf16 v[240:255], v[140:143], v[100:103], v[240:255]
    s_waitcnt vmcnt(4) lgkmcnt(4)
    v_mfma_f32_32x32x16_bf16 v[192:207], v[144:147], v[104:107], v[192:207]
    v_mfma_f32_32x32x16_bf16 v[224:239], v[144:147], v[108:111], v[224:239]
    v_mfma_f32_32x32x16_bf16 v[208:223], v[148:151], v[104:107], v[208:223]
    v_mfma_f32_32x32x16_bf16 v[240:255], v[148:151], v[108:111], v[240:255]
    s_waitcnt vmcnt(0) lgkmcnt(0)
    v_mfma_f32_32x32x16_bf16 v[192:207], v[128:131], v[112:115], v[192:207]
    v_mfma_f32_32x32x16_bf16 v[224:239], v[128:131], v[116:119], v[224:239]
    v_mfma_f32_32x32x16_bf16 v[208:223], v[132:135], v[112:115], v[208:223]
    v_mfma_f32_32x32x16_bf16 v[240:255], v[132:135], v[116:119], v[240:255]
    s_barrier
    v_add_u32 v13, s6, v9
    s_nop 7
    s_nop 7
    s_cmp_eq_u32 s3, 0
    s_cbranch_scc1 F_own_39
    ds_write_b128 v13, v[192:195] offset:0
    ds_write_b128 v13, v[196:199] offset:1024
    ds_write_b128 v13, v[200:203] offset:2048
    ds_write_b128 v13, v[204:207] offset:3072
F_own_39:
    s_cmp_eq_u32 s3, 1
    s_cbranch_scc1 F_own_40
    ds_write_b128 v13, v[224:227] offset:4096
    ds_write_b128 v13, v[228:231] offset:5120
    ds_write_b128 v13, v[232:235] offset:6144
    ds_write_b128 v13, v[236:239] offset:7168
F_own_40:
    s_cmp_eq_u32 s3, 2
    s_cbranch_scc1 F_own_41
    ds_write_b128 v13, v[208:211] offset:8192
    ds_write_b128 v13, v[212:215] offset:9216
    ds_write_b128 v13, v[216:219] offset:10240
    ds_write_b128 v13, v[220:223] offset:11264
F_own_41:
    s_cmp_eq_u32 s3, 3
    s_cbranch_scc1 F_own_42
    ds_write_b128 v13, v[240:243] offset:12288
    ds_write_b128 v13, v[244:247] offset:13312
    ds_write_b128 v13, v[248:251] offset:14336
    ds_write_b128 v13, v[252:255] offset:15360
F_own_42:
    s_cmp_lg_u32 s3, 0
    s_cbranch_scc1 F_mv_43
    v_mov_b32 v24, v192
    v_mov_b32 v25, v193
    v_mov_b32 v26, v194
    v_mov_b32 v27, v195
    v_mov_b32 v28, v196
    v_mov_b32 v29, v197
    v_mov_b32 v30, v198
    v_mov_b32 v31, v199
    v_mov_b32 v32, v200
    v_mov_b32 v33, v201
    v_mov_b32 v34, v202
    v_mov_b32 v35, v203
    v_mov_b32 v36, v204
    v_mov_b32 v37, v205
    v_mov_b32 v38, v206
    v_mov_b32 v39, v207
    s_branch F_mvd_47
F_mv_43:
    s_cmp_lg_u32 s3, 1
    s_cbranch_scc1 F_mv_44
    v_mov_b32 v24, v224
    v_mov_b32 v25, v225
    v_mov_b32 v26, v226
    v_mov_b32 v27, v227
    v_mov_b32 v28, v228
    v_mov_b32 v29, v229
    v_mov_b32 v30, v230
    v_mov_b32 v31, v231
    v_mov_b32 v32, v232
    v_mov_b32 v33, v233
    v_mov_b32 v34, v234
    v_mov_b32 v35, v235
    v_mov_b32 v36, v236
    v_mov_b32 v37, v237
    v_mov_b32 v38, v238
    v_mov_b32 v39, v239
    s_branch F_mvd_47
F_mv_44:
    s_cmp_lg_u32 s3, 2
    s_cbranch_scc1 F_mv_45
    v_mov_b32 v24, v208
    v_mov_b32 v25, v209
    v_mov_b32 v26, v210
    v_mov_b32 v27, v211
    v_mov_b32 v28, v212
    v_mov_b32 v29, v213
    v_mov_b32 v30, v214
    v_mov_b32 v31, v215
    v_mov_b32 v32, v216
    v_mov_b32 v33, v217
    v_mov_b32 v34, v218
    v_mov_b32 v35, v219
    v_mov_b32 v36, v220
    v_mov_b32 v37, v221
    v_mov_b32 v38, v222
    v_mov_b32 v39, v223
    s_branch F_mvd_47
F_mv_45:
    s_cmp_lg_u32 s3, 3
    s_cbranch_scc1 F_mv_46
    v_mov_b32 v24, v240
    v_mov_b32 v25, v241
    v_mov_b32 v26, v242
    v_mov_b32 v27, v243
    v_mov_b32 v28, v244
    v_mov_b32 v29, v245
    v_mov_b32 v30, v246
    v_mov_b32 v31, v247
    v_mov_b32 v32, v248
    v_mov_b32 v33, v249
    v_mov_b32 v34, v250
    v_mov_b32 v35, v251
    v_mov_b32 v36, v252
    v_mov_b32 v37, v253
    v_mov_b32 v38, v254
    v_mov_b32 v39, v255
    s_branch F_mvd_47
F_mv_46:
F_mvd_47:
    v_lshlrev_b32 v40, 16, v16
    v_and_b32 v41, 0xffff0000, v16
    v_add_f32 v24, v24, v40
    v_add_f32 v25, v25, v41
    v_lshlrev_b32 v40, 16, v17
    v_and_b32 v41, 0xffff0000, v17
    v_add_f32 v26, v26, v40
    v_add_f32 v27, v27, v41
    v_lshlrev_b32 v40, 16, v18
    v_and_b32 v41, 0xffff0000, v18
    v_add_f32 v28, v28, v40
    v_add_f32 v29, v29, v41
    v_lshlrev_b32 v40, 16, v19
    v_and_b32 v41, 0xffff0000, v19
    v_add_f32 v30, v30, v40
    v_add_f32 v31, v31, v41
    v_lshlrev_b32 v40, 16, v20
    v_and_b32 v41, 0xffff0000, v20
    v_add_f32 v32, v32, v40
    v_add_f32 v33, v33, v41
    v_lshlrev_b32 v40, 16, v21
    v_and_b32 v41, 0xffff0000, v21
    v_add_f32 v34, v34, v40
    v_add_f32 v35, v35, v41
    v_lshlrev_b32 v40, 16, v22
    v_and_b32 v41, 0xffff0000, v22
    v_add_f32 v36, v36, v40
    v_add_f32 v37, v37, v41
    v_lshlrev_b32 v40, 16, v23
    v_and_b32 v41, 0xffff0000, v23
    v_add_f32 v38, v38, v40
    v_add_f32 v39, v39, v41
    s_lshl_b32 s14, s3, 12
    v_add_u32 v13, s14, v9
    s_waitcnt lgkmcnt(0)
    s_barrier
    s_add_u32 s15, s3, 1
    s_and_b32 s15, s15, 3
    s_lshl_b32 s15, s15, 14
    v_add_u32 v14, s15, v13
    ds_read_b128 v[64:67], v14 offset:0
    ds_read_b128 v[68:71], v14 offset:1024
    ds_read_b128 v[72:75], v14 offset:2048
    ds_read_b128 v[76:79], v14 offset:3072
    s_add_u32 s15, s3, 2
    s_and_b32 s15, s15, 3
    s_lshl_b32 s15, s15, 14
    v_add_u32 v14, s15, v13
    ds_read_b128 v[80:83], v14 offset:0
    ds_read_b128 v[84:87], v14 offset:1024
    ds_read_b128 v[88:91], v14 offset:2048
    ds_read_b128 v[92:95], v14 offset:3072
    s_add_u32 s15, s3, 3
    s_and_b32 s15, s15, 3
    s_lshl_b32 s15, s15, 14
    v_add_u32 v14, s15, v13
    ds_read_b128 v[96:99], v14 offset:0
    ds_read_b128 v[100:103], v14 offset:1024
    ds_read_b128 v[104:107], v14 offset:2048
    ds_read_b128 v[108:111], v14 offset:3072
    s_waitcnt lgkmcnt(8)
    v_add_f32 v24, v24, v64
    v_add_f32 v25, v25, v65
    v_add_f32 v26, v26, v66
    v_add_f32 v27, v27, v67
    v_add_f32 v28, v28, v68
    v_add_f32 v29, v29, v69
    v_add_f32 v30, v30, v70
    v_add_f32 v31, v31, v71
    v_add_f32 v32, v32, v72
    v_add_f32 v33, v33, v73
    v_add_f32 v34, v34, v74
    v_add_f32 v35, v35, v75
    v_add_f32 v36, v36, v76
    v_add_f32 v37, v37, v77
    v_add_f32 v38, v38, v78
    v_add_f32 v39, v39, v79
    s_waitcnt lgkmcnt(4)
    v_add_f32 v24, v24, v80
    v_add_f32 v25, v25, v81
    v_add_f32 v26, v26, v82
    v_add_f32 v27, v27, v83
    v_add_f32 v28, v28, v84
    v_add_f32 v29, v29, v85
    v_add_f32 v30, v30, v86
    v_add_f32 v31, v31, v87
    v_add_f32 v32, v32, v88
    v_add_f32 v33, v33, v89
    v_add_f32 v34, v34, v90
    v_add_f32 v35, v35, v91
    v_add_f32 v36, v36, v92
    v_add_f32 v37, v37, v93
    v_add_f32 v38, v38, v94
    v_add_f32 v39, v39, v95
    s_waitcnt lgkmcnt(0)
    v_add_f32 v24, v24, v96
    v_add_f32 v25, v25, v97
    v_add_f32 v26, v26, v98
    v_add_f32 v27, v27, v99
    v_add_f32 v28, v28, v100
    v_add_f32 v29, v29, v101
    v_add_f32 v30, v30, v102
    v_add_f32 v31, v31, v103
    v_add_f32 v32, v32, v104
    v_add_f32 v33, v33, v105
    v_add_f32 v34, v34, v106
    v_add_f32 v35, v35, v107
    v_add_f32 v36, v36, v108
    v_add_f32 v37, v37, v109
    v_add_f32 v38, v38, v110
    v_add_f32 v39, v39, v111
    s_barrier
    s_lshl_b32 s12, s3, 17
    s_add_u32 s12, s12, s13
    s_add_u32 m0, s6, 0
    s_add_u32 s14, s12, 0
    buffer_load_dwordx4 v8, s[44:47], s14 offen lds
    s_add_u32 m0, s6, 1024
    s_add_u32 s14, s12, 8192
    buffer_load_dwordx4 v8, s[44:47], s14 offen lds
    s_add_u32 m0, s6, 2048
    s_add_u32 s14, s12, 16384
    buffer_load_dwordx4 v8, s[44:47], s14 offen lds
    s_add_u32 m0, s6, 3072
    s_add_u32 s14, s12, 24576
    buffer_load_dwordx4 v8, s[44:47], s14 offen lds
    s_add_u32 m0, s6, 4096
    s_add_u32 s14, s12, 32768
    buffer_load_dwordx4 v8, s[44:47], s14 offen lds
    s_add_u32 m0, s6, 5120
    s_add_u32 s14, s12, 40960
    buffer_load_dwordx4 v8, s[44:47], s14 offen lds
    s_add_u32 m0, s6, 6144
    s_add_u32 s14, s12, 49152
    buffer_load_dwordx4 v8, s[44:47], s14 offen lds
    s_add_u32 m0, s6, 7168
    s_add_u32 s14, s12, 57344
    buffer_load_dwordx4 v8, s[44:47], s14 offen lds
    s_add_u32 m0, s6, 8192
    s_add_u32 s14, s12, 65536
    buffer_load_dwordx4 v8, s[44:47], s14 offen lds
    s_add_u32 m0, s6, 9216
    s_add_u32 s14, s12, 73728
    buffer_load_dwordx4 v8, s[44:47], s14 offen lds
    s_add_u32 m0, s6, 10240
    s_add_u32 s14, s12, 81920
    buffer_load_dwordx4 v8, s[44:47], s14 offen lds
    s_add_u32 m0, s6, 11264
    s_add_u32 s14, s12, 90112
    buffer_load_dwordx4 v8, s[44:47], s14 offen lds
    s_add_u32 m0, s6, 12288
    s_add_u32 s14, s12, 98304
    buffer_load_dwordx4 v8, s[44:47], s14 offen lds
    s_add_u32 m0, s6, 13312
    s_add_u32 s14, s12, 106496
    buffer_load_dwordx4 v8, s[44:47], s14 offen lds
    s_add_u32 m0, s6, 14336
    s_add_u32 s14, s12, 114688
    buffer_load_dwordx4 v8, s[44:47], s14 offen lds
    s_add_u32 m0, s6, 15360
    s_add_u32 s14, s12, 122880
    buffer_load_dwordx4 v8, s[44:47], s14 offen lds
    v_subrev_u32 v14, s6, v10
    s_lshr_b32 s14, s3, 1
    s_lshl_b32 s14, s14, 15
    v_add_u32 v14, s14, v14
    v_xor_b32 v15, 64, v14
    v_mov_b32 v192, 0
    v_mov_b32 v193, 0
    v_mov_b32 v194, 0
    v_mov_b32 v195, 0
    v_mov_b32 v196, 0
    v_mov_b32 v197, 0
    v_mov_b32 v198, 0
    v_mov_b32 v199, 0
    v_mov_b32 v200, 0
    v_mov_b32 v201, 0
    v_mov_b32 v202, 0
    v_mov_b32 v203, 0
    v_mov_b32 v204, 0
    v_mov_b32 v205, 0
    v_mov_b32 v206, 0
    v_mov_b32 v207, 0
    v_mov_b32 v208, 0
    v_mov_b32 v209, 0
    v_mov_b32 v210, 0
    v_mov_b32 v211, 0
    v_mov_b32 v212, 0
    v_mov_b32 v213, 0
    v_mov_b32 v214, 0
    v_mov_b32 v215, 0
    v_mov_b32 v216, 0
    v_mov_b32 v217, 0
    v_mov_b32 v218, 0
    v_mov_b32 v219, 0
    v_mov_b32 v220, 0
    v_mov_b32 v221, 0
    v_mov_b32 v222, 0
    v_mov_b32 v223, 0
    s_waitcnt vmcnt(0)
    s_barrier
    ds_read_b64_tr_b16 v[128:129], v14 offset:0
    ds_read_b64_tr_b16 v[130:131], v14 offset:1024
    ds_read_b64_tr_b16 v[132:133], v15 offset:0
    ds_read_b64_tr_b16 v[134:135], v15 offset:1024
    ds_read_b64_tr_b16 v[136:137], v14 offset:2048
    ds_read_b64_tr_b16 v[138:139], v14 offset:3072
    ds_read_b64_tr_b16 v[140:141], v15 offset:2048
    ds_read_b64_tr_b16 v[142:143], v15 offset:3072
    s_waitcnt lgkmcnt(0)
    ds_read_b64_tr_b16 v[144:145], v14 offset:4096
    ds_read_b64_tr_b16 v[146:147], v14 offset:5120
    ds_read_b64_tr_b16 v[148:149], v15 offset:4096
    ds_read_b64_tr_b16 v[150:151], v15 offset:5120
    ds_read_b64_tr_b16 v[152:153], v14 offset:6144
    ds_read_b64_tr_b16 v[154:155], v14 offset:7168
    ds_read_b64_tr_b16 v[156:157], v15 offset:6144
    ds_read_b64_tr_b16 v[158:159], v15 offset:7168
    s_waitcnt lgkmcnt(0)
    ds_read_b64_tr_b16 v[160:161], v14 offset:8192
    ds_read_b64_tr_b16 v[162:163], v14 offset:9216
    ds_read_b64_tr_b16 v[164:165], v15 offset:8192
    ds_read_b64_tr_b16 v[166:167], v15 offset:9216
    ds_read_b64_tr_b16 v[168:169], v14 offset:10240
    ds_read_b64_tr_b16 v[170:171], v14 offset:11264
    ds_read_b64_tr_b16 v[172:173], v15 offset:10240
    ds_read_b64_tr_b16 v[174:175], v15 offset:11264
    s_waitcnt lgkmcnt(0)
    ds_read_b64_tr_b16 v[176:177], v14 offset:12288
    ds_read_b64_tr_b16 v[178:179], v14 offset:13312
    ds_read_b64_tr_b16 v[180:181], v15 offset:12288
    ds_read_b64_tr_b16 v[182:183], v15 offset:13312
    ds_read_b64_tr_b16 v[184:185], v14 offset:14336
    ds_read_b64_tr_b16 v[186:187], v14 offset:15360
    ds_read_b64_tr_b16 v[188:189], v15 offset:14336
    ds_read_b64_tr_b16 v[190:191], v15 offset:15360
    s_waitcnt lgkmcnt(0)
    ds_read_b64_tr_b16 v[224:225], v14 offset:16384
    ds_read_b64_tr_b16 v[226:227], v14 offset:17408
    ds_read_b64_tr_b16 v[228:229], v15 offset:16384
    ds_read_b64_tr_b16 v[230:231], v15 offset:17408
    ds_read_b64_tr_b16 v[232:233], v14 offset:18432
    ds_read_b64_tr_b16 v[234:235], v14 offset:19456
    ds_read_b64_tr_b16 v[236:237], v15 offset:18432
    ds_read_b64_tr_b16 v[238:239], v15 offset:19456
    ds_read_b64_tr_b16 v[240:241], v14 offset:20480
    ds_read_b64_tr_b16 v[242:243], v14 offset:21504
    ds_read_b64_tr_b16 v[244:245], v15 offset:20480
    ds_read_b64_tr_b16 v[246:247], v15 offset:21504
    ds_read_b64_tr_b16 v[248:249], v14 offset:22528
    ds_read_b64_tr_b16 v[250:251], v14 offset:23552
    ds_read_b64_tr_b16 v[252:253], v15 offset:22528
    ds_read_b64_tr_b16 v[254:255], v15 offset:23552
    s_cmp_lg_u32 s3, 0
    s_cbranch_scc1 WGW_48
    s_lshl_b32 s14, s4, 7
    s_add_u32 s14, s14, 208896
    v_lshlrev_b32 v2, 2, v1
    s_mov_b32 s75, 0
    s_mov_b32 exec_lo, 0xff
    s_mov_b32 exec_hi, 0x0
POLL_49:
    buffer_load_dword v3, v2, s[52:55], s14 offen sc0 sc1
    s_waitcnt vmcnt(0)
    v_cmp_ne_u32 vcc, s74, v3
    s_cbranch_vccz POLLD_50
    s_sleep 2
    s_add_u32 s75, s75, 1
    s_cmp_lt_u32 s75, 200000
    s_cbranch_scc1 POLL_49
POLLD_50:
    s_mov_b64 exec, -1
WGW_48:
    s_barrier
    s_setprio 3
    s_lshl_b32 s11, s4, 1
    s_and_b32 s14, s3, 1
    s_add_u32 s11, s11, s14
    s_lshl_b32 s11, s11, 15
    s_lshr_b32 s14, s3, 1
    s_lshl_b32 s14, s14, 14
    s_add_u32 s11, s11, s14
    s_add_u32 s14, s11, 0
    buffer_load_dwordx4 v[64:67], v9, s[60:63], s14 offen offset:0 sc1
    buffer_load_dwordx4 v[68:71], v9, s[60:63], s14 offen offset:1024 sc1
    buffer_load_dwordx4 v[72:75], v9, s[60:63], s14 offen offset:2048 sc1
    buffer_load_dwordx4 v[76:79], v9, s[60:63], s14 offen offset:3072 sc1
    s_add_u32 s14, s11, 4096
    buffer_load_dwordx4 v[80:83], v9, s[60:63], s14 offen offset:0 sc1
    buffer_load_dwordx4 v[84:87], v9, s[60:63], s14 offen offset:1024 sc1
    buffer_load_dwordx4 v[88:91], v9, s[60:63], s14 offen offset:2048 sc1
    buffer_load_dwordx4 v[92:95], v9, s[60:63], s14 offen offset:3072 sc1
    s_add_u32 s14, s11, 8192
    buffer_load_dwordx4 v[96:99], v9, s[60:63], s14 offen offset:0 sc1
    buffer_load_dwordx4 v[100:103], v9, s[60:63], s14 offen offset:1024 sc1
    buffer_load_dwordx4 v[104:107], v9, s[60:63], s14 offen offset:2048 sc1
    buffer_load_dwordx4 v[108:111], v9, s[60:63], s14 offen offset:3072 sc1
    s_add_u32 s14, s11, 12288
    buffer_load_dwordx4 v[112:115], v9, s[60:63], s14 offen offset:0 sc1
    buffer_load_dwordx4 v[116:119], v9, s[60:63], s14 offen offset:1024 sc1
    buffer_load_dwordx4 v[120:123], v9, s[60:63], s14 offen offset:2048 sc1
    buffer_load_dwordx4 v[124:127], v9, s[60:63], s14 offen offset:3072 sc1
    s_waitcnt vmcnt(15) lgkmcnt(0)
    v_mfma_f32_32x32x16_bf16 v[192:207], v[128:131], v[64:67], v[192:207]
    v_mfma_f32_32x32x16_bf16 v[208:223], v[132:135], v[64:67], v[208:223]
    s_waitcnt vmcnt(14)
    v_mfma_f32_32x32x16_bf16 v[192:207], v[136:139], v[68:71], v[192:207]
    v_mfma_f32_32x32x16_bf16 v[208:223], v[140:143], v[68:71], v[208:223]
    s_waitcnt vmcnt(13)
    v_mfma_f32_32x32x16_bf16 v[192:207], v[144:147], v[72:75], v[192:207]
    v_mfma_f32_32x32x16_bf16 v[208:223], v[148:151], v[72:75], v[208:223]
    s_waitcnt vmcnt(12)
    v_mfma_f32_32x32x16_bf16 v[192:207], v[152:155], v[76:79], v[192:207]
    v_mfma_f32_32x32x16_bf16 v[208:223], v[156:159], v[76:79], v[208:223]
    s_waitcnt vmcnt(11)
    v_mfma_f32_32x32x16_bf16 v[192:207], v[160:163], v[80:83], v[192:207]
    v_mfma_f32_32x32x16_bf16 v[208:223], v[164:167], v[80:83], v[208:223]
    s_waitcnt vmcnt(10)
    v_mfma_f32_32x32x16_bf16 v[192:207], v[168:171], v[84:87], v[192:207]
    v_mfma_f32_32x32x16_bf16 v[208:223], v[172:175], v[84:87], v[208:223]
    s_waitcnt vmcnt(9)
    v_mfma_f32_32x32x16_bf16 v[192:207], v[176:179], v[88:91], v[192:207]
    v_mfma_f32_32x32x16_bf16 v[208:223], v[180:183], v[88:91], v[208:223]
    s_waitcnt vmcnt(8)
    v_mfma_f32_32x32x16_bf16 v[192:207], v[184:187], v[92:95], v[192:207]
    v_mfma_f32_32x32x16_bf16 v[208:223], v[188:191], v[92:95], v[208:223]
    s_waitcnt vmcnt(7)
    v_mfma_f32_32x32x16_bf16 v[192:207], v[224:227], v[96:99], v[192:207]
    v_mfma_f32_32x32x16_bf16 v[208:223], v[228:231], v[96:99], v[208:223]
    ds_read_b64_tr_b16 v[224:225], v14 offset:24576
    ds_read_b64_tr_b16 v[226:227], v14 offset:25600
    ds_read_b64_tr_b16 v[228:229], v15 offset:24576
    ds_read_b64_tr_b16 v[230:231], v15 offset:25600
    s_waitcnt vmcnt(6)
    v_mfma_f32_32x32x16_bf16 v[192:207], v[232:235], v[100:103], v[192:207]
    v_mfma_f32_32x32x16_bf16 v[208:223], v[236:239], v[100:103], v[208:223]
    ds_read_b64_tr_b16 v[232:233], v14 offset:26624
    ds_read_b64_tr_b16 v[234:235], v14 offset:27648
    ds_read_b64_tr_b16 v[236:237], v15 offset:26624
    ds_read_b64_tr_b16 v[238:239], v15 offset:27648
    s_waitcnt vmcnt(5)
    v_mfma_f32_32x32x16_bf16 v[192:207], v[240:243], v[104:107], v[192:207]
    v_mfma_f32_32x32x16_bf16 v[208:223], v[244:247], v[104:107], v[208:223]
    ds_read_b64_tr_b16 v[240:241], v14 offset:28672
    ds_read_b64_tr_b16 v[242:243], v14 offset:29696
    ds_read_b64_tr_b16 v[244:245], v15 offset:28672
    ds_read_b64_tr_b16 v[246:247], v15 offset:29696
    s_waitcnt vmcnt(4)
    v_mfma_f32_32x32x16_bf16 v[192:207], v[248:251], v[108:111], v[192:207]
    v_mfma_f32_32x32x16_bf16 v[208:223], v[252:255], v[108:111], v[208:223]
    ds_read_b64_tr_b16 v[248:249], v14 offset:30720
    ds_read_b64_tr_b16 v[250:251], v14 offset:31744
    ds_read_b64_tr_b16 v[252:253], v15 offset:30720
    ds_read_b64_tr_b16 v[254:255], v15 offset:31744
    s_waitcnt vmcnt(3) lgkmcnt(0)
    v_mfma_f32_32x32x16_bf16 v[192:207], v[224:227], v[112:115], v[192:207]
    v_mfma_f32_32x32x16_bf16 v[208:223], v[228:231], v[112:115], v[208:223]
    s_waitcnt vmcnt(2)
    v_mfma_f32_32x32x16_bf16 v[192:207], v[232:235], v[116:119], v[192:207]
    v_mfma_f32_32x32x16_bf16 v[208:223], v[236:239], v[116:119], v[208:223]
    s_waitcnt vmcnt(1)
    v_mfma_f32_32x32x16_bf16 v[192:207], v[240:243], v[120:123], v[192:207]
    v_mfma_f32_32x32x16_bf16 v[208:223], v[244:247], v[120:123], v[208:223]
    s_waitcnt vmcnt(0)
    v_mfma_f32_32x32x16_bf16 v[192:207], v[248:251], v[124:127], v[192:207]
    v_mfma_f32_32x32x16_bf16 v[208:223], v[252:255], v[124:127], v[208:223]
    s_nop 15
    s_lshl_b32 s14, s3, 12
    v_add_u32 v13, s14, v9
    s_barrier
    s_cmp_ge_u32 s3, 2
    s_cbranch_scc1 F_k1_51
    ds_write_b128 v13, v[208:211] offset:0
    ds_write_b128 v13, v[212:215] offset:1024
    ds_write_b128 v13, v[216:219] offset:2048
    ds_write_b128 v13, v[220:223] offset:3072
    v_add_f32 v24, v24, v192
    v_add_f32 v25, v25, v193
    v_add_f32 v26, v26, v194
    v_add_f32 v27, v27, v195
    v_add_f32 v28, v28, v196
    v_add_f32 v29, v29, v197
    v_add_f32 v30, v30, v198
    v_add_f32 v31, v31, v199
    v_add_f32 v32, v32, v200
    v_add_f32 v33, v33, v201
    v_add_f32 v34, v34, v202
    v_add_f32 v35, v35, v203
    v_add_f32 v36, v36, v204
    v_add_f32 v37, v37, v205
    v_add_f32 v38, v38, v206
    v_add_f32 v39, v39, v207
    s_branch F_k2_52
F_k1_51:
    ds_write_b128 v13, v[192:195] offset:0
    ds_write_b128 v13, v[196:199] offset:1024
    ds_write_b128 v13, v[200:203] offset:2048
    ds_write_b128 v13, v[204:207] offset:3072
    v_add_f32 v24, v24, v208
    v_add_f32 v25, v25, v209
    v_add_f32 v26, v26, v210
    v_add_f32 v27, v27, v211
    v_add_f32 v28, v28, v212
    v_add_f32 v29, v29, v213
    v_add_f32 v30, v30, v214
    v_add_f32 v31, v31, v215
    v_add_f32 v32, v32, v216
    v_add_f32 v33, v33, v217
    v_add_f32 v34, v34, v218
    v_add_f32 v35, v35, v219
    v_add_f32 v36, v36, v220
    v_add_f32 v37, v37, v221
    v_add_f32 v38, v38, v222
    v_add_f32 v39, v39, v223
F_k2_52:
    s_xor_b32 s14, s3, 2
    s_lshl_b32 s14, s14, 12
    v_add_u32 v13, s14, v9
    s_waitcnt lgkmcnt(0)
    s_barrier
    ds_read_b128 v[64:67], v13 offset:0
    ds_read_b128 v[68:71], v13 offset:1024
    ds_read_b128 v[72:75], v13 offset:2048
    ds_read_b128 v[76:79], v13 offset:3072
    s_waitcnt lgkmcnt(0)
    v_add_f32 v24, v24, v64
    v_add_f32 v25, v25, v65
    v_add_f32 v26, v26, v66
    v_add_f32 v27, v27, v67
    v_add_f32 v28, v28, v68
    v_add_f32 v29, v29, v69
    v_add_f32 v30, v30, v70
    v_add_f32 v31, v31, v71
    v_add_f32 v32, v32, v72
    v_add_f32 v33, v33, v73
    v_add_f32 v34, v34, v74
    v_add_f32 v35, v35, v75
    v_add_f32 v36, v36, v76
    v_add_f32 v37, v37, v77
    v_add_f32 v38, v38, v78
    v_add_f32 v39, v39, v79
    v_cvt_pk_bf16_f32 v64, v24, v25
    v_cvt_pk_bf16_f32 v65, v26, v27
    v_cvt_pk_bf16_f32 v66, v28, v29
    v_cvt_pk_bf16_f32 v67, v30, v31
    v_cvt_pk_bf16_f32 v68, v32, v33
    v_cvt_pk_bf16_f32 v69, v34, v35
    v_cvt_pk_bf16_f32 v70, v36, v37
    v_cvt_pk_bf16_f32 v71, v38, v39
    buffer_store_dwordx4 v[64:67], v12, s[64:67], 0 offen
    buffer_store_dwordx4 v[68:71], v12, s[64:67], 0 offen offset:16
K_flush:
K_end:
    s_endpgm

.section .rodata,"a"
.p2align 6
.amdhsa_kernel parallel_sum__grouped_kv_mqa__glu_gated_geglu__prompt_kernel
  .amdhsa_next_free_vgpr 256
  .amdhsa_next_free_sgpr 102
  .amdhsa_accum_offset 256
  .amdhsa_group_segment_fixed_size 0
  .amdhsa_kernarg_size 96
  .amdhsa_user_sgpr_count 2
  .amdhsa_user_sgpr_kernarg_segment_ptr 1
  .amdhsa_system_sgpr_workgroup_id_x 1
.end_amdhsa_kernel
```
